```python
import torch

def _softmax(x, axis=-1):
    return torch.softmax(x, dim=axis)
def _gelu(x):
    return torch.nn.functional.gelu(x, approximate="tanh")
def _silu(x):
    return torch.nn.functional.silu(x)
def _sigmoid(x):
    return torch.sigmoid(x)
def _layernorm(x, axis=-1, eps=1e-5):
    m = x.mean(dim=axis, keepdim=True)
    v = x.var(dim=axis, keepdim=True, unbiased=False)
    return (x - m) / torch.sqrt(v + eps)
def _scatter_add(tgt, idx, src, axis=0):
    return tgt.clone().index_add_(axis, idx, src)
def _segment_sum(src, seg, n):
    out = torch.zeros((n,) + src.shape[1:], dtype=src.dtype)
    return out.index_add_(0, seg, src)
def _pad(x, pw):
    flat = tuple(v for pair in reversed(pw) for v in pair)
    return torch.nn.functional.pad(x, flat)

kernel_name = 'concat_heads__ssm_conv_s5__ssm_conv_s4d__prompt'

def setup_inputs():

    _w = (lambda a: (lambda t: t.to(torch.bfloat16) if t.is_floating_point() else t)(torch.as_tensor(a)))
    def _A_setup():
        B, S, D = 1, 2048, 576
        P = D
        Lambda_re = -0.5 * (lambda _x: torch.exp(torch.as_tensor(_x)))((lambda *s: torch.randn(*s, dtype=torch.bfloat16) * 0.2)(P))
        Lambda_im = (lambda *s: torch.randn(*s, dtype=torch.bfloat16) * 0.4)(P) * 1.0
        B_re = (lambda *s: torch.randn(*s, dtype=torch.bfloat16) * 0.2)(P, D) * (D ** -0.5)
        B_im = (lambda *s: torch.randn(*s, dtype=torch.bfloat16) * 0.2)(P, D) * (D ** -0.5)
        C_re = (lambda *s: torch.randn(*s, dtype=torch.bfloat16) * 0.2)(D, P) * (P ** -0.5)
        C_im = (lambda *s: torch.randn(*s, dtype=torch.bfloat16) * 0.2)(D, P) * (P ** -0.5)
        log_dt = (lambda *s: torch.randn(*s, dtype=torch.bfloat16) * 0.2)(P) * 0.3 - 2.0
        Dskip = (lambda *s: torch.randn(*s, dtype=torch.bfloat16) * 0.05)(D)
        return {
            "x": _w((lambda *s: torch.randn(*s, dtype=torch.bfloat16) * 0.05)(B, S, D)),
            "Lambda_re": _w(Lambda_re),
            "Lambda_im": _w(Lambda_im),
            "B_re": _w(B_re),
            "B_im": _w(B_im),
            "C_re": _w(C_re),
            "C_im": _w(C_im),
            "log_dt": _w(log_dt),
            "Dskip": _w(Dskip),
        }
    _A_in = _A_setup()

    def _B_setup():
        Bsz, L, D, N = 1, 2048, 576, 128
        return {
            "u": _w((lambda *s: torch.randn(*s, dtype=torch.bfloat16) * 0.05)(Bsz, L, D)),
            "log_A_real": _w((lambda *s: torch.randn(*s, dtype=torch.bfloat16) * 3.2)(D, N) * 0.5),
            "A_imag": _w((lambda *s: torch.randn(*s, dtype=torch.bfloat16) * 0.05)(D, N) * 3.14),
            "C_real": _w((lambda *s: torch.randn(*s, dtype=torch.bfloat16) * 0.1)(D, N) / N ** 0.5),
            "C_imag": _w((lambda *s: torch.randn(*s, dtype=torch.bfloat16) * 0.1)(D, N) / N ** 0.5),
            "log_dt": _w((lambda *s: torch.randn(*s, dtype=torch.bfloat16) * 0.05)(D) * 0.5 - 4.0),
            "D_skip": _w((lambda *s: torch.randn(*s, dtype=torch.bfloat16) * 0.05)(D)),
        }
    _B_in = _B_setup()

    return {
        "A_x": _A_in["x"],
        "A_Lambda_re": _A_in["Lambda_re"],
        "A_Lambda_im": _A_in["Lambda_im"],
        "A_B_re": _A_in["B_re"],
        "A_B_im": _A_in["B_im"],
        "A_C_re": _A_in["C_re"],
        "A_C_im": _A_in["C_im"],
        "A_log_dt": _A_in["log_dt"],
        "A_Dskip": _A_in["Dskip"],
        "B_u": _B_in["u"],
        "B_log_A_real": _B_in["log_A_real"],
        "B_A_imag": _B_in["A_imag"],
        "B_C_real": _B_in["C_real"],
        "B_C_imag": _B_in["C_imag"],
        "B_log_dt": _B_in["log_dt"],
        "B_D_skip": _B_in["D_skip"],
    }

def reference(A_x, A_Lambda_re, A_Lambda_im, A_B_re, A_B_im, A_C_re, A_C_im, A_log_dt, A_Dskip, B_u, B_log_A_real, B_A_imag, B_C_real, B_C_imag, B_log_dt, B_D_skip):
    def _A_ref(x, Lambda_re, Lambda_im, B_re, B_im, C_re, C_im, log_dt, Dskip):
        Bsz, L, H = x.shape
        Lam = Lambda_re + 1j * Lambda_im
        Bmat = B_re + 1j * B_im
        Cmat = C_re + 1j * C_im
        dt = torch.exp(log_dt)
        Lam_bar = torch.exp(dt * Lam)
        B_bar = ((Lam_bar - 1.0) / Lam)[:, None] * Bmat
        Bu = torch.einsum("bld,pd->blp", x + 0j, B_bar)
        h = torch.zeros_like(Bu[:, 0, :])
        hs = []
        for t in range(L):
            h = Lam_bar[None, :] * h + Bu[:, t, :]
            hs.append(h)
        hseq = torch.stack(hs, 1)
        y = 2.0 * torch.einsum("blp,dp->bld", hseq, Cmat).real + x * Dskip[None, None, :]
        return y

    def _B_ref(u, log_A_real, A_imag, C_real, C_imag, log_dt, D_skip):
        L = u.shape[1]
        dt = torch.exp(log_dt)
        A = -torch.exp(log_A_real) + 1j * A_imag
        C = (C_real + 1j * C_imag) * dt[:, None]
        pos = (lambda x, dt: x.to(dt))(torch.arange(L), log_dt.dtype)
        P = torch.exp((A * dt[:, None])[:, :, None] * pos[None, None, :])
        K = 2.0 * torch.einsum("dn,dnl->dl", C, P).real
        L2 = 2 * L
        u_t = (lambda x, *d: x.permute(*d))(u, 0, 2, 1)
        Kf = (lambda x, *a, **k: torch.fft.rfft(x.float(), *a, **k))(K, L2)
        Uf = (lambda x, *a, **k: torch.fft.rfft(x.float(), *a, **k))(u_t, L2)
        y = (lambda x, *a, **k: torch.fft.irfft(x, *a, **k).to(torch.bfloat16))(Uf * Kf[None, :, :], L2)[:, :, :L]
        y = (lambda x, *d: x.permute(*d))(y, 0, 2, 1)
        return y + u * D_skip[None, None, :]

    a = _A_ref(A_x, A_Lambda_re, A_Lambda_im, A_B_re, A_B_im, A_C_re, A_C_im, A_log_dt, A_Dskip)
    b = _B_ref(B_u, B_log_A_real, B_A_imag, B_C_real, B_C_imag, B_log_dt, B_D_skip)
    return torch.concatenate([a, b], axis=-1)
```

```asm
; @launch grid=(256,1,1) block=(512,1,1) lds=163840
.amdgcn_target "amdgcn-amd-amdhsa--gfx950"
.text
.globl concat_heads__ssm_conv_s5__ssm_conv_s4d__prompt_kernel
.p2align 8
.type concat_heads__ssm_conv_s5__ssm_conv_s4d__prompt_kernel,@function
.set CODE_BYTES, code_end-concat_heads__ssm_conv_s5__ssm_conv_s4d__prompt_kernel
concat_heads__ssm_conv_s5__ssm_conv_s4d__prompt_kernel:
    s_load_dwordx16 s[64:79], s[0:1], 0
    s_load_dwordx16 s[80:95], s[0:1], 64
    s_load_dwordx4 s[96:99], s[0:1], 128
    s_load_dwordx2 s[100:101], s[0:1], 144
    s_cmp_ge_u32 s2, 256
    s_cbranch_scc1 k_end
    v_lshrrev_b32 v1, 6, v0
    s_getpc_b64 s[4:5]
    s_and_b32 s4, s4, 0xffffff00
    s_lshr_b32 s6, s2, 3
    s_lshl_b32 s6, s6, 11
    v_lshrrev_b32 v2, 5, v0
    v_lshl_add_u32 v2, v2, 7, s6
    v_min_u32 v2, CODE_BYTES-4, v2
    v_and_b32 v2, -4, v2
    global_load_dword v255, v2, s[4:5]
    v_readfirstlane_b32 s3, v1
    s_cmp_ge_u32 s2, 144
    s_cbranch_scc1 role_b
    s_cmp_lt_u32 s3, 4
    s_cbranch_scc1 role_ac
role_ah:
    s_and_b32 s48, s2, 7
    s_lshl_b32 s48, s48, 1
    s_lshr_b32 s49, s2, 3
    s_cmp_ge_u32 s49, 9
    s_cselect_b32 s50, 1, 0
    s_add_u32 s48, s48, s50
    s_mul_i32 s51, s50, 9
    s_sub_u32 s49, s49, s51
    s_lshl_b32 s50, s50, 2
    s_add_u32 s53, s49, s50
    s_cmp_ge_u32 s53, 9
    s_cselect_b32 s50, 9, 0
    s_sub_u32 s53, s53, s50
    s_lshl_b32 s53, s53, 7
    s_and_b32 s52, s3, 3
    v_and_b32 v1, 63, v0
    v_lshrrev_b32 v5, 3, v1
    v_lshrrev_b32 v2, 4, v1
    v_and_b32 v4, 7, v1
    v_xor_b32 v4, v4, v2
    v_lshlrev_b32 v4, 4, v4
    v_lshrrev_b32 v2, 5, v1
    v_lshlrev_b32 v3, 5, v2
    v_bfe_u32 v2, v1, 3, 1
    v_lshl_add_u32 v3, v2, 4, v3
    v_bfe_u32 v2, v1, 4, 1
    v_add_u32 v3, v3, v2
    v_mul_u32_u24 v3, 1152, v3
    v_xor_b32 v2, 64, v4
    v_add_u32 v8, v3, v4
    v_add_u32 v9, v3, v2
    v_add_u32 v10, 256, v8
    v_add_u32 v11, 72960, v9
    v_add_u32 v9, 72704, v9
    v_mul_u32_u24 v3, 1152, v5
    v_add_u32 v12, v3, v4
    v_add_u32 v13, v3, v2
    v_add_u32 v13, 8192, v13
    s_mul_i32 s54, s48, 147456
    s_mul_i32 s50, s52, 4608
    s_add_u32 s54, s54, s50
    s_lshl_b32 s50, s49, 2
    s_add_u32 s50, s50, s52
    s_mul_i32 s55, s50, 18432
    s_lshl_b32 s56, s52, 12
    s_waitcnt lgkmcnt(0)
    s_mov_b64 s[4:5], s[64:65]
    s_mov_b64 s[8:9], s[70:71]
    s_mov_b64 s[10:11], s[72:73]
    s_mov_b64 s[12:13], s[74:75]
    s_mov_b64 s[14:15], s[76:77]
    s_mov_b64 s[6:7], s[80:81]
    s_mov_b64 s[16:17], s[96:97]
    s_mov_b64 s[18:19], s[98:99]
    s_mov_b64 s[20:21], s[100:101]
    s_mov_b32 s24, s4
    s_mov_b32 s25, s5
    s_mov_b32 s26, 2359296
    s_mov_b32 s27, 0x00020000
    s_mov_b32 s28, s8
    s_mov_b32 s29, s9
    s_mov_b32 s30, 663552
    s_mov_b32 s31, 0x00020000
    s_mov_b32 s32, s10
    s_mov_b32 s33, s11
    s_mov_b32 s34, 663552
    s_mov_b32 s35, 0x00020000
    s_mov_b32 s59, s53
    s_add_u32 s50, s54, s53
    s_add_u32 m0, s56, 0
    s_add_u32 s53, s53, 128
    s_cmp_ge_u32 s53, 1152
    s_cselect_b32 s53, 0, s53
    buffer_load_dwordx4 v8, s[24:27], s50 offen offset:0  lds
    buffer_load_dwordx4 v9, s[24:27], s50 offen offset:1024  lds
    buffer_load_dwordx4 v10, s[24:27], s50 offen offset:2048  lds
    buffer_load_dwordx4 v11, s[24:27], s50 offen offset:3072  lds
    s_add_u32 s51, s55, s59
    s_add_u32 m0, s56, 16384
    s_add_u32 s59, s59, 128
    s_cmp_ge_u32 s59, 1152
    s_cselect_b32 s59, 0, s59
    buffer_load_dwordx4 v12, s[28:31], s51 offen offset:0 lds
    buffer_load_dwordx4 v13, s[28:31], s51 offen offset:1024 lds
    s_add_u32 m0, s56, 18432
    s_nop 0
    buffer_load_dwordx4 v12, s[32:35], s51 offen offset:0 lds
    buffer_load_dwordx4 v13, s[32:35], s51 offen offset:1024 lds
    s_add_u32 s51, s55, s59
    s_add_u32 m0, s56, 49152
    s_add_u32 s59, s59, 128
    s_cmp_ge_u32 s59, 1152
    s_cselect_b32 s59, 0, s59
    buffer_load_dwordx4 v12, s[28:31], s51 offen offset:0 lds
    buffer_load_dwordx4 v13, s[28:31], s51 offen offset:1024 lds
    s_add_u32 m0, s56, 51200
    s_nop 0
    buffer_load_dwordx4 v12, s[32:35], s51 offen offset:0 lds
    buffer_load_dwordx4 v13, s[32:35], s51 offen offset:1024 lds
    s_add_u32 s50, s54, s53
    s_add_u32 m0, s56, 32768
    s_add_u32 s53, s53, 128
    s_cmp_ge_u32 s53, 1152
    s_cselect_b32 s53, 0, s53
    buffer_load_dwordx4 v8, s[24:27], s50 offen offset:0  lds
    buffer_load_dwordx4 v9, s[24:27], s50 offen offset:1024  lds
    buffer_load_dwordx4 v10, s[24:27], s50 offen offset:2048  lds
    buffer_load_dwordx4 v11, s[24:27], s50 offen offset:3072  lds
    s_add_u32 s40, s20, 8462336
    s_addc_u32 s41, s21, 0
    s_mov_b32 s42, 18432
    s_mov_b32 s43, 0x00020000
    s_mul_i32 s50, s48, 1152
    v_and_b32 v2, 3, v1
    v_lshl_add_u32 v2, v2, 2, s50
    v_lshrrev_b32 v29, 2, v1
    v_lshl_add_u32 v29, v29, 7, v2
    v_subrev_u32 v2, 36, v1
    v_min_u32 v2, 8, v2
    v_lshl_add_u32 v20, v2, 7, s50
    v_add_u32 v2, 16, v20
    v_cmp_gt_u32 vcc, 36, v1
    s_nop 1
    v_cndmask_b32 v29, v2, v29, vcc
    s_lshl_b32 s51, s49, 7
    s_add_u32 s50, s50, s51
    v_mov_b32 v31, s50
    v_mov_b32 v2, 0x7fffffff
    v_cmp_eq_u32 vcc, 0, v1
    s_nop 1
    v_cndmask_b32 v31, v2, v31, vcc
    v_mov_b32 v22, 1
    s_getreg_b32 s60, hwreg(HW_REG_XCC_ID)
    s_and_b32 s60, s60, 15
    s_cmp_lt_u32 s52, 2
    s_cselect_b32 s36, s12, s14
    s_cselect_b32 s37, s13, s15
    s_mov_b32 s38, 663552
    s_mov_b32 s39, 0x00020000
    s_mov_b32 s44, s16
    s_mov_b32 s45, s17
    s_mov_b32 s46, 9437184
    s_mov_b32 s47, 0x00020000
    s_lshl_b32 s61, s49, 7
    s_lshl_b32 s50, s49, 6
    s_and_b32 s51, s52, 1
    s_lshl_b32 s51, s51, 5
    s_add_u32 s50, s50, s51
    s_mul_i32 s57, s50, 1152
    v_mov_b32 v16, v12
    v_mov_b32 v17, v13
    v_add_u32 v18, 16384, v12
    v_add_u32 v19, 16384, v13
    v_lshrrev_b32 v2, 4, v1
    v_mul_u32_u24 v56, 4608, v2
    v_and_b32 v2, 15, v1
    v_lshl_add_u32 v56, v2, 4, v56
    v_add_u32 v57, 17408, v56
    v_add_u32 v58, 34816, v56
    v_add_u32 v59, 52224, v56
    s_lshl_b32 s50, s48, 7
    s_lshl_b32 s51, s52, 3
    s_add_u32 s50, s50, s51
    v_bfe_u32 v2, v1, 3, 1
    v_lshl_add_u32 v3, v2, 5, s50
    v_and_b32 v2, 4, v1
    v_add_u32 v3, v3, v2
    v_lshrrev_b32 v2, 4, v1
    v_and_b32 v4, 3, v1
    v_lshl_add_u32 v4, v2, 2, v4
    s_lshl_b32 s51, s49, 4
    v_add_u32 v27, s51, v4
    v_mul_u32_u24 v24, 1152, v3
    v_lshl_add_u32 v24, v27, 3, v24
    v_mul_u32_u24 v25, 4608, v3
    v_lshl_add_u32 v25, v27, 4, v25
    v_lshlrev_b32 v27, 3, v27
    v_and_b32 v26, 15, v1
    v_lshlrev_b32 v26, 4, v26
    v_bfe_u32 v2, v1, 4, 1
    v_lshl_add_u32 v26, v2, 10, v26
    v_lshrrev_b32 v2, 5, v1
    v_lshl_add_u32 v26, v2, 14, v26
    s_lshl_b32 s50, s52, 11
    v_add_u32 v26, s50, v26
    s_lshl_b32 s63, s52, 13
    global_load_dwordx2 v[48:49], v27, s[6:7]
    s_lshl_b32 s58, s48, 7
    s_lshl_b32 s50, s52, 5
    s_add_u32 s58, s58, s50
    s_mul_i32 s58, s58, 4608
    s_lshl_b32 s62, s49, 8
    s_add_u32 s62, s62, 256
    s_cmp_ge_u32 s62, 2304
    s_cselect_b32 s62, 0, s62
    s_waitcnt vmcnt(9)
    s_barrier
    s_add_u32 s51, s55, s59
    s_add_u32 m0, s56, 81920
    s_add_u32 s59, s59, 128
    s_cmp_ge_u32 s59, 1152
    s_cselect_b32 s59, 0, s59
    buffer_load_dwordx4 v12, s[28:31], s51 offen offset:0 lds
    buffer_load_dwordx4 v13, s[28:31], s51 offen offset:1024 lds
    s_add_u32 m0, s56, 83968
    s_nop 0
    buffer_load_dwordx4 v12, s[32:35], s51 offen offset:0 lds
    buffer_load_dwordx4 v13, s[32:35], s51 offen offset:1024 lds
    s_add_u32 s50, s54, s53
    s_add_u32 m0, s56, 65536
    s_add_u32 s53, s53, 128
    s_cmp_ge_u32 s53, 1152
    s_cselect_b32 s53, 0, s53
    buffer_load_dwordx4 v8, s[24:27], s50 offen offset:0  lds
    buffer_load_dwordx4 v9, s[24:27], s50 offen offset:1024  lds
    buffer_load_dwordx4 v10, s[24:27], s50 offen offset:2048  lds
    buffer_load_dwordx4 v11, s[24:27], s50 offen offset:3072  lds
    s_waitcnt vmcnt(9)
    s_barrier
    s_add_u32 s50, s54, s53
    s_add_u32 m0, s56, 98304
    s_add_u32 s53, s53, 128
    s_cmp_ge_u32 s53, 1152
    s_cselect_b32 s53, 0, s53
    buffer_load_dwordx4 v8, s[24:27], s50 offen offset:0  lds
    buffer_load_dwordx4 v9, s[24:27], s50 offen offset:1024  lds
    buffer_load_dwordx4 v10, s[24:27], s50 offen offset:2048  lds
    buffer_load_dwordx4 v11, s[24:27], s50 offen offset:3072  lds
    s_add_u32 s51, s55, s59
    s_add_u32 m0, s56, 114688
    s_add_u32 s59, s59, 128
    s_cmp_ge_u32 s59, 1152
    s_cselect_b32 s59, 0, s59
    buffer_load_dwordx4 v12, s[28:31], s51 offen offset:0 lds
    buffer_load_dwordx4 v13, s[28:31], s51 offen offset:1024 lds
    s_add_u32 m0, s56, 116736
    s_nop 0
    buffer_load_dwordx4 v12, s[32:35], s51 offen offset:0 lds
    buffer_load_dwordx4 v13, s[32:35], s51 offen offset:1024 lds
    s_waitcnt vmcnt(8)
    s_barrier
    s_add_u32 s50, s54, s53
    s_add_u32 m0, s56, 131072
    s_add_u32 s53, s53, 128
    s_cmp_ge_u32 s53, 1152
    s_cselect_b32 s53, 0, s53
    buffer_load_dwordx4 v8, s[24:27], s50 offen offset:0  lds
    buffer_load_dwordx4 v9, s[24:27], s50 offen offset:1024  lds
    buffer_load_dwordx4 v10, s[24:27], s50 offen offset:2048  lds
    buffer_load_dwordx4 v11, s[24:27], s50 offen offset:3072  lds
    s_add_u32 s51, s55, s59
    s_add_u32 m0, s56, 147456
    s_add_u32 s59, s59, 128
    s_cmp_ge_u32 s59, 1152
    s_cselect_b32 s59, 0, s59
    buffer_load_dwordx4 v12, s[28:31], s51 offen offset:0 lds
    buffer_load_dwordx4 v13, s[28:31], s51 offen offset:1024 lds
    s_add_u32 m0, s56, 149504
    s_nop 0
    buffer_load_dwordx4 v12, s[32:35], s51 offen offset:0 lds
    buffer_load_dwordx4 v13, s[32:35], s51 offen offset:1024 lds
    s_waitcnt vmcnt(8)
    s_barrier
    s_add_u32 s50, s54, s53
    s_add_u32 m0, s56, 0
    s_add_u32 s53, s53, 128
    s_cmp_ge_u32 s53, 1152
    s_cselect_b32 s53, 0, s53
    buffer_load_dwordx4 v8, s[24:27], s50 offen offset:0  lds
    buffer_load_dwordx4 v9, s[24:27], s50 offen offset:1024  lds
    buffer_load_dwordx4 v10, s[24:27], s50 offen offset:2048  lds
    buffer_load_dwordx4 v11, s[24:27], s50 offen offset:3072  lds
    s_add_u32 s51, s55, s59
    s_add_u32 m0, s56, 16384
    s_add_u32 s59, s59, 128
    s_cmp_ge_u32 s59, 1152
    s_cselect_b32 s59, 0, s59
    buffer_load_dwordx4 v12, s[28:31], s51 offen offset:0 lds
    buffer_load_dwordx4 v13, s[28:31], s51 offen offset:1024 lds
    s_add_u32 m0, s56, 18432
    s_nop 0
    buffer_load_dwordx4 v12, s[32:35], s51 offen offset:0 lds
    buffer_load_dwordx4 v13, s[32:35], s51 offen offset:1024 lds
    s_waitcnt vmcnt(8)
    s_barrier
    s_add_u32 s50, s54, s53
    s_add_u32 m0, s56, 32768
    s_add_u32 s53, s53, 128
    s_cmp_ge_u32 s53, 1152
    s_cselect_b32 s53, 0, s53
    buffer_load_dwordx4 v8, s[24:27], s50 offen offset:0  lds
    buffer_load_dwordx4 v9, s[24:27], s50 offen offset:1024  lds
    buffer_load_dwordx4 v10, s[24:27], s50 offen offset:2048  lds
    buffer_load_dwordx4 v11, s[24:27], s50 offen offset:3072  lds
    s_add_u32 s51, s55, s59
    s_add_u32 m0, s56, 49152
    s_add_u32 s59, s59, 128
    s_cmp_ge_u32 s59, 1152
    s_cselect_b32 s59, 0, s59
    buffer_load_dwordx4 v12, s[28:31], s51 offen offset:0 lds
    buffer_load_dwordx4 v13, s[28:31], s51 offen offset:1024 lds
    s_add_u32 m0, s56, 51200
    s_nop 0
    buffer_load_dwordx4 v12, s[32:35], s51 offen offset:0 lds
    buffer_load_dwordx4 v13, s[32:35], s51 offen offset:1024 lds
    s_waitcnt vmcnt(8)
    s_barrier
    s_add_u32 s50, s54, s53
    s_add_u32 m0, s56, 65536
    s_add_u32 s53, s53, 128
    s_cmp_ge_u32 s53, 1152
    s_cselect_b32 s53, 0, s53
    buffer_load_dwordx4 v8, s[24:27], s50 offen offset:0  lds
    buffer_load_dwordx4 v9, s[24:27], s50 offen offset:1024  lds
    buffer_load_dwordx4 v10, s[24:27], s50 offen offset:2048  lds
    buffer_load_dwordx4 v11, s[24:27], s50 offen offset:3072  lds
    s_add_u32 s51, s55, s59
    s_add_u32 m0, s56, 81920
    s_add_u32 s59, s59, 128
    s_cmp_ge_u32 s59, 1152
    s_cselect_b32 s59, 0, s59
    buffer_load_dwordx4 v12, s[28:31], s51 offen offset:0 lds
    buffer_load_dwordx4 v13, s[28:31], s51 offen offset:1024 lds
    s_add_u32 m0, s56, 83968
    s_nop 0
    buffer_load_dwordx4 v12, s[32:35], s51 offen offset:0 lds
    buffer_load_dwordx4 v13, s[32:35], s51 offen offset:1024 lds
    s_waitcnt vmcnt(8)
    s_barrier
    s_add_u32 s50, s54, s53
    s_add_u32 m0, s56, 98304
    s_add_u32 s53, s53, 128
    s_cmp_ge_u32 s53, 1152
    s_cselect_b32 s53, 0, s53
    buffer_load_dwordx4 v8, s[24:27], s50 offen offset:0  lds
    buffer_load_dwordx4 v9, s[24:27], s50 offen offset:1024  lds
    buffer_load_dwordx4 v10, s[24:27], s50 offen offset:2048  lds
    buffer_load_dwordx4 v11, s[24:27], s50 offen offset:3072  lds
    s_add_u32 s51, s55, s59
    s_add_u32 m0, s56, 114688
    s_add_u32 s59, s59, 128
    s_cmp_ge_u32 s59, 1152
    s_cselect_b32 s59, 0, s59
    buffer_load_dwordx4 v12, s[28:31], s51 offen offset:0 lds
    buffer_load_dwordx4 v13, s[28:31], s51 offen offset:1024 lds
    s_add_u32 m0, s56, 116736
    s_nop 0
    buffer_load_dwordx4 v12, s[32:35], s51 offen offset:0 lds
    buffer_load_dwordx4 v13, s[32:35], s51 offen offset:1024 lds
    s_waitcnt vmcnt(8)
    s_barrier
    s_add_u32 s50, s57, s61
    s_add_u32 m0, s56, 0
    s_add_u32 s61, s61, 128
    s_cmp_ge_u32 s61, 1152
    s_cselect_b32 s61, 0, s61
    buffer_load_dwordx4 v16, s[36:39], s50 offen offset:0 lds
    buffer_load_dwordx4 v17, s[36:39], s50 offen offset:1024 lds
    buffer_load_dwordx4 v18, s[36:39], s50 offen offset:2048 lds
    buffer_load_dwordx4 v19, s[36:39], s50 offen offset:3072 lds
    s_add_u32 s50, s57, s61
    s_add_u32 m0, s56, 16384
    s_add_u32 s61, s61, 128
    s_cmp_ge_u32 s61, 1152
    s_cselect_b32 s61, 0, s61
    buffer_load_dwordx4 v16, s[36:39], s50 offen offset:0 lds
    buffer_load_dwordx4 v17, s[36:39], s50 offen offset:1024 lds
    buffer_load_dwordx4 v18, s[36:39], s50 offen offset:2048 lds
    buffer_load_dwordx4 v19, s[36:39], s50 offen offset:3072 lds
    s_waitcnt vmcnt(8)
    s_barrier
    s_add_u32 s50, s57, s61
    s_add_u32 m0, s56, 32768
    s_add_u32 s61, s61, 128
    s_cmp_ge_u32 s61, 1152
    s_cselect_b32 s61, 0, s61
    buffer_load_dwordx4 v16, s[36:39], s50 offen offset:0 lds
    buffer_load_dwordx4 v17, s[36:39], s50 offen offset:1024 lds
    buffer_load_dwordx4 v18, s[36:39], s50 offen offset:2048 lds
    buffer_load_dwordx4 v19, s[36:39], s50 offen offset:3072 lds
    s_add_u32 s50, s57, s61
    s_add_u32 m0, s56, 49152
    s_add_u32 s61, s61, 128
    s_cmp_ge_u32 s61, 1152
    s_cselect_b32 s61, 0, s61
    buffer_load_dwordx4 v16, s[36:39], s50 offen offset:0 lds
    buffer_load_dwordx4 v17, s[36:39], s50 offen offset:1024 lds
    buffer_load_dwordx4 v18, s[36:39], s50 offen offset:2048 lds
    buffer_load_dwordx4 v19, s[36:39], s50 offen offset:3072 lds
    s_barrier
    s_add_u32 s50, s57, s61
    s_add_u32 m0, s56, 65536
    s_add_u32 s61, s61, 128
    s_cmp_ge_u32 s61, 1152
    s_cselect_b32 s61, 0, s61
    buffer_load_dwordx4 v16, s[36:39], s50 offen offset:0 lds
    buffer_load_dwordx4 v17, s[36:39], s50 offen offset:1024 lds
    buffer_load_dwordx4 v18, s[36:39], s50 offen offset:2048 lds
    buffer_load_dwordx4 v19, s[36:39], s50 offen offset:3072 lds
    s_add_u32 s50, s57, s61
    s_add_u32 m0, s56, 81920
    s_add_u32 s61, s61, 128
    s_cmp_ge_u32 s61, 1152
    s_cselect_b32 s61, 0, s61
    buffer_load_dwordx4 v16, s[36:39], s50 offen offset:0 lds
    buffer_load_dwordx4 v17, s[36:39], s50 offen offset:1024 lds
    buffer_load_dwordx4 v18, s[36:39], s50 offen offset:2048 lds
    buffer_load_dwordx4 v19, s[36:39], s50 offen offset:3072 lds
    s_add_u32 s50, s57, s61
    s_add_u32 m0, s56, 98304
    s_add_u32 s61, s61, 128
    s_cmp_ge_u32 s61, 1152
    s_cselect_b32 s61, 0, s61
    buffer_load_dwordx4 v16, s[36:39], s50 offen offset:0 lds
    buffer_load_dwordx4 v17, s[36:39], s50 offen offset:1024 lds
    buffer_load_dwordx4 v18, s[36:39], s50 offen offset:2048 lds
    buffer_load_dwordx4 v19, s[36:39], s50 offen offset:3072 lds
    s_add_u32 s50, s57, s61
    s_add_u32 m0, s56, 114688
    s_add_u32 s61, s61, 128
    s_cmp_ge_u32 s61, 1152
    s_cselect_b32 s61, 0, s61
    buffer_load_dwordx4 v16, s[36:39], s50 offen offset:0 lds
    buffer_load_dwordx4 v17, s[36:39], s50 offen offset:1024 lds
    buffer_load_dwordx4 v18, s[36:39], s50 offen offset:2048 lds
    buffer_load_dwordx4 v19, s[36:39], s50 offen offset:3072 lds
    s_add_u32 s50, s57, s61
    s_add_u32 m0, s56, 131072
    s_add_u32 s61, s61, 128
    s_cmp_ge_u32 s61, 1152
    s_cselect_b32 s61, 0, s61
    buffer_load_dwordx4 v16, s[36:39], s50 offen offset:0 lds
    buffer_load_dwordx4 v17, s[36:39], s50 offen offset:1024 lds
    buffer_load_dwordx4 v18, s[36:39], s50 offen offset:2048 lds
    buffer_load_dwordx4 v19, s[36:39], s50 offen offset:3072 lds
    s_mov_b32 s50, 0
    buffer_load_dwordx2 v[32:33], v24, s[24:27], s50 offen offset:0
    buffer_load_dwordx2 v[34:35], v24, s[24:27], s50 offen offset:1152
    buffer_load_dwordx2 v[36:37], v24, s[24:27], s50 offen offset:2304
    buffer_load_dwordx2 v[38:39], v24, s[24:27], s50 offen offset:3456
    s_mov_b32 s50, 73728
    buffer_load_dwordx2 v[40:41], v24, s[24:27], s50 offen offset:0
    buffer_load_dwordx2 v[42:43], v24, s[24:27], s50 offen offset:1152
    buffer_load_dwordx2 v[44:45], v24, s[24:27], s50 offen offset:2304
    buffer_load_dwordx2 v[46:47], v24, s[24:27], s50 offen offset:3456
    v_lshlrev_b32 v52, 16, v48
    v_and_b32 v53, 0xffff0000, v48
    v_lshlrev_b32 v54, 16, v49
    v_and_b32 v55, 0xffff0000, v49
    s_waitcnt vmcnt(0)
    s_barrier
    s_cmp_lg_u32 s52, 0
    s_cbranch_scc1 ah_poll_ok
ah_poll:
    buffer_load_dword v2, v29, s[40:43], 0 offen sc1
    s_waitcnt vmcnt(0)
    v_cmp_ne_u32 vcc, 1, v2
    s_nop 0
    s_and_b32 vcc_hi, vcc_hi, 15
    s_cmp_lg_u64 vcc, 0
    s_cbranch_scc1 ah_poll
    v_cmp_ne_u32 vcc, s60, v2
    s_nop 0
    s_lshr_b32 s60, vcc_hi, 4
ah_poll_ok:
    s_barrier
    s_add_u32 s50, s58, s62
    s_add_u32 m0, s63, 32768
    s_nop 0
    buffer_load_dwordx4 v56, s[44:47], s50 offen offset:0 sc1 lds
    buffer_load_dwordx4 v57, s[44:47], s50 offen offset:1024 sc1 lds
    buffer_load_dwordx4 v58, s[44:47], s50 offen offset:2048 sc1 lds
    buffer_load_dwordx4 v59, s[44:47], s50 offen offset:3072 sc1 lds
    s_add_u32 s50, s58, s62
    s_add_u32 m0, s63, 36864
    s_add_u32 s50, s50, 73728
    s_add_u32 s62, s62, 256
    s_cmp_ge_u32 s62, 2304
    s_cselect_b32 s62, 0, s62
    buffer_load_dwordx4 v56, s[44:47], s50 offen offset:0 sc1 lds
    buffer_load_dwordx4 v57, s[44:47], s50 offen offset:1024 sc1 lds
    buffer_load_dwordx4 v58, s[44:47], s50 offen offset:2048 sc1 lds
    buffer_load_dwordx4 v59, s[44:47], s50 offen offset:3072 sc1 lds
    s_add_u32 s50, s58, s62
    s_add_u32 m0, s63, 65536
    s_nop 0
    buffer_load_dwordx4 v56, s[44:47], s50 offen offset:0 sc1 lds
    buffer_load_dwordx4 v57, s[44:47], s50 offen offset:1024 sc1 lds
    buffer_load_dwordx4 v58, s[44:47], s50 offen offset:2048 sc1 lds
    buffer_load_dwordx4 v59, s[44:47], s50 offen offset:3072 sc1 lds
    s_waitcnt vmcnt(4)
    s_barrier
    s_add_u32 s50, s58, s62
    s_add_u32 m0, s63, 69632
    s_add_u32 s50, s50, 73728
    s_add_u32 s62, s62, 256
    s_cmp_ge_u32 s62, 2304
    s_cselect_b32 s62, 0, s62
    buffer_load_dwordx4 v56, s[44:47], s50 offen offset:0 sc1 lds
    buffer_load_dwordx4 v57, s[44:47], s50 offen offset:1024 sc1 lds
    buffer_load_dwordx4 v58, s[44:47], s50 offen offset:2048 sc1 lds
    buffer_load_dwordx4 v59, s[44:47], s50 offen offset:3072 sc1 lds
    s_add_u32 s50, s58, s62
    s_add_u32 m0, s63, 98304
    s_nop 0
    buffer_load_dwordx4 v56, s[44:47], s50 offen offset:0 sc1 lds
    buffer_load_dwordx4 v57, s[44:47], s50 offen offset:1024 sc1 lds
    buffer_load_dwordx4 v58, s[44:47], s50 offen offset:2048 sc1 lds
    buffer_load_dwordx4 v59, s[44:47], s50 offen offset:3072 sc1 lds
    s_waitcnt vmcnt(4)
    s_barrier
    s_add_u32 s50, s58, s62
    s_add_u32 m0, s63, 102400
    s_add_u32 s50, s50, 73728
    s_add_u32 s62, s62, 256
    s_cmp_ge_u32 s62, 2304
    s_cselect_b32 s62, 0, s62
    buffer_load_dwordx4 v56, s[44:47], s50 offen offset:0 sc1 lds
    buffer_load_dwordx4 v57, s[44:47], s50 offen offset:1024 sc1 lds
    buffer_load_dwordx4 v58, s[44:47], s50 offen offset:2048 sc1 lds
    buffer_load_dwordx4 v59, s[44:47], s50 offen offset:3072 sc1 lds
    s_add_u32 s50, s58, s62
    s_add_u32 m0, s63, 131072
    s_nop 0
    buffer_load_dwordx4 v56, s[44:47], s50 offen offset:0 sc1 lds
    buffer_load_dwordx4 v57, s[44:47], s50 offen offset:1024 sc1 lds
    buffer_load_dwordx4 v58, s[44:47], s50 offen offset:2048 sc1 lds
    buffer_load_dwordx4 v59, s[44:47], s50 offen offset:3072 sc1 lds
    s_waitcnt vmcnt(4)
    s_barrier
    s_add_u32 s50, s58, s62
    s_add_u32 m0, s63, 135168
    s_add_u32 s50, s50, 73728
    s_add_u32 s62, s62, 256
    s_cmp_ge_u32 s62, 2304
    s_cselect_b32 s62, 0, s62
    buffer_load_dwordx4 v56, s[44:47], s50 offen offset:0 sc1 lds
    buffer_load_dwordx4 v57, s[44:47], s50 offen offset:1024 sc1 lds
    buffer_load_dwordx4 v58, s[44:47], s50 offen offset:2048 sc1 lds
    buffer_load_dwordx4 v59, s[44:47], s50 offen offset:3072 sc1 lds
    s_add_u32 s50, s58, s62
    s_add_u32 m0, s63, 0
    s_nop 0
    buffer_load_dwordx4 v56, s[44:47], s50 offen offset:0 sc1 lds
    buffer_load_dwordx4 v57, s[44:47], s50 offen offset:1024 sc1 lds
    buffer_load_dwordx4 v58, s[44:47], s50 offen offset:2048 sc1 lds
    buffer_load_dwordx4 v59, s[44:47], s50 offen offset:3072 sc1 lds
    s_waitcnt vmcnt(4)
    s_barrier
    s_add_u32 s50, s58, s62
    s_add_u32 m0, s63, 4096
    s_add_u32 s50, s50, 73728
    s_add_u32 s62, s62, 256
    s_cmp_ge_u32 s62, 2304
    s_cselect_b32 s62, 0, s62
    buffer_load_dwordx4 v56, s[44:47], s50 offen offset:0 sc1 lds
    buffer_load_dwordx4 v57, s[44:47], s50 offen offset:1024 sc1 lds
    buffer_load_dwordx4 v58, s[44:47], s50 offen offset:2048 sc1 lds
    buffer_load_dwordx4 v59, s[44:47], s50 offen offset:3072 sc1 lds
    s_add_u32 s50, s58, s62
    s_add_u32 m0, s63, 32768
    s_nop 0
    buffer_load_dwordx4 v56, s[44:47], s50 offen offset:0 sc1 lds
    buffer_load_dwordx4 v57, s[44:47], s50 offen offset:1024 sc1 lds
    buffer_load_dwordx4 v58, s[44:47], s50 offen offset:2048 sc1 lds
    buffer_load_dwordx4 v59, s[44:47], s50 offen offset:3072 sc1 lds
    s_waitcnt vmcnt(4)
    s_barrier
    s_add_u32 s50, s58, s62
    s_add_u32 m0, s63, 36864
    s_add_u32 s50, s50, 73728
    s_add_u32 s62, s62, 256
    s_cmp_ge_u32 s62, 2304
    s_cselect_b32 s62, 0, s62
    buffer_load_dwordx4 v56, s[44:47], s50 offen offset:0 sc1 lds
    buffer_load_dwordx4 v57, s[44:47], s50 offen offset:1024 sc1 lds
    buffer_load_dwordx4 v58, s[44:47], s50 offen offset:2048 sc1 lds
    buffer_load_dwordx4 v59, s[44:47], s50 offen offset:3072 sc1 lds
    s_add_u32 s50, s58, s62
    s_add_u32 m0, s63, 65536
    s_nop 0
    buffer_load_dwordx4 v56, s[44:47], s50 offen offset:0 sc1 lds
    buffer_load_dwordx4 v57, s[44:47], s50 offen offset:1024 sc1 lds
    buffer_load_dwordx4 v58, s[44:47], s50 offen offset:2048 sc1 lds
    buffer_load_dwordx4 v59, s[44:47], s50 offen offset:3072 sc1 lds
    s_waitcnt vmcnt(4)
    s_barrier
    s_add_u32 s50, s58, s62
    s_add_u32 m0, s63, 69632
    s_add_u32 s50, s50, 73728
    s_add_u32 s62, s62, 256
    s_cmp_ge_u32 s62, 2304
    s_cselect_b32 s62, 0, s62
    buffer_load_dwordx4 v56, s[44:47], s50 offen offset:0 sc1 lds
    buffer_load_dwordx4 v57, s[44:47], s50 offen offset:1024 sc1 lds
    buffer_load_dwordx4 v58, s[44:47], s50 offen offset:2048 sc1 lds
    buffer_load_dwordx4 v59, s[44:47], s50 offen offset:3072 sc1 lds
    s_add_u32 s50, s58, s62
    s_add_u32 m0, s63, 98304
    s_nop 0
    buffer_load_dwordx4 v56, s[44:47], s50 offen offset:0 sc1 lds
    buffer_load_dwordx4 v57, s[44:47], s50 offen offset:1024 sc1 lds
    buffer_load_dwordx4 v58, s[44:47], s50 offen offset:2048 sc1 lds
    buffer_load_dwordx4 v59, s[44:47], s50 offen offset:3072 sc1 lds
    s_waitcnt vmcnt(4)
    s_barrier
    s_add_u32 s50, s58, s62
    s_add_u32 m0, s63, 102400
    s_add_u32 s50, s50, 73728
    s_add_u32 s62, s62, 256
    s_cmp_ge_u32 s62, 2304
    s_cselect_b32 s62, 0, s62
    buffer_load_dwordx4 v56, s[44:47], s50 offen offset:0 sc1 lds
    buffer_load_dwordx4 v57, s[44:47], s50 offen offset:1024 sc1 lds
    buffer_load_dwordx4 v58, s[44:47], s50 offen offset:2048 sc1 lds
    buffer_load_dwordx4 v59, s[44:47], s50 offen offset:3072 sc1 lds
    v_lshlrev_b32 v64, 16, v32
    v_and_b32 v65, 0xffff0000, v32
    v_lshlrev_b32 v66, 16, v33
    v_and_b32 v67, 0xffff0000, v33
    v_mul_f32 v64, v64, v52
    v_mul_f32 v65, v65, v53
    v_mul_f32 v66, v66, v54
    v_mul_f32 v67, v67, v55
    v_cvt_pk_bf16_f32 v64, 0, v64
    v_cvt_pk_bf16_f32 v65, 0, v65
    v_cvt_pk_bf16_f32 v66, 0, v66
    v_cvt_pk_bf16_f32 v67, 0, v67
    v_lshlrev_b32 v68, 16, v34
    v_and_b32 v69, 0xffff0000, v34
    v_lshlrev_b32 v70, 16, v35
    v_and_b32 v71, 0xffff0000, v35
    v_mul_f32 v68, v68, v52
    v_mul_f32 v69, v69, v53
    v_mul_f32 v70, v70, v54
    v_mul_f32 v71, v71, v55
    v_cvt_pk_bf16_f32 v68, 0, v68
    v_cvt_pk_bf16_f32 v69, 0, v69
    v_cvt_pk_bf16_f32 v70, 0, v70
    v_cvt_pk_bf16_f32 v71, 0, v71
    v_lshlrev_b32 v72, 16, v36
    v_and_b32 v73, 0xffff0000, v36
    v_lshlrev_b32 v74, 16, v37
    v_and_b32 v75, 0xffff0000, v37
    v_mul_f32 v72, v72, v52
    v_mul_f32 v73, v73, v53
    v_mul_f32 v74, v74, v54
    v_mul_f32 v75, v75, v55
    v_cvt_pk_bf16_f32 v72, 0, v72
    v_cvt_pk_bf16_f32 v73, 0, v73
    v_cvt_pk_bf16_f32 v74, 0, v74
    v_cvt_pk_bf16_f32 v75, 0, v75
    v_lshlrev_b32 v76, 16, v38
    v_and_b32 v77, 0xffff0000, v38
    v_lshlrev_b32 v78, 16, v39
    v_and_b32 v79, 0xffff0000, v39
    v_mul_f32 v76, v76, v52
    v_mul_f32 v77, v77, v53
    v_mul_f32 v78, v78, v54
    v_mul_f32 v79, v79, v55
    v_cvt_pk_bf16_f32 v76, 0, v76
    v_cvt_pk_bf16_f32 v77, 0, v77
    v_cvt_pk_bf16_f32 v78, 0, v78
    v_cvt_pk_bf16_f32 v79, 0, v79
    v_lshlrev_b32 v80, 16, v40
    v_and_b32 v81, 0xffff0000, v40
    v_lshlrev_b32 v82, 16, v41
    v_and_b32 v83, 0xffff0000, v41
    v_mul_f32 v80, v80, v52
    v_mul_f32 v81, v81, v53
    v_mul_f32 v82, v82, v54
    v_mul_f32 v83, v83, v55
    v_cvt_pk_bf16_f32 v80, 0, v80
    v_cvt_pk_bf16_f32 v81, 0, v81
    v_cvt_pk_bf16_f32 v82, 0, v82
    v_cvt_pk_bf16_f32 v83, 0, v83
    s_waitcnt vmcnt(0)
    s_barrier
    s_cmp_lg_u32 s52, 0
    s_cbranch_scc1 ah_dn_j
    s_cmp_eq_u32 s60, 0
    s_cbranch_scc1 ah_dn_f
    buffer_store_dword v22, v31, s[40:43], 0 offen offset:20 sc1
    s_branch ah_dn_j
ah_dn_f:
    buffer_store_dword v22, v31, s[40:43], 0 offen offset:20
ah_dn_j:
    s_waitcnt vmcnt(0)
    v_lshlrev_b32 v84, 16, v42
    v_and_b32 v85, 0xffff0000, v42
    v_lshlrev_b32 v86, 16, v43
    v_and_b32 v87, 0xffff0000, v43
    v_mul_f32 v84, v84, v52
    v_mul_f32 v85, v85, v53
    v_mul_f32 v86, v86, v54
    v_mul_f32 v87, v87, v55
    v_cvt_pk_bf16_f32 v84, 0, v84
    v_cvt_pk_bf16_f32 v85, 0, v85
    v_cvt_pk_bf16_f32 v86, 0, v86
    v_cvt_pk_bf16_f32 v87, 0, v87
    v_lshlrev_b32 v88, 16, v44
    v_and_b32 v89, 0xffff0000, v44
    v_lshlrev_b32 v90, 16, v45
    v_and_b32 v91, 0xffff0000, v45
    v_mul_f32 v88, v88, v52
    v_mul_f32 v89, v89, v53
    v_mul_f32 v90, v90, v54
    v_mul_f32 v91, v91, v55
    v_cvt_pk_bf16_f32 v88, 0, v88
    v_cvt_pk_bf16_f32 v89, 0, v89
    v_cvt_pk_bf16_f32 v90, 0, v90
    v_cvt_pk_bf16_f32 v91, 0, v91
    v_lshlrev_b32 v92, 16, v46
    v_and_b32 v93, 0xffff0000, v46
    v_lshlrev_b32 v94, 16, v47
    v_and_b32 v95, 0xffff0000, v47
    v_mul_f32 v92, v92, v52
    v_mul_f32 v93, v93, v53
    v_mul_f32 v94, v94, v54
    v_mul_f32 v95, v95, v55
    v_cvt_pk_bf16_f32 v92, 0, v92
    v_cvt_pk_bf16_f32 v93, 0, v93
    v_cvt_pk_bf16_f32 v94, 0, v94
    v_cvt_pk_bf16_f32 v95, 0, v95
    s_cmp_lg_u32 s52, 0
    s_cbranch_scc1 ah_dp_ok
ah_dp:
    buffer_load_dword v2, v20, s[40:43], 0 offen offset:20 sc1
    s_waitcnt vmcnt(0)
    v_cmp_ne_u32 vcc, 1, v2
    s_nop 0
    s_cmp_lg_u64 vcc, 0
    s_cbranch_scc1 ah_dp
ah_dp_ok:
    s_setprio 3
    s_barrier
    ds_read_b128 v[96:99], v26 offset:0
    ds_read_b128 v[100:103], v26 offset:32768
    ds_read_b128 v[104:107], v26 offset:256
    ds_read_b128 v[108:111], v26 offset:33024
    ds_read_b128 v[112:115], v26 offset:512
    ds_read_b128 v[116:119], v26 offset:33280
    ds_read_b128 v[120:123], v26 offset:768
    ds_read_b128 v[124:127], v26 offset:33536
    s_waitcnt lgkmcnt(6)
    v_add_f32 v64, v64, v96
    v_add_f32 v65, v65, v97
    v_add_f32 v66, v66, v98
    v_add_f32 v67, v67, v99
    v_add_f32 v64, v64, v100
    v_add_f32 v65, v65, v101
    v_add_f32 v66, v66, v102
    v_add_f32 v67, v67, v103
    s_mov_b32 s50, 0
    buffer_store_dwordx4 v[64:67], v25, s[44:47], s50 offen
    s_waitcnt lgkmcnt(4)
    v_add_f32 v68, v68, v104
    v_add_f32 v69, v69, v105
    v_add_f32 v70, v70, v106
    v_add_f32 v71, v71, v107
    v_add_f32 v68, v68, v108
    v_add_f32 v69, v69, v109
    v_add_f32 v70, v70, v110
    v_add_f32 v71, v71, v111
    s_mov_b32 s50, 4608
    buffer_store_dwordx4 v[68:71], v25, s[44:47], s50 offen
    s_waitcnt lgkmcnt(2)
    v_add_f32 v72, v72, v112
    v_add_f32 v73, v73, v113
    v_add_f32 v74, v74, v114
    v_add_f32 v75, v75, v115
    v_add_f32 v72, v72, v116
    v_add_f32 v73, v73, v117
    v_add_f32 v74, v74, v118
    v_add_f32 v75, v75, v119
    s_mov_b32 s50, 9216
    buffer_store_dwordx4 v[72:75], v25, s[44:47], s50 offen
    s_waitcnt lgkmcnt(0)
    v_add_f32 v76, v76, v120
    v_add_f32 v77, v77, v121
    v_add_f32 v78, v78, v122
    v_add_f32 v79, v79, v123
    v_add_f32 v76, v76, v124
    v_add_f32 v77, v77, v125
    v_add_f32 v78, v78, v126
    v_add_f32 v79, v79, v127
    s_mov_b32 s50, 13824
    buffer_store_dwordx4 v[76:79], v25, s[44:47], s50 offen
    s_barrier
    ds_read_b128 v[96:99], v26 offset:8192
    ds_read_b128 v[100:103], v26 offset:40960
    ds_read_b128 v[104:107], v26 offset:8448
    ds_read_b128 v[108:111], v26 offset:41216
    ds_read_b128 v[112:115], v26 offset:8704
    ds_read_b128 v[116:119], v26 offset:41472
    ds_read_b128 v[120:123], v26 offset:8960
    ds_read_b128 v[124:127], v26 offset:41728
    s_waitcnt lgkmcnt(6)
    v_add_f32 v80, v80, v96
    v_add_f32 v81, v81, v97
    v_add_f32 v82, v82, v98
    v_add_f32 v83, v83, v99
    v_add_f32 v80, v80, v100
    v_add_f32 v81, v81, v101
    v_add_f32 v82, v82, v102
    v_add_f32 v83, v83, v103
    s_mov_b32 s50, 294912
    buffer_store_dwordx4 v[80:83], v25, s[44:47], s50 offen
    s_waitcnt lgkmcnt(4)
    v_add_f32 v84, v84, v104
    v_add_f32 v85, v85, v105
    v_add_f32 v86, v86, v106
    v_add_f32 v87, v87, v107
    v_add_f32 v84, v84, v108
    v_add_f32 v85, v85, v109
    v_add_f32 v86, v86, v110
    v_add_f32 v87, v87, v111
    s_mov_b32 s50, 299520
    buffer_store_dwordx4 v[84:87], v25, s[44:47], s50 offen
    s_waitcnt lgkmcnt(2)
    v_add_f32 v88, v88, v112
    v_add_f32 v89, v89, v113
    v_add_f32 v90, v90, v114
    v_add_f32 v91, v91, v115
    v_add_f32 v88, v88, v116
    v_add_f32 v89, v89, v117
    v_add_f32 v90, v90, v118
    v_add_f32 v91, v91, v119
    s_mov_b32 s50, 304128
    buffer_store_dwordx4 v[88:91], v25, s[44:47], s50 offen
    s_waitcnt lgkmcnt(0)
    v_add_f32 v92, v92, v120
    v_add_f32 v93, v93, v121
    v_add_f32 v94, v94, v122
    v_add_f32 v95, v95, v123
    v_add_f32 v92, v92, v124
    v_add_f32 v93, v93, v125
    v_add_f32 v94, v94, v126
    v_add_f32 v95, v95, v127
    s_mov_b32 s50, 308736
    buffer_store_dwordx4 v[92:95], v25, s[44:47], s50 offen
    s_endpgm
role_ac:
    s_and_b32 s48, s2, 7
    s_lshl_b32 s48, s48, 1
    s_lshr_b32 s49, s2, 3
    s_cmp_ge_u32 s49, 9
    s_cselect_b32 s50, 1, 0
    s_add_u32 s48, s48, s50
    s_mul_i32 s51, s50, 9
    s_sub_u32 s49, s49, s51
    v_and_b32 v1, 63, v0
    v_and_b32 v2, 15, v0
    v_lshrrev_b32 v3, 4, v1
    s_lshl_b32 s52, s49, 2
    s_add_u32 s52, s52, s3
    s_lshl_b32 s51, s52, 4
    v_add_u32 v8, s51, v2
    v_lshlrev_b32 v11, 1, v8
    s_mul_i32 s51, s48, 576
    v_add_u32 v8, s51, v8
    v_lshlrev_b32 v10, 3, v8
    v_mul_u32_u24 v8, 18432, v3
    v_sub_u32 v14, v10, v8
    v_subrev_u32 v244, 4608, v14
    v_subrev_u32 v245, 9216, v14
    v_subrev_u32 v246, 13824, v14
    v_subrev_u32 v247, 18432, v14
    v_cmp_eq_u32 vcc, 3, v3
    v_mov_b32 v8, 0x7fffffff
    s_nop 0
    v_cndmask_b32 v10, v8, v10, vcc
    s_waitcnt lgkmcnt(0)
    s_mov_b64 s[4:5], s[66:67]
    s_mov_b64 s[6:7], s[68:69]
    s_mov_b64 s[8:9], s[78:79]
    s_mov_b64 s[20:21], s[98:99]
    s_mov_b64 s[22:23], s[100:101]
    s_mov_b64 s[10:11], s[96:97]
    s_lshl_b32 s50, s52, 5
    s_load_dwordx8 s[64:71], s[4:5], s50
    s_load_dwordx8 s[72:79], s[6:7], s50
    s_load_dwordx8 s[80:87], s[8:9], s50
    s_add_u32 s40, s22, 8388608
    s_addc_u32 s41, s23, 0
    s_mov_b32 s42, 73728
    s_mov_b32 s43, 0x00020000
    s_mov_b32 s36, s10
    s_mov_b32 s37, s11
    s_mov_b32 s38, 9437184
    s_mov_b32 s39, 0x00020000
    s_mov_b32 s44, s20
    s_mov_b32 s45, s21
    s_mov_b32 s46, 256
    s_mov_b32 s47, 0x00020000
    v_lshrrev_b32 v8, 1, v2
    v_xor_b32 v8, v8, v3
    v_lshlrev_b32 v8, 4, v8
    v_lshl_add_u32 v15, v2, 7, v8
    v_and_b32 v8, 1, v3
    v_lshlrev_b32 v8, 2, v8
    v_xor_b32 v8, v8, v1
    v_lshlrev_b32 v12, 4, v8
    s_getreg_b32 s56, hwreg(HW_REG_XCC_ID)
    s_and_b32 s56, s56, 15
    v_and_b32 v13, 3, v0
    v_lshlrev_b32 v13, 2, v13
    s_add_u32 s24, s22, 8462336
    s_addc_u32 s25, s23, 0
    s_mov_b32 s26, 18432
    s_mov_b32 s27, 0x00020000
    s_mul_i32 s50, s48, 1152
    v_min_u32 v241, 8, v1
    v_lshl_add_u32 v241, v241, 7, s50
    s_lshl_b32 s51, s49, 7
    s_add_u32 s50, s50, s51
    v_mov_b32 v240, s50
    v_mov_b32 v242, 0x7fffffff
    v_cmp_eq_u32 vcc, 0, v0
    s_nop 1
    v_cndmask_b32 v240, v242, v240, vcc
    v_and_b32 v243, 255, v12
    v_mul_u32_u24 v8, 4608, v3
    v_add_u32 v243, v243, v8
    s_lshl_b32 s50, s48, 7
    s_lshl_b32 s51, s3, 4
    s_add_u32 s50, s50, s51
    s_mul_i32 s50, s50, 4608
    s_lshl_b32 s51, s49, 8
    s_add_u32 s28, s50, s51
    s_add_u32 s29, s28, 18432
    s_add_u32 s30, s28, 36864
    s_add_u32 s31, s28, 55296
    s_add_u32 s32, s28, 294912
    s_add_u32 s33, s28, 313344
    s_add_u32 s34, s28, 331776
    s_add_u32 s35, s28, 350208
    s_lshl_b32 s55, s3, 12
    v_mov_b32 v4, v15
    v_xor_b32 v5, 64, v4
    v_add_u32 v6, s55, v4
    v_xor_b32 v7, 64, v6
    v_lshrrev_b32 v48, 1, v2
    v_and_b32 v49, 1, v2
    v_lshlrev_b32 v49, 4, v49
    s_waitcnt lgkmcnt(0)
    v_mov_b32 v40, s64
    v_mov_b32 v41, s72
    v_mov_b32 v42, s80
    v_cmp_eq_u32 vcc, 1, v48
    v_mov_b32 v50, s65
    v_mov_b32 v51, s73
    v_mov_b32 v52, s81
    v_cndmask_b32 v40, v40, v50, vcc
    v_cndmask_b32 v41, v41, v51, vcc
    v_cndmask_b32 v42, v42, v52, vcc
    v_cmp_eq_u32 vcc, 2, v48
    v_mov_b32 v50, s66
    v_mov_b32 v51, s74
    v_mov_b32 v52, s82
    v_cndmask_b32 v40, v40, v50, vcc
    v_cndmask_b32 v41, v41, v51, vcc
    v_cndmask_b32 v42, v42, v52, vcc
    v_cmp_eq_u32 vcc, 3, v48
    v_mov_b32 v50, s67
    v_mov_b32 v51, s75
    v_mov_b32 v52, s83
    v_cndmask_b32 v40, v40, v50, vcc
    v_cndmask_b32 v41, v41, v51, vcc
    v_cndmask_b32 v42, v42, v52, vcc
    v_cmp_eq_u32 vcc, 4, v48
    v_mov_b32 v50, s68
    v_mov_b32 v51, s76
    v_mov_b32 v52, s84
    v_cndmask_b32 v40, v40, v50, vcc
    v_cndmask_b32 v41, v41, v51, vcc
    v_cndmask_b32 v42, v42, v52, vcc
    v_cmp_eq_u32 vcc, 5, v48
    v_mov_b32 v50, s69
    v_mov_b32 v51, s77
    v_mov_b32 v52, s85
    v_cndmask_b32 v40, v40, v50, vcc
    v_cndmask_b32 v41, v41, v51, vcc
    v_cndmask_b32 v42, v42, v52, vcc
    v_cmp_eq_u32 vcc, 6, v48
    v_mov_b32 v50, s70
    v_mov_b32 v51, s78
    v_mov_b32 v52, s86
    v_cndmask_b32 v40, v40, v50, vcc
    v_cndmask_b32 v41, v41, v51, vcc
    v_cndmask_b32 v42, v42, v52, vcc
    v_cmp_eq_u32 vcc, 7, v48
    v_mov_b32 v50, s71
    v_mov_b32 v51, s79
    v_mov_b32 v52, s87
    v_cndmask_b32 v40, v40, v50, vcc
    v_cndmask_b32 v41, v41, v51, vcc
    v_cndmask_b32 v42, v42, v52, vcc
    v_lshrrev_b32 v40, v49, v40
    v_lshrrev_b32 v41, v49, v41
    v_lshrrev_b32 v42, v49, v42
    v_lshlrev_b32 v40, 16, v40
    v_lshlrev_b32 v41, 16, v41
    v_lshlrev_b32 v42, 16, v42
    v_mul_f32 v42, 0x3fb8aa3b, v42
    v_exp_f32 v42, v42
    s_nop 0
    v_cvt_pk_bf16_f32 v42, 0, v42
    v_mul_f32 v46, v42, v40
    v_mul_f32 v47, v42, v41
    v_mul_f32 v46, 0x3fb8aa3b, v46
    v_mul_f32 v47, 0.15915494, v47
    v_exp_f32 v48, v46
    v_rndne_f32 v16, v47
    v_sub_f32 v49, v47, v16
    v_cos_f32 v16, v49
    v_sin_f32 v17, v49
    v_mul_f32 v16, v16, v48
    v_mul_f32 v17, v17, v48
    v_mul_f32 v48, 0x41800000, v46
    v_mul_f32 v49, 0x41800000, v47
    v_exp_f32 v48, v48
    v_rndne_f32 v18, v49
    v_sub_f32 v49, v49, v18
    v_cos_f32 v18, v49
    v_sin_f32 v19, v49
    v_mul_f32 v18, v18, v48
    v_mul_f32 v19, v19, v48
    v_mul_f32 v48, 0x42000000, v46
    v_mul_f32 v49, 0x42000000, v47
    v_exp_f32 v48, v48
    v_rndne_f32 v20, v49
    v_sub_f32 v49, v49, v20
    v_cos_f32 v20, v49
    v_sin_f32 v21, v49
    v_mul_f32 v20, v20, v48
    v_mul_f32 v21, v21, v48
    v_mul_f32 v48, 0x42800000, v46
    v_mul_f32 v49, 0x42800000, v47
    v_exp_f32 v48, v48
    v_rndne_f32 v22, v49
    v_sub_f32 v49, v49, v22
    v_cos_f32 v22, v49
    v_sin_f32 v23, v49
    v_mul_f32 v22, v22, v48
    v_mul_f32 v23, v23, v48
    v_cvt_f32_u32 v52, v3
    v_mul_f32 v50, 0x42000000, v52
    v_mul_f32 v48, v50, v46
    v_mul_f32 v49, v50, v47
    v_exp_f32 v48, v48
    v_rndne_f32 v24, v49
    v_sub_f32 v49, v49, v24
    v_cos_f32 v24, v49
    v_sin_f32 v26, v49
    v_mul_f32 v24, v24, v48
    v_mul_f32 v26, v26, v48
    v_add_f32 v50, 0x41800000, v50
    v_mul_f32 v48, v50, v46
    v_mul_f32 v49, v50, v47
    v_exp_f32 v48, v48
    v_rndne_f32 v25, v49
    v_sub_f32 v49, v49, v25
    v_cos_f32 v25, v49
    v_sin_f32 v27, v49
    v_mul_f32 v25, v25, v48
    v_mul_f32 v27, v27, v48
    v_cmp_eq_u32 vcc, 3, v3
    s_nop 1
    v_cndmask_b32 v28, 1.0, v20, vcc
    v_cndmask_b32 v29, 0, v21, vcc
    v_mul_f32 v50, 0x44000000, v52
    v_mul_f32 v48, v50, v46
    v_mul_f32 v49, v50, v47
    v_exp_f32 v48, v48
    v_rndne_f32 v30, v49
    v_sub_f32 v49, v49, v30
    v_cos_f32 v30, v49
    v_sin_f32 v31, v49
    v_mul_f32 v30, v30, v48
    v_mul_f32 v31, v31, v48
    v_add_f32 v50, 0x43000000, v50
    v_mul_f32 v48, v50, v46
    v_mul_f32 v49, v50, v47
    v_exp_f32 v48, v48
    v_rndne_f32 v32, v49
    v_sub_f32 v49, v49, v32
    v_cos_f32 v32, v49
    v_sin_f32 v33, v49
    v_mul_f32 v32, v32, v48
    v_mul_f32 v33, v33, v48
    v_add_f32 v50, 0x43000000, v50
    v_mul_f32 v48, v50, v46
    v_mul_f32 v49, v50, v47
    v_exp_f32 v48, v48
    v_rndne_f32 v34, v49
    v_sub_f32 v49, v49, v34
    v_cos_f32 v34, v49
    v_sin_f32 v35, v49
    v_mul_f32 v34, v34, v48
    v_mul_f32 v35, v35, v48
    v_add_f32 v50, 0x43000000, v50
    v_mul_f32 v48, v50, v46
    v_mul_f32 v49, v50, v47
    v_exp_f32 v48, v48
    v_rndne_f32 v36, v49
    v_sub_f32 v49, v49, v36
    v_cos_f32 v36, v49
    v_sin_f32 v37, v49
    v_mul_f32 v36, v36, v48
    v_mul_f32 v37, v37, v48
    v_mul_f32 v48, v40, v40
    v_fma_f32 v48, v41, v41, v48
    v_rcp_f32 v48, v48
    v_add_f32 v49, -1.0, v16
    v_add_f32 v48, v48, v48
    v_mul_f32 v50, v49, v40
    v_mul_f32 v51, v17, v40
    v_fma_f32 v50, v17, v41, v50
    v_fma_f32 v51, -v49, v41, v51
    v_mul_f32 v38, v50, v48
    v_mul_f32 v39, v51, v48
.p2align 3
    v_pk_mul_f32 v[192:193], v[38:39], v[16:17] op_sel:[0,0] op_sel_hi:[1,0]
    v_pk_fma_f32 v[192:193], v[38:39], v[16:17], v[192:193] op_sel:[1,1,0] op_sel_hi:[0,1,1] neg_lo:[1,0,0]
    v_pk_mul_f32 v[194:195], v[192:193], v[16:17] op_sel:[0,0] op_sel_hi:[1,0]
    v_pk_fma_f32 v[194:195], v[192:193], v[16:17], v[194:195] op_sel:[1,1,0] op_sel_hi:[0,1,1] neg_lo:[1,0,0]
    v_pk_mul_f32 v[196:197], v[194:195], v[16:17] op_sel:[0,0] op_sel_hi:[1,0]
    v_pk_fma_f32 v[196:197], v[194:195], v[16:17], v[196:197] op_sel:[1,1,0] op_sel_hi:[0,1,1] neg_lo:[1,0,0]
    v_pk_mul_f32 v[198:199], v[196:197], v[16:17] op_sel:[0,0] op_sel_hi:[1,0]
    v_pk_fma_f32 v[198:199], v[196:197], v[16:17], v[198:199] op_sel:[1,1,0] op_sel_hi:[0,1,1] neg_lo:[1,0,0]
    v_pk_mul_f32 v[200:201], v[198:199], v[16:17] op_sel:[0,0] op_sel_hi:[1,0]
    v_pk_fma_f32 v[200:201], v[198:199], v[16:17], v[200:201] op_sel:[1,1,0] op_sel_hi:[0,1,1] neg_lo:[1,0,0]
    v_pk_mul_f32 v[202:203], v[200:201], v[16:17] op_sel:[0,0] op_sel_hi:[1,0]
    v_pk_fma_f32 v[202:203], v[200:201], v[16:17], v[202:203] op_sel:[1,1,0] op_sel_hi:[0,1,1] neg_lo:[1,0,0]
    v_pk_mul_f32 v[204:205], v[202:203], v[16:17] op_sel:[0,0] op_sel_hi:[1,0]
    v_pk_fma_f32 v[204:205], v[202:203], v[16:17], v[204:205] op_sel:[1,1,0] op_sel_hi:[0,1,1] neg_lo:[1,0,0]
    v_pk_mul_f32 v[206:207], v[204:205], v[16:17] op_sel:[0,0] op_sel_hi:[1,0]
    v_pk_fma_f32 v[206:207], v[204:205], v[16:17], v[206:207] op_sel:[1,1,0] op_sel_hi:[0,1,1] neg_lo:[1,0,0]
    v_pk_mul_f32 v[208:209], v[206:207], v[16:17] op_sel:[0,0] op_sel_hi:[1,0]
    v_pk_fma_f32 v[208:209], v[206:207], v[16:17], v[208:209] op_sel:[1,1,0] op_sel_hi:[0,1,1] neg_lo:[1,0,0]
    v_pk_mul_f32 v[210:211], v[208:209], v[16:17] op_sel:[0,0] op_sel_hi:[1,0]
    v_pk_fma_f32 v[210:211], v[208:209], v[16:17], v[210:211] op_sel:[1,1,0] op_sel_hi:[0,1,1] neg_lo:[1,0,0]
    v_pk_mul_f32 v[212:213], v[210:211], v[16:17] op_sel:[0,0] op_sel_hi:[1,0]
    v_pk_fma_f32 v[212:213], v[210:211], v[16:17], v[212:213] op_sel:[1,1,0] op_sel_hi:[0,1,1] neg_lo:[1,0,0]
    v_pk_mul_f32 v[214:215], v[212:213], v[16:17] op_sel:[0,0] op_sel_hi:[1,0]
    v_pk_fma_f32 v[214:215], v[212:213], v[16:17], v[214:215] op_sel:[1,1,0] op_sel_hi:[0,1,1] neg_lo:[1,0,0]
    v_pk_mul_f32 v[216:217], v[214:215], v[16:17] op_sel:[0,0] op_sel_hi:[1,0]
    v_pk_fma_f32 v[216:217], v[214:215], v[16:17], v[216:217] op_sel:[1,1,0] op_sel_hi:[0,1,1] neg_lo:[1,0,0]
    v_pk_mul_f32 v[218:219], v[216:217], v[16:17] op_sel:[0,0] op_sel_hi:[1,0]
    v_pk_fma_f32 v[218:219], v[216:217], v[16:17], v[218:219] op_sel:[1,1,0] op_sel_hi:[0,1,1] neg_lo:[1,0,0]
    v_pk_mul_f32 v[220:221], v[218:219], v[16:17] op_sel:[0,0] op_sel_hi:[1,0]
    v_pk_fma_f32 v[220:221], v[218:219], v[16:17], v[220:221] op_sel:[1,1,0] op_sel_hi:[0,1,1] neg_lo:[1,0,0]
    v_pk_mul_f32 v[222:223], v[220:221], v[16:17] op_sel:[0,0] op_sel_hi:[1,0]
    v_pk_fma_f32 v[222:223], v[220:221], v[16:17], v[222:223] op_sel:[1,1,0] op_sel_hi:[0,1,1] neg_lo:[1,0,0]
    s_barrier
    ds_read_b128 v[224:227], v6 offset:16384
    ds_read_b128 v[228:231], v6 offset:18432
    ds_read_b128 v[128:131], v4 offset:0
    ds_read_b128 v[132:135], v4 offset:2048
    ds_read_b128 v[136:139], v4 offset:4096
    ds_read_b128 v[140:143], v4 offset:6144
    ds_read_b128 v[144:147], v4 offset:8192
    ds_read_b128 v[148:151], v4 offset:10240
    ds_read_b128 v[152:155], v4 offset:12288
    ds_read_b128 v[156:159], v4 offset:14336
    s_waitcnt lgkmcnt(7)
    v_mfma_f32_16x16x32_bf16 v[64:67], v[128:131], v[224:227], 0
    ds_read_b128 v[232:235], v7 offset:16384
    v_mfma_f32_16x16x32_bf16 v[96:99], v[128:131], v[228:231], 0
    ds_read_b128 v[236:239], v7 offset:18432
    s_waitcnt lgkmcnt(8)
    v_mfma_f32_16x16x32_bf16 v[68:71], v[132:135], v[224:227], 0
    ds_read_b128 v[160:163], v5 offset:0
    v_mfma_f32_16x16x32_bf16 v[100:103], v[132:135], v[228:231], 0
    ds_read_b128 v[164:167], v5 offset:2048
    s_waitcnt lgkmcnt(9)
    v_mfma_f32_16x16x32_bf16 v[72:75], v[136:139], v[224:227], 0
    ds_read_b128 v[168:171], v5 offset:4096
    v_mfma_f32_16x16x32_bf16 v[104:107], v[136:139], v[228:231], 0
    ds_read_b128 v[172:175], v5 offset:6144
    s_waitcnt lgkmcnt(10)
    v_mfma_f32_16x16x32_bf16 v[76:79], v[140:143], v[224:227], 0
    ds_read_b128 v[176:179], v5 offset:8192
    v_mfma_f32_16x16x32_bf16 v[108:111], v[140:143], v[228:231], 0
    ds_read_b128 v[180:183], v5 offset:10240
    s_waitcnt lgkmcnt(11)
    v_mfma_f32_16x16x32_bf16 v[80:83], v[144:147], v[224:227], 0
    ds_read_b128 v[184:187], v5 offset:12288
    v_mfma_f32_16x16x32_bf16 v[112:115], v[144:147], v[228:231], 0
    ds_read_b128 v[188:191], v5 offset:14336
    s_waitcnt lgkmcnt(12)
    v_mfma_f32_16x16x32_bf16 v[84:87], v[148:151], v[224:227], 0
    v_mfma_f32_16x16x32_bf16 v[116:119], v[148:151], v[228:231], 0
    s_waitcnt lgkmcnt(11)
    v_mfma_f32_16x16x32_bf16 v[88:91], v[152:155], v[224:227], 0
    v_mfma_f32_16x16x32_bf16 v[120:123], v[152:155], v[228:231], 0
    s_waitcnt lgkmcnt(10)
    v_mfma_f32_16x16x32_bf16 v[92:95], v[156:159], v[224:227], 0
    v_mfma_f32_16x16x32_bf16 v[124:127], v[156:159], v[228:231], 0
    v_add_u32 v4, 32768, v15
    v_xor_b32 v5, 64, v4
    v_add_u32 v6, s55, v4
    v_xor_b32 v7, 64, v6
    s_barrier
    s_waitcnt lgkmcnt(7)
    v_mfma_f32_16x16x32_bf16 v[64:67], v[160:163], v[232:235], v[64:67]
    ds_read_b128 v[224:227], v6 offset:16384
    v_mfma_f32_16x16x32_bf16 v[96:99], v[160:163], v[236:239], v[96:99]
    ds_read_b128 v[228:231], v6 offset:18432
    s_waitcnt lgkmcnt(8)
    v_mfma_f32_16x16x32_bf16 v[68:71], v[164:167], v[232:235], v[68:71]
    ds_read_b128 v[128:131], v4 offset:0
    v_mfma_f32_16x16x32_bf16 v[100:103], v[164:167], v[236:239], v[100:103]
    ds_read_b128 v[132:135], v4 offset:2048
    s_waitcnt lgkmcnt(9)
    v_mfma_f32_16x16x32_bf16 v[72:75], v[168:171], v[232:235], v[72:75]
    ds_read_b128 v[136:139], v4 offset:4096
    v_mfma_f32_16x16x32_bf16 v[104:107], v[168:171], v[236:239], v[104:107]
    ds_read_b128 v[140:143], v4 offset:6144
    s_waitcnt lgkmcnt(10)
    v_mfma_f32_16x16x32_bf16 v[76:79], v[172:175], v[232:235], v[76:79]
    ds_read_b128 v[144:147], v4 offset:8192
    v_mfma_f32_16x16x32_bf16 v[108:111], v[172:175], v[236:239], v[108:111]
    ds_read_b128 v[148:151], v4 offset:10240
    s_waitcnt lgkmcnt(11)
    v_mfma_f32_16x16x32_bf16 v[80:83], v[176:179], v[232:235], v[80:83]
    ds_read_b128 v[152:155], v4 offset:12288
    v_mfma_f32_16x16x32_bf16 v[112:115], v[176:179], v[236:239], v[112:115]
    ds_read_b128 v[156:159], v4 offset:14336
    s_waitcnt lgkmcnt(12)
    v_mfma_f32_16x16x32_bf16 v[84:87], v[180:183], v[232:235], v[84:87]
    v_mfma_f32_16x16x32_bf16 v[116:119], v[180:183], v[236:239], v[116:119]
    s_waitcnt lgkmcnt(11)
    v_mfma_f32_16x16x32_bf16 v[88:91], v[184:187], v[232:235], v[88:91]
    v_mfma_f32_16x16x32_bf16 v[120:123], v[184:187], v[236:239], v[120:123]
    s_waitcnt lgkmcnt(10)
    v_mfma_f32_16x16x32_bf16 v[92:95], v[188:191], v[232:235], v[92:95]
    v_mfma_f32_16x16x32_bf16 v[124:127], v[188:191], v[236:239], v[124:127]
    s_waitcnt lgkmcnt(7)
    v_mfma_f32_16x16x32_bf16 v[64:67], v[128:131], v[224:227], v[64:67]
    ds_read_b128 v[232:235], v7 offset:16384
    v_mfma_f32_16x16x32_bf16 v[96:99], v[128:131], v[228:231], v[96:99]
    ds_read_b128 v[236:239], v7 offset:18432
    s_waitcnt lgkmcnt(8)
    v_mfma_f32_16x16x32_bf16 v[68:71], v[132:135], v[224:227], v[68:71]
    ds_read_b128 v[160:163], v5 offset:0
    v_mfma_f32_16x16x32_bf16 v[100:103], v[132:135], v[228:231], v[100:103]
    ds_read_b128 v[164:167], v5 offset:2048
    s_waitcnt lgkmcnt(9)
    v_mfma_f32_16x16x32_bf16 v[72:75], v[136:139], v[224:227], v[72:75]
    ds_read_b128 v[168:171], v5 offset:4096
    v_mfma_f32_16x16x32_bf16 v[104:107], v[136:139], v[228:231], v[104:107]
    ds_read_b128 v[172:175], v5 offset:6144
    s_waitcnt lgkmcnt(10)
    v_mfma_f32_16x16x32_bf16 v[76:79], v[140:143], v[224:227], v[76:79]
    ds_read_b128 v[176:179], v5 offset:8192
    v_mfma_f32_16x16x32_bf16 v[108:111], v[140:143], v[228:231], v[108:111]
    ds_read_b128 v[180:183], v5 offset:10240
    s_waitcnt lgkmcnt(11)
    v_mfma_f32_16x16x32_bf16 v[80:83], v[144:147], v[224:227], v[80:83]
    ds_read_b128 v[184:187], v5 offset:12288
    v_mfma_f32_16x16x32_bf16 v[112:115], v[144:147], v[228:231], v[112:115]
    ds_read_b128 v[188:191], v5 offset:14336
    s_waitcnt lgkmcnt(12)
    v_mfma_f32_16x16x32_bf16 v[84:87], v[148:151], v[224:227], v[84:87]
    v_mfma_f32_16x16x32_bf16 v[116:119], v[148:151], v[228:231], v[116:119]
    s_waitcnt lgkmcnt(11)
    v_mfma_f32_16x16x32_bf16 v[88:91], v[152:155], v[224:227], v[88:91]
    v_mfma_f32_16x16x32_bf16 v[120:123], v[152:155], v[228:231], v[120:123]
    s_waitcnt lgkmcnt(10)
    v_mfma_f32_16x16x32_bf16 v[92:95], v[156:159], v[224:227], v[92:95]
    v_mfma_f32_16x16x32_bf16 v[124:127], v[156:159], v[228:231], v[124:127]
    v_add_u32 v4, 65536, v15
    v_xor_b32 v5, 64, v4
    v_add_u32 v6, s55, v4
    v_xor_b32 v7, 64, v6
    s_barrier
    s_waitcnt lgkmcnt(7)
    v_mfma_f32_16x16x32_bf16 v[64:67], v[160:163], v[232:235], v[64:67]
    ds_read_b128 v[224:227], v6 offset:16384
    v_mfma_f32_16x16x32_bf16 v[96:99], v[160:163], v[236:239], v[96:99]
    ds_read_b128 v[228:231], v6 offset:18432
    s_waitcnt lgkmcnt(8)
    v_mfma_f32_16x16x32_bf16 v[68:71], v[164:167], v[232:235], v[68:71]
    ds_read_b128 v[128:131], v4 offset:0
    v_mfma_f32_16x16x32_bf16 v[100:103], v[164:167], v[236:239], v[100:103]
    ds_read_b128 v[132:135], v4 offset:2048
    s_waitcnt lgkmcnt(9)
    v_mfma_f32_16x16x32_bf16 v[72:75], v[168:171], v[232:235], v[72:75]
    ds_read_b128 v[136:139], v4 offset:4096
    v_mfma_f32_16x16x32_bf16 v[104:107], v[168:171], v[236:239], v[104:107]
    ds_read_b128 v[140:143], v4 offset:6144
    s_waitcnt lgkmcnt(10)
    v_mfma_f32_16x16x32_bf16 v[76:79], v[172:175], v[232:235], v[76:79]
    ds_read_b128 v[144:147], v4 offset:8192
    v_mfma_f32_16x16x32_bf16 v[108:111], v[172:175], v[236:239], v[108:111]
    ds_read_b128 v[148:151], v4 offset:10240
    s_waitcnt lgkmcnt(11)
    v_mfma_f32_16x16x32_bf16 v[80:83], v[176:179], v[232:235], v[80:83]
    ds_read_b128 v[152:155], v4 offset:12288
    v_mfma_f32_16x16x32_bf16 v[112:115], v[176:179], v[236:239], v[112:115]
    ds_read_b128 v[156:159], v4 offset:14336
    s_waitcnt lgkmcnt(12)
    v_mfma_f32_16x16x32_bf16 v[84:87], v[180:183], v[232:235], v[84:87]
    v_mfma_f32_16x16x32_bf16 v[116:119], v[180:183], v[236:239], v[116:119]
    s_waitcnt lgkmcnt(11)
    v_mfma_f32_16x16x32_bf16 v[88:91], v[184:187], v[232:235], v[88:91]
    v_mfma_f32_16x16x32_bf16 v[120:123], v[184:187], v[236:239], v[120:123]
    s_waitcnt lgkmcnt(10)
    v_mfma_f32_16x16x32_bf16 v[92:95], v[188:191], v[232:235], v[92:95]
    v_mfma_f32_16x16x32_bf16 v[124:127], v[188:191], v[236:239], v[124:127]
    s_waitcnt lgkmcnt(7)
    v_mfma_f32_16x16x32_bf16 v[64:67], v[128:131], v[224:227], v[64:67]
    ds_read_b128 v[232:235], v7 offset:16384
    v_mfma_f32_16x16x32_bf16 v[96:99], v[128:131], v[228:231], v[96:99]
    ds_read_b128 v[236:239], v7 offset:18432
    s_waitcnt lgkmcnt(8)
    v_mfma_f32_16x16x32_bf16 v[68:71], v[132:135], v[224:227], v[68:71]
    ds_read_b128 v[160:163], v5 offset:0
    v_mfma_f32_16x16x32_bf16 v[100:103], v[132:135], v[228:231], v[100:103]
    ds_read_b128 v[164:167], v5 offset:2048
    s_waitcnt lgkmcnt(9)
    v_mfma_f32_16x16x32_bf16 v[72:75], v[136:139], v[224:227], v[72:75]
    ds_read_b128 v[168:171], v5 offset:4096
    v_mfma_f32_16x16x32_bf16 v[104:107], v[136:139], v[228:231], v[104:107]
    ds_read_b128 v[172:175], v5 offset:6144
    s_waitcnt lgkmcnt(10)
    v_mfma_f32_16x16x32_bf16 v[76:79], v[140:143], v[224:227], v[76:79]
    ds_read_b128 v[176:179], v5 offset:8192
    v_mfma_f32_16x16x32_bf16 v[108:111], v[140:143], v[228:231], v[108:111]
    ds_read_b128 v[180:183], v5 offset:10240
    s_waitcnt lgkmcnt(11)
    v_mfma_f32_16x16x32_bf16 v[80:83], v[144:147], v[224:227], v[80:83]
    ds_read_b128 v[184:187], v5 offset:12288
    v_mfma_f32_16x16x32_bf16 v[112:115], v[144:147], v[228:231], v[112:115]
    ds_read_b128 v[188:191], v5 offset:14336
    s_waitcnt lgkmcnt(12)
    v_mfma_f32_16x16x32_bf16 v[84:87], v[148:151], v[224:227], v[84:87]
    v_mfma_f32_16x16x32_bf16 v[116:119], v[148:151], v[228:231], v[116:119]
    s_waitcnt lgkmcnt(11)
    v_mfma_f32_16x16x32_bf16 v[88:91], v[152:155], v[224:227], v[88:91]
    v_mfma_f32_16x16x32_bf16 v[120:123], v[152:155], v[228:231], v[120:123]
    s_waitcnt lgkmcnt(10)
    v_mfma_f32_16x16x32_bf16 v[92:95], v[156:159], v[224:227], v[92:95]
    v_mfma_f32_16x16x32_bf16 v[124:127], v[156:159], v[228:231], v[124:127]
    v_add_u32 v4, 98304, v15
    v_xor_b32 v5, 64, v4
    v_add_u32 v6, s55, v4
    v_xor_b32 v7, 64, v6
    s_barrier
    s_waitcnt lgkmcnt(7)
    v_mfma_f32_16x16x32_bf16 v[64:67], v[160:163], v[232:235], v[64:67]
    ds_read_b128 v[224:227], v6 offset:16384
    v_mfma_f32_16x16x32_bf16 v[96:99], v[160:163], v[236:239], v[96:99]
    ds_read_b128 v[228:231], v6 offset:18432
    s_waitcnt lgkmcnt(8)
    v_mfma_f32_16x16x32_bf16 v[68:71], v[164:167], v[232:235], v[68:71]
    ds_read_b128 v[128:131], v4 offset:0
    v_mfma_f32_16x16x32_bf16 v[100:103], v[164:167], v[236:239], v[100:103]
    ds_read_b128 v[132:135], v4 offset:2048
    s_waitcnt lgkmcnt(9)
    v_mfma_f32_16x16x32_bf16 v[72:75], v[168:171], v[232:235], v[72:75]
    ds_read_b128 v[136:139], v4 offset:4096
    v_mfma_f32_16x16x32_bf16 v[104:107], v[168:171], v[236:239], v[104:107]
    ds_read_b128 v[140:143], v4 offset:6144
    s_waitcnt lgkmcnt(10)
    v_mfma_f32_16x16x32_bf16 v[76:79], v[172:175], v[232:235], v[76:79]
    ds_read_b128 v[144:147], v4 offset:8192
    v_mfma_f32_16x16x32_bf16 v[108:111], v[172:175], v[236:239], v[108:111]
    ds_read_b128 v[148:151], v4 offset:10240
    s_waitcnt lgkmcnt(11)
    v_mfma_f32_16x16x32_bf16 v[80:83], v[176:179], v[232:235], v[80:83]
    ds_read_b128 v[152:155], v4 offset:12288
    v_mfma_f32_16x16x32_bf16 v[112:115], v[176:179], v[236:239], v[112:115]
    ds_read_b128 v[156:159], v4 offset:14336
    s_waitcnt lgkmcnt(12)
    v_mfma_f32_16x16x32_bf16 v[84:87], v[180:183], v[232:235], v[84:87]
    v_mfma_f32_16x16x32_bf16 v[116:119], v[180:183], v[236:239], v[116:119]
    s_waitcnt lgkmcnt(11)
    v_mfma_f32_16x16x32_bf16 v[88:91], v[184:187], v[232:235], v[88:91]
    v_mfma_f32_16x16x32_bf16 v[120:123], v[184:187], v[236:239], v[120:123]
    s_waitcnt lgkmcnt(10)
    v_mfma_f32_16x16x32_bf16 v[92:95], v[188:191], v[232:235], v[92:95]
    v_mfma_f32_16x16x32_bf16 v[124:127], v[188:191], v[236:239], v[124:127]
    s_waitcnt lgkmcnt(7)
    v_mfma_f32_16x16x32_bf16 v[64:67], v[128:131], v[224:227], v[64:67]
    ds_read_b128 v[232:235], v7 offset:16384
    v_mfma_f32_16x16x32_bf16 v[96:99], v[128:131], v[228:231], v[96:99]
    ds_read_b128 v[236:239], v7 offset:18432
    s_waitcnt lgkmcnt(8)
    v_mfma_f32_16x16x32_bf16 v[68:71], v[132:135], v[224:227], v[68:71]
    ds_read_b128 v[160:163], v5 offset:0
    v_mfma_f32_16x16x32_bf16 v[100:103], v[132:135], v[228:231], v[100:103]
    ds_read_b128 v[164:167], v5 offset:2048
    s_waitcnt lgkmcnt(9)
    v_mfma_f32_16x16x32_bf16 v[72:75], v[136:139], v[224:227], v[72:75]
    ds_read_b128 v[168:171], v5 offset:4096
    v_mfma_f32_16x16x32_bf16 v[104:107], v[136:139], v[228:231], v[104:107]
    ds_read_b128 v[172:175], v5 offset:6144
    s_waitcnt lgkmcnt(10)
    v_mfma_f32_16x16x32_bf16 v[76:79], v[140:143], v[224:227], v[76:79]
    ds_read_b128 v[176:179], v5 offset:8192
    v_mfma_f32_16x16x32_bf16 v[108:111], v[140:143], v[228:231], v[108:111]
    ds_read_b128 v[180:183], v5 offset:10240
    s_waitcnt lgkmcnt(11)
    v_mfma_f32_16x16x32_bf16 v[80:83], v[144:147], v[224:227], v[80:83]
    ds_read_b128 v[184:187], v5 offset:12288
    v_mfma_f32_16x16x32_bf16 v[112:115], v[144:147], v[228:231], v[112:115]
    ds_read_b128 v[188:191], v5 offset:14336
    s_waitcnt lgkmcnt(12)
    v_mfma_f32_16x16x32_bf16 v[84:87], v[148:151], v[224:227], v[84:87]
    v_mfma_f32_16x16x32_bf16 v[116:119], v[148:151], v[228:231], v[116:119]
    s_waitcnt lgkmcnt(11)
    v_mfma_f32_16x16x32_bf16 v[88:91], v[152:155], v[224:227], v[88:91]
    v_mfma_f32_16x16x32_bf16 v[120:123], v[152:155], v[228:231], v[120:123]
    s_waitcnt lgkmcnt(10)
    v_mfma_f32_16x16x32_bf16 v[92:95], v[156:159], v[224:227], v[92:95]
    v_mfma_f32_16x16x32_bf16 v[124:127], v[156:159], v[228:231], v[124:127]
    v_add_u32 v4, 131072, v15
    v_xor_b32 v5, 64, v4
    v_add_u32 v6, s55, v4
    v_xor_b32 v7, 64, v6
    s_barrier
    s_waitcnt lgkmcnt(7)
    v_mfma_f32_16x16x32_bf16 v[64:67], v[160:163], v[232:235], v[64:67]
    ds_read_b128 v[224:227], v6 offset:16384
    v_mfma_f32_16x16x32_bf16 v[96:99], v[160:163], v[236:239], v[96:99]
    ds_read_b128 v[228:231], v6 offset:18432
    s_waitcnt lgkmcnt(8)
    v_mfma_f32_16x16x32_bf16 v[68:71], v[164:167], v[232:235], v[68:71]
    ds_read_b128 v[128:131], v4 offset:0
    v_mfma_f32_16x16x32_bf16 v[100:103], v[164:167], v[236:239], v[100:103]
    ds_read_b128 v[132:135], v4 offset:2048
    s_waitcnt lgkmcnt(9)
    v_mfma_f32_16x16x32_bf16 v[72:75], v[168:171], v[232:235], v[72:75]
    ds_read_b128 v[136:139], v4 offset:4096
    v_mfma_f32_16x16x32_bf16 v[104:107], v[168:171], v[236:239], v[104:107]
    ds_read_b128 v[140:143], v4 offset:6144
    s_waitcnt lgkmcnt(10)
    v_mfma_f32_16x16x32_bf16 v[76:79], v[172:175], v[232:235], v[76:79]
    ds_read_b128 v[144:147], v4 offset:8192
    v_mfma_f32_16x16x32_bf16 v[108:111], v[172:175], v[236:239], v[108:111]
    ds_read_b128 v[148:151], v4 offset:10240
    s_waitcnt lgkmcnt(11)
    v_mfma_f32_16x16x32_bf16 v[80:83], v[176:179], v[232:235], v[80:83]
    ds_read_b128 v[152:155], v4 offset:12288
    v_mfma_f32_16x16x32_bf16 v[112:115], v[176:179], v[236:239], v[112:115]
    ds_read_b128 v[156:159], v4 offset:14336
    s_waitcnt lgkmcnt(12)
    v_mfma_f32_16x16x32_bf16 v[84:87], v[180:183], v[232:235], v[84:87]
    v_mfma_f32_16x16x32_bf16 v[116:119], v[180:183], v[236:239], v[116:119]
    s_waitcnt lgkmcnt(11)
    v_mfma_f32_16x16x32_bf16 v[88:91], v[184:187], v[232:235], v[88:91]
    v_mfma_f32_16x16x32_bf16 v[120:123], v[184:187], v[236:239], v[120:123]
    s_waitcnt lgkmcnt(10)
    v_mfma_f32_16x16x32_bf16 v[92:95], v[188:191], v[232:235], v[92:95]
    v_mfma_f32_16x16x32_bf16 v[124:127], v[188:191], v[236:239], v[124:127]
    s_waitcnt lgkmcnt(7)
    v_mfma_f32_16x16x32_bf16 v[64:67], v[128:131], v[224:227], v[64:67]
    ds_read_b128 v[232:235], v7 offset:16384
    v_mfma_f32_16x16x32_bf16 v[96:99], v[128:131], v[228:231], v[96:99]
    ds_read_b128 v[236:239], v7 offset:18432
    s_waitcnt lgkmcnt(8)
    v_mfma_f32_16x16x32_bf16 v[68:71], v[132:135], v[224:227], v[68:71]
    ds_read_b128 v[160:163], v5 offset:0
    v_mfma_f32_16x16x32_bf16 v[100:103], v[132:135], v[228:231], v[100:103]
    ds_read_b128 v[164:167], v5 offset:2048
    s_waitcnt lgkmcnt(9)
    v_mfma_f32_16x16x32_bf16 v[72:75], v[136:139], v[224:227], v[72:75]
    ds_read_b128 v[168:171], v5 offset:4096
    v_mfma_f32_16x16x32_bf16 v[104:107], v[136:139], v[228:231], v[104:107]
    ds_read_b128 v[172:175], v5 offset:6144
    s_waitcnt lgkmcnt(10)
    v_mfma_f32_16x16x32_bf16 v[76:79], v[140:143], v[224:227], v[76:79]
    ds_read_b128 v[176:179], v5 offset:8192
    v_mfma_f32_16x16x32_bf16 v[108:111], v[140:143], v[228:231], v[108:111]
    ds_read_b128 v[180:183], v5 offset:10240
    s_waitcnt lgkmcnt(11)
    v_mfma_f32_16x16x32_bf16 v[80:83], v[144:147], v[224:227], v[80:83]
    ds_read_b128 v[184:187], v5 offset:12288
    v_mfma_f32_16x16x32_bf16 v[112:115], v[144:147], v[228:231], v[112:115]
    ds_read_b128 v[188:191], v5 offset:14336
    s_waitcnt lgkmcnt(12)
    v_mfma_f32_16x16x32_bf16 v[84:87], v[148:151], v[224:227], v[84:87]
    v_mfma_f32_16x16x32_bf16 v[116:119], v[148:151], v[228:231], v[116:119]
    s_waitcnt lgkmcnt(11)
    v_mfma_f32_16x16x32_bf16 v[88:91], v[152:155], v[224:227], v[88:91]
    v_mfma_f32_16x16x32_bf16 v[120:123], v[152:155], v[228:231], v[120:123]
    s_waitcnt lgkmcnt(10)
    v_mfma_f32_16x16x32_bf16 v[92:95], v[156:159], v[224:227], v[92:95]
    v_mfma_f32_16x16x32_bf16 v[124:127], v[156:159], v[228:231], v[124:127]
    v_mov_b32 v4, v15
    v_xor_b32 v5, 64, v4
    v_add_u32 v6, s55, v4
    v_xor_b32 v7, 64, v6
    s_barrier
    buffer_load_dword v8, v13, s[44:47], 0 offen offset:240 sc1
    s_waitcnt lgkmcnt(7)
    v_mfma_f32_16x16x32_bf16 v[64:67], v[160:163], v[232:235], v[64:67]
    ds_read_b128 v[224:227], v6 offset:16384
    v_mfma_f32_16x16x32_bf16 v[96:99], v[160:163], v[236:239], v[96:99]
    ds_read_b128 v[228:231], v6 offset:18432
    s_waitcnt lgkmcnt(8)
    v_mfma_f32_16x16x32_bf16 v[68:71], v[164:167], v[232:235], v[68:71]
    ds_read_b128 v[128:131], v4 offset:0
    v_mfma_f32_16x16x32_bf16 v[100:103], v[164:167], v[236:239], v[100:103]
    ds_read_b128 v[132:135], v4 offset:2048
    s_waitcnt lgkmcnt(9)
    v_mfma_f32_16x16x32_bf16 v[72:75], v[168:171], v[232:235], v[72:75]
    ds_read_b128 v[136:139], v4 offset:4096
    v_mfma_f32_16x16x32_bf16 v[104:107], v[168:171], v[236:239], v[104:107]
    ds_read_b128 v[140:143], v4 offset:6144
    s_waitcnt lgkmcnt(10)
    v_mfma_f32_16x16x32_bf16 v[76:79], v[172:175], v[232:235], v[76:79]
    ds_read_b128 v[144:147], v4 offset:8192
    v_mfma_f32_16x16x32_bf16 v[108:111], v[172:175], v[236:239], v[108:111]
    ds_read_b128 v[148:151], v4 offset:10240
    s_waitcnt lgkmcnt(11)
    v_mfma_f32_16x16x32_bf16 v[80:83], v[176:179], v[232:235], v[80:83]
    ds_read_b128 v[152:155], v4 offset:12288
    v_mfma_f32_16x16x32_bf16 v[112:115], v[176:179], v[236:239], v[112:115]
    ds_read_b128 v[156:159], v4 offset:14336
    s_waitcnt lgkmcnt(12)
    v_mfma_f32_16x16x32_bf16 v[84:87], v[180:183], v[232:235], v[84:87]
    v_mfma_f32_16x16x32_bf16 v[116:119], v[180:183], v[236:239], v[116:119]
    s_waitcnt lgkmcnt(11)
    v_mfma_f32_16x16x32_bf16 v[88:91], v[184:187], v[232:235], v[88:91]
    v_mfma_f32_16x16x32_bf16 v[120:123], v[184:187], v[236:239], v[120:123]
    s_waitcnt lgkmcnt(10)
    v_mfma_f32_16x16x32_bf16 v[92:95], v[188:191], v[232:235], v[92:95]
    v_mfma_f32_16x16x32_bf16 v[124:127], v[188:191], v[236:239], v[124:127]
    s_waitcnt lgkmcnt(7)
    v_mfma_f32_16x16x32_bf16 v[64:67], v[128:131], v[224:227], v[64:67]
    ds_read_b128 v[232:235], v7 offset:16384
    v_mfma_f32_16x16x32_bf16 v[96:99], v[128:131], v[228:231], v[96:99]
    ds_read_b128 v[236:239], v7 offset:18432
    s_waitcnt lgkmcnt(8)
    v_mfma_f32_16x16x32_bf16 v[68:71], v[132:135], v[224:227], v[68:71]
    ds_read_b128 v[160:163], v5 offset:0
    v_mfma_f32_16x16x32_bf16 v[100:103], v[132:135], v[228:231], v[100:103]
    ds_read_b128 v[164:167], v5 offset:2048
    s_waitcnt lgkmcnt(9)
    v_mfma_f32_16x16x32_bf16 v[72:75], v[136:139], v[224:227], v[72:75]
    ds_read_b128 v[168:171], v5 offset:4096
    v_mfma_f32_16x16x32_bf16 v[104:107], v[136:139], v[228:231], v[104:107]
    ds_read_b128 v[172:175], v5 offset:6144
    s_waitcnt lgkmcnt(10)
    v_mfma_f32_16x16x32_bf16 v[76:79], v[140:143], v[224:227], v[76:79]
    ds_read_b128 v[176:179], v5 offset:8192
    v_mfma_f32_16x16x32_bf16 v[108:111], v[140:143], v[228:231], v[108:111]
    ds_read_b128 v[180:183], v5 offset:10240
    s_waitcnt lgkmcnt(11)
    v_mfma_f32_16x16x32_bf16 v[80:83], v[144:147], v[224:227], v[80:83]
    ds_read_b128 v[184:187], v5 offset:12288
    v_mfma_f32_16x16x32_bf16 v[112:115], v[144:147], v[228:231], v[112:115]
    ds_read_b128 v[188:191], v5 offset:14336
    s_waitcnt lgkmcnt(12)
    v_mfma_f32_16x16x32_bf16 v[84:87], v[148:151], v[224:227], v[84:87]
    v_mfma_f32_16x16x32_bf16 v[116:119], v[148:151], v[228:231], v[116:119]
    s_waitcnt lgkmcnt(11)
    v_mfma_f32_16x16x32_bf16 v[88:91], v[152:155], v[224:227], v[88:91]
    v_mfma_f32_16x16x32_bf16 v[120:123], v[152:155], v[228:231], v[120:123]
    s_waitcnt lgkmcnt(10)
    v_mfma_f32_16x16x32_bf16 v[92:95], v[156:159], v[224:227], v[92:95]
    v_mfma_f32_16x16x32_bf16 v[124:127], v[156:159], v[228:231], v[124:127]
    v_add_u32 v4, 32768, v15
    v_xor_b32 v5, 64, v4
    v_add_u32 v6, s55, v4
    v_xor_b32 v7, 64, v6
    s_barrier
    s_waitcnt lgkmcnt(7)
    v_mfma_f32_16x16x32_bf16 v[64:67], v[160:163], v[232:235], v[64:67]
    ds_read_b128 v[224:227], v6 offset:16384
    v_mfma_f32_16x16x32_bf16 v[96:99], v[160:163], v[236:239], v[96:99]
    ds_read_b128 v[228:231], v6 offset:18432
    s_waitcnt lgkmcnt(8)
    v_mfma_f32_16x16x32_bf16 v[68:71], v[164:167], v[232:235], v[68:71]
    ds_read_b128 v[128:131], v4 offset:0
    v_mfma_f32_16x16x32_bf16 v[100:103], v[164:167], v[236:239], v[100:103]
    ds_read_b128 v[132:135], v4 offset:2048
    s_waitcnt lgkmcnt(9)
    v_mfma_f32_16x16x32_bf16 v[72:75], v[168:171], v[232:235], v[72:75]
    ds_read_b128 v[136:139], v4 offset:4096
    v_mfma_f32_16x16x32_bf16 v[104:107], v[168:171], v[236:239], v[104:107]
    ds_read_b128 v[140:143], v4 offset:6144
    s_waitcnt lgkmcnt(10)
    v_mfma_f32_16x16x32_bf16 v[76:79], v[172:175], v[232:235], v[76:79]
    ds_read_b128 v[144:147], v4 offset:8192
    v_mfma_f32_16x16x32_bf16 v[108:111], v[172:175], v[236:239], v[108:111]
    ds_read_b128 v[148:151], v4 offset:10240
    s_waitcnt lgkmcnt(11)
    v_mfma_f32_16x16x32_bf16 v[80:83], v[176:179], v[232:235], v[80:83]
    ds_read_b128 v[152:155], v4 offset:12288
    v_mfma_f32_16x16x32_bf16 v[112:115], v[176:179], v[236:239], v[112:115]
    ds_read_b128 v[156:159], v4 offset:14336
    s_waitcnt lgkmcnt(12)
    v_mfma_f32_16x16x32_bf16 v[84:87], v[180:183], v[232:235], v[84:87]
    v_mfma_f32_16x16x32_bf16 v[116:119], v[180:183], v[236:239], v[116:119]
    s_waitcnt lgkmcnt(11)
    v_mfma_f32_16x16x32_bf16 v[88:91], v[184:187], v[232:235], v[88:91]
    v_mfma_f32_16x16x32_bf16 v[120:123], v[184:187], v[236:239], v[120:123]
    s_waitcnt lgkmcnt(10)
    v_mfma_f32_16x16x32_bf16 v[92:95], v[188:191], v[232:235], v[92:95]
    v_mfma_f32_16x16x32_bf16 v[124:127], v[188:191], v[236:239], v[124:127]
    s_waitcnt lgkmcnt(7)
    v_mfma_f32_16x16x32_bf16 v[64:67], v[128:131], v[224:227], v[64:67]
    ds_read_b128 v[232:235], v7 offset:16384
    v_mfma_f32_16x16x32_bf16 v[96:99], v[128:131], v[228:231], v[96:99]
    ds_read_b128 v[236:239], v7 offset:18432
    s_waitcnt lgkmcnt(8)
    v_mfma_f32_16x16x32_bf16 v[68:71], v[132:135], v[224:227], v[68:71]
    ds_read_b128 v[160:163], v5 offset:0
    v_mfma_f32_16x16x32_bf16 v[100:103], v[132:135], v[228:231], v[100:103]
    ds_read_b128 v[164:167], v5 offset:2048
    s_waitcnt lgkmcnt(9)
    v_mfma_f32_16x16x32_bf16 v[72:75], v[136:139], v[224:227], v[72:75]
    ds_read_b128 v[168:171], v5 offset:4096
    v_mfma_f32_16x16x32_bf16 v[104:107], v[136:139], v[228:231], v[104:107]
    ds_read_b128 v[172:175], v5 offset:6144
    s_waitcnt lgkmcnt(10)
    v_mfma_f32_16x16x32_bf16 v[76:79], v[140:143], v[224:227], v[76:79]
    ds_read_b128 v[176:179], v5 offset:8192
    v_mfma_f32_16x16x32_bf16 v[108:111], v[140:143], v[228:231], v[108:111]
    ds_read_b128 v[180:183], v5 offset:10240
    s_waitcnt lgkmcnt(11)
    v_mfma_f32_16x16x32_bf16 v[80:83], v[144:147], v[224:227], v[80:83]
    ds_read_b128 v[184:187], v5 offset:12288
    v_mfma_f32_16x16x32_bf16 v[112:115], v[144:147], v[228:231], v[112:115]
    ds_read_b128 v[188:191], v5 offset:14336
    s_waitcnt lgkmcnt(12)
    v_mfma_f32_16x16x32_bf16 v[84:87], v[148:151], v[224:227], v[84:87]
    v_mfma_f32_16x16x32_bf16 v[116:119], v[148:151], v[228:231], v[116:119]
    s_waitcnt lgkmcnt(11)
    v_mfma_f32_16x16x32_bf16 v[88:91], v[152:155], v[224:227], v[88:91]
    v_mfma_f32_16x16x32_bf16 v[120:123], v[152:155], v[228:231], v[120:123]
    s_waitcnt lgkmcnt(10)
    v_mfma_f32_16x16x32_bf16 v[92:95], v[156:159], v[224:227], v[92:95]
    v_mfma_f32_16x16x32_bf16 v[124:127], v[156:159], v[228:231], v[124:127]
    v_add_u32 v4, 65536, v15
    v_xor_b32 v5, 64, v4
    v_add_u32 v6, s55, v4
    v_xor_b32 v7, 64, v6
    s_barrier
    s_waitcnt vmcnt(0)
    v_cmp_eq_u32 vcc, 0, v8
    v_mov_b32 v9, s56
    s_cmp_eq_u64 vcc, 0
    s_cselect_b64 s[60:61], -1, 0
    v_cndmask_b32 v240, v242, v240, s[60:61]
    buffer_store_dword v9, v240, s[24:27], 0 offen offset:16 sc1
    s_waitcnt lgkmcnt(7)
    v_mfma_f32_16x16x32_bf16 v[64:67], v[160:163], v[232:235], v[64:67]
    ds_read_b128 v[224:227], v6 offset:16384
    v_mfma_f32_16x16x32_bf16 v[96:99], v[160:163], v[236:239], v[96:99]
    ds_read_b128 v[228:231], v6 offset:18432
    s_waitcnt lgkmcnt(8)
    v_mfma_f32_16x16x32_bf16 v[68:71], v[164:167], v[232:235], v[68:71]
    ds_read_b128 v[128:131], v4 offset:0
    v_mfma_f32_16x16x32_bf16 v[100:103], v[164:167], v[236:239], v[100:103]
    ds_read_b128 v[132:135], v4 offset:2048
    s_waitcnt lgkmcnt(9)
    v_mfma_f32_16x16x32_bf16 v[72:75], v[168:171], v[232:235], v[72:75]
    ds_read_b128 v[136:139], v4 offset:4096
    v_mfma_f32_16x16x32_bf16 v[104:107], v[168:171], v[236:239], v[104:107]
    ds_read_b128 v[140:143], v4 offset:6144
    s_waitcnt lgkmcnt(10)
    v_mfma_f32_16x16x32_bf16 v[76:79], v[172:175], v[232:235], v[76:79]
    ds_read_b128 v[144:147], v4 offset:8192
    v_mfma_f32_16x16x32_bf16 v[108:111], v[172:175], v[236:239], v[108:111]
    ds_read_b128 v[148:151], v4 offset:10240
    s_waitcnt lgkmcnt(11)
    v_mfma_f32_16x16x32_bf16 v[80:83], v[176:179], v[232:235], v[80:83]
    ds_read_b128 v[152:155], v4 offset:12288
    v_mfma_f32_16x16x32_bf16 v[112:115], v[176:179], v[236:239], v[112:115]
    ds_read_b128 v[156:159], v4 offset:14336
    s_waitcnt lgkmcnt(12)
    v_mfma_f32_16x16x32_bf16 v[84:87], v[180:183], v[232:235], v[84:87]
    v_mfma_f32_16x16x32_bf16 v[116:119], v[180:183], v[236:239], v[116:119]
    s_waitcnt lgkmcnt(11)
    v_mfma_f32_16x16x32_bf16 v[88:91], v[184:187], v[232:235], v[88:91]
    v_mfma_f32_16x16x32_bf16 v[120:123], v[184:187], v[236:239], v[120:123]
    s_waitcnt lgkmcnt(10)
    v_mfma_f32_16x16x32_bf16 v[92:95], v[188:191], v[232:235], v[92:95]
    v_mfma_f32_16x16x32_bf16 v[124:127], v[188:191], v[236:239], v[124:127]
    s_waitcnt lgkmcnt(7)
    v_mfma_f32_16x16x32_bf16 v[64:67], v[128:131], v[224:227], v[64:67]
    ds_read_b128 v[232:235], v7 offset:16384
    v_mfma_f32_16x16x32_bf16 v[96:99], v[128:131], v[228:231], v[96:99]
    ds_read_b128 v[236:239], v7 offset:18432
    s_waitcnt lgkmcnt(8)
    v_mfma_f32_16x16x32_bf16 v[68:71], v[132:135], v[224:227], v[68:71]
    ds_read_b128 v[160:163], v5 offset:0
    v_mfma_f32_16x16x32_bf16 v[100:103], v[132:135], v[228:231], v[100:103]
    ds_read_b128 v[164:167], v5 offset:2048
    s_waitcnt lgkmcnt(9)
    v_mfma_f32_16x16x32_bf16 v[72:75], v[136:139], v[224:227], v[72:75]
    ds_read_b128 v[168:171], v5 offset:4096
    v_mfma_f32_16x16x32_bf16 v[104:107], v[136:139], v[228:231], v[104:107]
    ds_read_b128 v[172:175], v5 offset:6144
    s_waitcnt lgkmcnt(10)
    v_mfma_f32_16x16x32_bf16 v[76:79], v[140:143], v[224:227], v[76:79]
    ds_read_b128 v[176:179], v5 offset:8192
    v_mfma_f32_16x16x32_bf16 v[108:111], v[140:143], v[228:231], v[108:111]
    ds_read_b128 v[180:183], v5 offset:10240
    s_waitcnt lgkmcnt(11)
    v_mfma_f32_16x16x32_bf16 v[80:83], v[144:147], v[224:227], v[80:83]
    ds_read_b128 v[184:187], v5 offset:12288
    v_mfma_f32_16x16x32_bf16 v[112:115], v[144:147], v[228:231], v[112:115]
    ds_read_b128 v[188:191], v5 offset:14336
    s_waitcnt lgkmcnt(12)
    v_mfma_f32_16x16x32_bf16 v[84:87], v[148:151], v[224:227], v[84:87]
    v_mfma_f32_16x16x32_bf16 v[116:119], v[148:151], v[228:231], v[116:119]
    s_waitcnt lgkmcnt(11)
    v_mfma_f32_16x16x32_bf16 v[88:91], v[152:155], v[224:227], v[88:91]
    v_mfma_f32_16x16x32_bf16 v[120:123], v[152:155], v[228:231], v[120:123]
    s_waitcnt lgkmcnt(10)
    v_mfma_f32_16x16x32_bf16 v[92:95], v[156:159], v[224:227], v[92:95]
    v_mfma_f32_16x16x32_bf16 v[124:127], v[156:159], v[228:231], v[124:127]
    v_add_u32 v4, 98304, v15
    v_xor_b32 v5, 64, v4
    v_add_u32 v6, s55, v4
    v_xor_b32 v7, 64, v6
    s_barrier
    s_waitcnt lgkmcnt(7)
    v_mfma_f32_16x16x32_bf16 v[64:67], v[160:163], v[232:235], v[64:67]
    ds_read_b128 v[224:227], v6 offset:16384
    v_mfma_f32_16x16x32_bf16 v[96:99], v[160:163], v[236:239], v[96:99]
    ds_read_b128 v[228:231], v6 offset:18432
    s_waitcnt lgkmcnt(8)
    v_mfma_f32_16x16x32_bf16 v[68:71], v[164:167], v[232:235], v[68:71]
    ds_read_b128 v[128:131], v4 offset:0
    v_mfma_f32_16x16x32_bf16 v[100:103], v[164:167], v[236:239], v[100:103]
    ds_read_b128 v[132:135], v4 offset:2048
    s_waitcnt lgkmcnt(9)
    v_mfma_f32_16x16x32_bf16 v[72:75], v[168:171], v[232:235], v[72:75]
    ds_read_b128 v[136:139], v4 offset:4096
    v_mfma_f32_16x16x32_bf16 v[104:107], v[168:171], v[236:239], v[104:107]
    ds_read_b128 v[140:143], v4 offset:6144
    s_waitcnt lgkmcnt(10)
    v_mfma_f32_16x16x32_bf16 v[76:79], v[172:175], v[232:235], v[76:79]
    ds_read_b128 v[144:147], v4 offset:8192
    v_mfma_f32_16x16x32_bf16 v[108:111], v[172:175], v[236:239], v[108:111]
    ds_read_b128 v[148:151], v4 offset:10240
    s_waitcnt lgkmcnt(11)
    v_mfma_f32_16x16x32_bf16 v[80:83], v[176:179], v[232:235], v[80:83]
    ds_read_b128 v[152:155], v4 offset:12288
    v_mfma_f32_16x16x32_bf16 v[112:115], v[176:179], v[236:239], v[112:115]
    ds_read_b128 v[156:159], v4 offset:14336
    s_waitcnt lgkmcnt(12)
    v_mfma_f32_16x16x32_bf16 v[84:87], v[180:183], v[232:235], v[84:87]
    v_mfma_f32_16x16x32_bf16 v[116:119], v[180:183], v[236:239], v[116:119]
    s_waitcnt lgkmcnt(11)
    v_mfma_f32_16x16x32_bf16 v[88:91], v[184:187], v[232:235], v[88:91]
    v_mfma_f32_16x16x32_bf16 v[120:123], v[184:187], v[236:239], v[120:123]
    s_waitcnt lgkmcnt(10)
    v_mfma_f32_16x16x32_bf16 v[92:95], v[188:191], v[232:235], v[92:95]
    v_mfma_f32_16x16x32_bf16 v[124:127], v[188:191], v[236:239], v[124:127]
    s_waitcnt lgkmcnt(7)
    v_mfma_f32_16x16x32_bf16 v[64:67], v[128:131], v[224:227], v[64:67]
    ds_read_b128 v[232:235], v7 offset:16384
    v_mfma_f32_16x16x32_bf16 v[96:99], v[128:131], v[228:231], v[96:99]
    ds_read_b128 v[236:239], v7 offset:18432
    s_waitcnt lgkmcnt(8)
    v_mfma_f32_16x16x32_bf16 v[68:71], v[132:135], v[224:227], v[68:71]
    ds_read_b128 v[160:163], v5 offset:0
    v_mfma_f32_16x16x32_bf16 v[100:103], v[132:135], v[228:231], v[100:103]
    ds_read_b128 v[164:167], v5 offset:2048
    s_waitcnt lgkmcnt(9)
    v_mfma_f32_16x16x32_bf16 v[72:75], v[136:139], v[224:227], v[72:75]
    ds_read_b128 v[168:171], v5 offset:4096
    v_mfma_f32_16x16x32_bf16 v[104:107], v[136:139], v[228:231], v[104:107]
    ds_read_b128 v[172:175], v5 offset:6144
    s_waitcnt lgkmcnt(10)
    v_mfma_f32_16x16x32_bf16 v[76:79], v[140:143], v[224:227], v[76:79]
    ds_read_b128 v[176:179], v5 offset:8192
    v_mfma_f32_16x16x32_bf16 v[108:111], v[140:143], v[228:231], v[108:111]
    ds_read_b128 v[180:183], v5 offset:10240
    s_waitcnt lgkmcnt(11)
    v_mfma_f32_16x16x32_bf16 v[80:83], v[144:147], v[224:227], v[80:83]
    ds_read_b128 v[184:187], v5 offset:12288
    v_mfma_f32_16x16x32_bf16 v[112:115], v[144:147], v[228:231], v[112:115]
    ds_read_b128 v[188:191], v5 offset:14336
    s_waitcnt lgkmcnt(12)
    v_mfma_f32_16x16x32_bf16 v[84:87], v[148:151], v[224:227], v[84:87]
    v_mfma_f32_16x16x32_bf16 v[116:119], v[148:151], v[228:231], v[116:119]
    s_waitcnt lgkmcnt(11)
    v_mfma_f32_16x16x32_bf16 v[88:91], v[152:155], v[224:227], v[88:91]
    v_mfma_f32_16x16x32_bf16 v[120:123], v[152:155], v[228:231], v[120:123]
    s_waitcnt lgkmcnt(10)
    v_mfma_f32_16x16x32_bf16 v[92:95], v[156:159], v[224:227], v[92:95]
    v_mfma_f32_16x16x32_bf16 v[124:127], v[156:159], v[228:231], v[124:127]
    s_waitcnt lgkmcnt(0)
    s_barrier
    v_mfma_f32_16x16x32_bf16 v[64:67], v[160:163], v[232:235], v[64:67]
    v_mfma_f32_16x16x32_bf16 v[96:99], v[160:163], v[236:239], v[96:99]
    v_mfma_f32_16x16x32_bf16 v[68:71], v[164:167], v[232:235], v[68:71]
    v_mfma_f32_16x16x32_bf16 v[100:103], v[164:167], v[236:239], v[100:103]
    v_mfma_f32_16x16x32_bf16 v[72:75], v[168:171], v[232:235], v[72:75]
    v_mfma_f32_16x16x32_bf16 v[104:107], v[168:171], v[236:239], v[104:107]
    v_mfma_f32_16x16x32_bf16 v[76:79], v[172:175], v[232:235], v[76:79]
    v_mfma_f32_16x16x32_bf16 v[108:111], v[172:175], v[236:239], v[108:111]
    v_mfma_f32_16x16x32_bf16 v[80:83], v[176:179], v[232:235], v[80:83]
    v_mfma_f32_16x16x32_bf16 v[112:115], v[176:179], v[236:239], v[112:115]
    v_mfma_f32_16x16x32_bf16 v[84:87], v[180:183], v[232:235], v[84:87]
    v_mfma_f32_16x16x32_bf16 v[116:119], v[180:183], v[236:239], v[116:119]
    v_mfma_f32_16x16x32_bf16 v[88:91], v[184:187], v[232:235], v[88:91]
    v_mfma_f32_16x16x32_bf16 v[120:123], v[184:187], v[236:239], v[120:123]
    v_mfma_f32_16x16x32_bf16 v[92:95], v[188:191], v[232:235], v[92:95]
    v_mfma_f32_16x16x32_bf16 v[124:127], v[188:191], v[236:239], v[124:127]
.p2align 3
    v_pk_fma_f32 v[66:67], v[64:65], v[16:17], v[66:67] op_sel:[0,0,0] op_sel_hi:[1,0,1]
    v_pk_fma_f32 v[98:99], v[96:97], v[16:17], v[98:99] op_sel:[0,0,0] op_sel_hi:[1,0,1]
    v_pk_fma_f32 v[66:67], v[96:97], v[16:17], v[66:67] op_sel:[0,1,0] op_sel_hi:[1,1,1] neg_lo:[0,1,0] neg_hi:[0,1,0]
    v_pk_fma_f32 v[98:99], v[64:65], v[16:17], v[98:99] op_sel:[0,1,0] op_sel_hi:[1,1,1]
    v_pk_fma_f32 v[68:69], v[66:67], v[16:17], v[68:69] op_sel:[0,0,0] op_sel_hi:[1,0,1]
    v_pk_fma_f32 v[100:101], v[98:99], v[16:17], v[100:101] op_sel:[0,0,0] op_sel_hi:[1,0,1]
    v_pk_fma_f32 v[68:69], v[98:99], v[16:17], v[68:69] op_sel:[0,1,0] op_sel_hi:[1,1,1] neg_lo:[0,1,0] neg_hi:[0,1,0]
    v_pk_fma_f32 v[100:101], v[66:67], v[16:17], v[100:101] op_sel:[0,1,0] op_sel_hi:[1,1,1]
    v_pk_fma_f32 v[70:71], v[68:69], v[16:17], v[70:71] op_sel:[0,0,0] op_sel_hi:[1,0,1]
    v_pk_fma_f32 v[102:103], v[100:101], v[16:17], v[102:103] op_sel:[0,0,0] op_sel_hi:[1,0,1]
    v_pk_fma_f32 v[70:71], v[100:101], v[16:17], v[70:71] op_sel:[0,1,0] op_sel_hi:[1,1,1] neg_lo:[0,1,0] neg_hi:[0,1,0]
    v_pk_fma_f32 v[102:103], v[68:69], v[16:17], v[102:103] op_sel:[0,1,0] op_sel_hi:[1,1,1]
    v_pk_fma_f32 v[72:73], v[70:71], v[16:17], v[72:73] op_sel:[0,0,0] op_sel_hi:[1,0,1]
    v_pk_fma_f32 v[104:105], v[102:103], v[16:17], v[104:105] op_sel:[0,0,0] op_sel_hi:[1,0,1]
    v_pk_fma_f32 v[72:73], v[102:103], v[16:17], v[72:73] op_sel:[0,1,0] op_sel_hi:[1,1,1] neg_lo:[0,1,0] neg_hi:[0,1,0]
    v_pk_fma_f32 v[104:105], v[70:71], v[16:17], v[104:105] op_sel:[0,1,0] op_sel_hi:[1,1,1]
    v_pk_fma_f32 v[74:75], v[72:73], v[16:17], v[74:75] op_sel:[0,0,0] op_sel_hi:[1,0,1]
    v_pk_fma_f32 v[106:107], v[104:105], v[16:17], v[106:107] op_sel:[0,0,0] op_sel_hi:[1,0,1]
    v_pk_fma_f32 v[74:75], v[104:105], v[16:17], v[74:75] op_sel:[0,1,0] op_sel_hi:[1,1,1] neg_lo:[0,1,0] neg_hi:[0,1,0]
    v_pk_fma_f32 v[106:107], v[72:73], v[16:17], v[106:107] op_sel:[0,1,0] op_sel_hi:[1,1,1]
    v_pk_fma_f32 v[76:77], v[74:75], v[16:17], v[76:77] op_sel:[0,0,0] op_sel_hi:[1,0,1]
    v_pk_fma_f32 v[108:109], v[106:107], v[16:17], v[108:109] op_sel:[0,0,0] op_sel_hi:[1,0,1]
    v_pk_fma_f32 v[76:77], v[106:107], v[16:17], v[76:77] op_sel:[0,1,0] op_sel_hi:[1,1,1] neg_lo:[0,1,0] neg_hi:[0,1,0]
    v_pk_fma_f32 v[108:109], v[74:75], v[16:17], v[108:109] op_sel:[0,1,0] op_sel_hi:[1,1,1]
    v_pk_fma_f32 v[78:79], v[76:77], v[16:17], v[78:79] op_sel:[0,0,0] op_sel_hi:[1,0,1]
    v_pk_fma_f32 v[110:111], v[108:109], v[16:17], v[110:111] op_sel:[0,0,0] op_sel_hi:[1,0,1]
    v_pk_fma_f32 v[78:79], v[108:109], v[16:17], v[78:79] op_sel:[0,1,0] op_sel_hi:[1,1,1] neg_lo:[0,1,0] neg_hi:[0,1,0]
    v_pk_fma_f32 v[110:111], v[76:77], v[16:17], v[110:111] op_sel:[0,1,0] op_sel_hi:[1,1,1]
    v_pk_fma_f32 v[80:81], v[78:79], v[16:17], v[80:81] op_sel:[0,0,0] op_sel_hi:[1,0,1]
    v_pk_fma_f32 v[112:113], v[110:111], v[16:17], v[112:113] op_sel:[0,0,0] op_sel_hi:[1,0,1]
    v_pk_fma_f32 v[80:81], v[110:111], v[16:17], v[80:81] op_sel:[0,1,0] op_sel_hi:[1,1,1] neg_lo:[0,1,0] neg_hi:[0,1,0]
    v_pk_fma_f32 v[112:113], v[78:79], v[16:17], v[112:113] op_sel:[0,1,0] op_sel_hi:[1,1,1]
    v_pk_fma_f32 v[82:83], v[80:81], v[16:17], v[82:83] op_sel:[0,0,0] op_sel_hi:[1,0,1]
    v_pk_fma_f32 v[114:115], v[112:113], v[16:17], v[114:115] op_sel:[0,0,0] op_sel_hi:[1,0,1]
    v_pk_fma_f32 v[82:83], v[112:113], v[16:17], v[82:83] op_sel:[0,1,0] op_sel_hi:[1,1,1] neg_lo:[0,1,0] neg_hi:[0,1,0]
    v_pk_fma_f32 v[114:115], v[80:81], v[16:17], v[114:115] op_sel:[0,1,0] op_sel_hi:[1,1,1]
    v_pk_fma_f32 v[84:85], v[82:83], v[16:17], v[84:85] op_sel:[0,0,0] op_sel_hi:[1,0,1]
    v_pk_fma_f32 v[116:117], v[114:115], v[16:17], v[116:117] op_sel:[0,0,0] op_sel_hi:[1,0,1]
    v_pk_fma_f32 v[84:85], v[114:115], v[16:17], v[84:85] op_sel:[0,1,0] op_sel_hi:[1,1,1] neg_lo:[0,1,0] neg_hi:[0,1,0]
    v_pk_fma_f32 v[116:117], v[82:83], v[16:17], v[116:117] op_sel:[0,1,0] op_sel_hi:[1,1,1]
    v_pk_fma_f32 v[86:87], v[84:85], v[16:17], v[86:87] op_sel:[0,0,0] op_sel_hi:[1,0,1]
    v_pk_fma_f32 v[118:119], v[116:117], v[16:17], v[118:119] op_sel:[0,0,0] op_sel_hi:[1,0,1]
    v_pk_fma_f32 v[86:87], v[116:117], v[16:17], v[86:87] op_sel:[0,1,0] op_sel_hi:[1,1,1] neg_lo:[0,1,0] neg_hi:[0,1,0]
    v_pk_fma_f32 v[118:119], v[84:85], v[16:17], v[118:119] op_sel:[0,1,0] op_sel_hi:[1,1,1]
    v_pk_fma_f32 v[88:89], v[86:87], v[16:17], v[88:89] op_sel:[0,0,0] op_sel_hi:[1,0,1]
    v_pk_fma_f32 v[120:121], v[118:119], v[16:17], v[120:121] op_sel:[0,0,0] op_sel_hi:[1,0,1]
    v_pk_fma_f32 v[88:89], v[118:119], v[16:17], v[88:89] op_sel:[0,1,0] op_sel_hi:[1,1,1] neg_lo:[0,1,0] neg_hi:[0,1,0]
    v_pk_fma_f32 v[120:121], v[86:87], v[16:17], v[120:121] op_sel:[0,1,0] op_sel_hi:[1,1,1]
    v_pk_fma_f32 v[90:91], v[88:89], v[16:17], v[90:91] op_sel:[0,0,0] op_sel_hi:[1,0,1]
    v_pk_fma_f32 v[122:123], v[120:121], v[16:17], v[122:123] op_sel:[0,0,0] op_sel_hi:[1,0,1]
    v_pk_fma_f32 v[90:91], v[120:121], v[16:17], v[90:91] op_sel:[0,1,0] op_sel_hi:[1,1,1] neg_lo:[0,1,0] neg_hi:[0,1,0]
    v_pk_fma_f32 v[122:123], v[88:89], v[16:17], v[122:123] op_sel:[0,1,0] op_sel_hi:[1,1,1]
    v_pk_fma_f32 v[92:93], v[90:91], v[16:17], v[92:93] op_sel:[0,0,0] op_sel_hi:[1,0,1]
    v_pk_fma_f32 v[124:125], v[122:123], v[16:17], v[124:125] op_sel:[0,0,0] op_sel_hi:[1,0,1]
    v_pk_fma_f32 v[92:93], v[122:123], v[16:17], v[92:93] op_sel:[0,1,0] op_sel_hi:[1,1,1] neg_lo:[0,1,0] neg_hi:[0,1,0]
    v_pk_fma_f32 v[124:125], v[90:91], v[16:17], v[124:125] op_sel:[0,1,0] op_sel_hi:[1,1,1]
    v_pk_fma_f32 v[94:95], v[92:93], v[16:17], v[94:95] op_sel:[0,0,0] op_sel_hi:[1,0,1]
    v_pk_fma_f32 v[126:127], v[124:125], v[16:17], v[126:127] op_sel:[0,0,0] op_sel_hi:[1,0,1]
    v_pk_fma_f32 v[94:95], v[124:125], v[16:17], v[94:95] op_sel:[0,1,0] op_sel_hi:[1,1,1] neg_lo:[0,1,0] neg_hi:[0,1,0]
    v_pk_fma_f32 v[126:127], v[92:93], v[16:17], v[126:127] op_sel:[0,1,0] op_sel_hi:[1,1,1]
    v_mov_b32 v42, 0
    v_mov_b32 v43, 0
    v_mov_b32 v48, 0
    v_mov_b32 v49, 0
    v_fma_f32 v40, v18, v94, v95
    v_fma_f32 v41, v18, v126, v127
    v_fma_f32 v40, -v19, v126, v40
    v_fma_f32 v41, v19, v94, v41
    v_mov_b32 v44, v40
    v_mov_b32 v45, v41
    s_nop 0
    v_permlane16_swap_b32 v42, v44
    v_permlane16_swap_b32 v43, v45
    v_fma_f32 v46, v20, v42, v40
    v_fma_f32 v47, v20, v43, v41
    v_fma_f32 v46, -v21, v43, v46
    v_fma_f32 v47, v21, v42, v47
    v_mov_b32 v44, v46
    v_mov_b32 v45, v47
    s_nop 0
    v_permlane16_swap_b32 v44, v46
    v_permlane16_swap_b32 v45, v47
    s_nop 0
    v_permlane32_swap_b32 v48, v46
    v_permlane32_swap_b32 v49, v47
    v_fma_f32 v50, v22, v48, v46
    v_fma_f32 v51, v22, v49, v47
    v_fma_f32 v50, -v23, v49, v50
    v_fma_f32 v51, v23, v48, v51
    v_and_b32 v50, -2, v50
    v_and_b32 v51, -2, v51
ac_clr:
    v_cmp_eq_u32 vcc, 0, v8
    s_nop 0
    s_cmp_eq_u64 vcc, 0
    s_cbranch_scc1 ac_clr_ok
    s_sleep 2
    buffer_load_dword v8, v13, s[44:47], 0 offen offset:240 sc1
    s_waitcnt vmcnt(0)
    s_branch ac_clr
ac_clr_ok:
    buffer_store_dwordx2 v[50:51], v10, s[40:43], 0 offen sc1
.p2align 3
    v_fma_f32 v52, v28, v48, v42
    v_fma_f32 v54, v28, v49, v43
    v_fma_f32 v52, -v29, v49, v52
    v_fma_f32 v54, v29, v48, v54
    v_fma_f32 v53, v18, v52, v94
    v_fma_f32 v55, v18, v54, v126
    v_fma_f32 v53, -v19, v54, v53
    v_fma_f32 v55, v19, v52, v55
    v_pk_mul_f32 v[128:129], v[64:65], v[38:39] op_sel:[0,0] op_sel_hi:[1,0]
    v_pk_fma_f32 v[128:129], v[96:97], v[38:39], v[128:129] op_sel:[0,1,0] op_sel_hi:[1,1,1] neg_lo:[0,1,0] neg_hi:[0,1,0]
    v_pk_mul_f32 v[96:97], v[96:97], v[38:39] op_sel:[0,0] op_sel_hi:[1,0] neg_lo:[0,1] neg_hi:[0,1]
    v_pk_fma_f32 v[96:97], v[64:65], v[38:39], v[96:97] op_sel:[0,1,0] op_sel_hi:[1,1,1] neg_lo:[0,1,0] neg_hi:[0,1,0]
    v_pk_mul_f32 v[130:131], v[66:67], v[38:39] op_sel:[0,0] op_sel_hi:[1,0]
    v_pk_fma_f32 v[130:131], v[98:99], v[38:39], v[130:131] op_sel:[0,1,0] op_sel_hi:[1,1,1] neg_lo:[0,1,0] neg_hi:[0,1,0]
    v_pk_mul_f32 v[98:99], v[98:99], v[38:39] op_sel:[0,0] op_sel_hi:[1,0] neg_lo:[0,1] neg_hi:[0,1]
    v_pk_fma_f32 v[98:99], v[66:67], v[38:39], v[98:99] op_sel:[0,1,0] op_sel_hi:[1,1,1] neg_lo:[0,1,0] neg_hi:[0,1,0]
    v_pk_mul_f32 v[132:133], v[68:69], v[38:39] op_sel:[0,0] op_sel_hi:[1,0]
    v_pk_fma_f32 v[132:133], v[100:101], v[38:39], v[132:133] op_sel:[0,1,0] op_sel_hi:[1,1,1] neg_lo:[0,1,0] neg_hi:[0,1,0]
    v_pk_mul_f32 v[100:101], v[100:101], v[38:39] op_sel:[0,0] op_sel_hi:[1,0] neg_lo:[0,1] neg_hi:[0,1]
    v_pk_fma_f32 v[100:101], v[68:69], v[38:39], v[100:101] op_sel:[0,1,0] op_sel_hi:[1,1,1] neg_lo:[0,1,0] neg_hi:[0,1,0]
    v_pk_mul_f32 v[134:135], v[70:71], v[38:39] op_sel:[0,0] op_sel_hi:[1,0]
    v_pk_fma_f32 v[134:135], v[102:103], v[38:39], v[134:135] op_sel:[0,1,0] op_sel_hi:[1,1,1] neg_lo:[0,1,0] neg_hi:[0,1,0]
    v_pk_mul_f32 v[102:103], v[102:103], v[38:39] op_sel:[0,0] op_sel_hi:[1,0] neg_lo:[0,1] neg_hi:[0,1]
    v_pk_fma_f32 v[102:103], v[70:71], v[38:39], v[102:103] op_sel:[0,1,0] op_sel_hi:[1,1,1] neg_lo:[0,1,0] neg_hi:[0,1,0]
    v_pk_mul_f32 v[136:137], v[72:73], v[38:39] op_sel:[0,0] op_sel_hi:[1,0]
    v_pk_fma_f32 v[136:137], v[104:105], v[38:39], v[136:137] op_sel:[0,1,0] op_sel_hi:[1,1,1] neg_lo:[0,1,0] neg_hi:[0,1,0]
    v_pk_mul_f32 v[104:105], v[104:105], v[38:39] op_sel:[0,0] op_sel_hi:[1,0] neg_lo:[0,1] neg_hi:[0,1]
    v_pk_fma_f32 v[104:105], v[72:73], v[38:39], v[104:105] op_sel:[0,1,0] op_sel_hi:[1,1,1] neg_lo:[0,1,0] neg_hi:[0,1,0]
    v_pk_mul_f32 v[138:139], v[74:75], v[38:39] op_sel:[0,0] op_sel_hi:[1,0]
    v_pk_fma_f32 v[138:139], v[106:107], v[38:39], v[138:139] op_sel:[0,1,0] op_sel_hi:[1,1,1] neg_lo:[0,1,0] neg_hi:[0,1,0]
    v_pk_mul_f32 v[106:107], v[106:107], v[38:39] op_sel:[0,0] op_sel_hi:[1,0] neg_lo:[0,1] neg_hi:[0,1]
    v_pk_fma_f32 v[106:107], v[74:75], v[38:39], v[106:107] op_sel:[0,1,0] op_sel_hi:[1,1,1] neg_lo:[0,1,0] neg_hi:[0,1,0]
    v_pk_mul_f32 v[140:141], v[76:77], v[38:39] op_sel:[0,0] op_sel_hi:[1,0]
    v_pk_fma_f32 v[140:141], v[108:109], v[38:39], v[140:141] op_sel:[0,1,0] op_sel_hi:[1,1,1] neg_lo:[0,1,0] neg_hi:[0,1,0]
    v_pk_mul_f32 v[108:109], v[108:109], v[38:39] op_sel:[0,0] op_sel_hi:[1,0] neg_lo:[0,1] neg_hi:[0,1]
    v_pk_fma_f32 v[108:109], v[76:77], v[38:39], v[108:109] op_sel:[0,1,0] op_sel_hi:[1,1,1] neg_lo:[0,1,0] neg_hi:[0,1,0]
    v_pk_mul_f32 v[142:143], v[78:79], v[38:39] op_sel:[0,0] op_sel_hi:[1,0]
    v_pk_fma_f32 v[142:143], v[110:111], v[38:39], v[142:143] op_sel:[0,1,0] op_sel_hi:[1,1,1] neg_lo:[0,1,0] neg_hi:[0,1,0]
    v_pk_mul_f32 v[110:111], v[110:111], v[38:39] op_sel:[0,0] op_sel_hi:[1,0] neg_lo:[0,1] neg_hi:[0,1]
    v_pk_fma_f32 v[110:111], v[78:79], v[38:39], v[110:111] op_sel:[0,1,0] op_sel_hi:[1,1,1] neg_lo:[0,1,0] neg_hi:[0,1,0]
    v_pk_mul_f32 v[144:145], v[80:81], v[38:39] op_sel:[0,0] op_sel_hi:[1,0]
    v_pk_fma_f32 v[144:145], v[112:113], v[38:39], v[144:145] op_sel:[0,1,0] op_sel_hi:[1,1,1] neg_lo:[0,1,0] neg_hi:[0,1,0]
    v_pk_mul_f32 v[112:113], v[112:113], v[38:39] op_sel:[0,0] op_sel_hi:[1,0] neg_lo:[0,1] neg_hi:[0,1]
    v_pk_fma_f32 v[112:113], v[80:81], v[38:39], v[112:113] op_sel:[0,1,0] op_sel_hi:[1,1,1] neg_lo:[0,1,0] neg_hi:[0,1,0]
    v_pk_mul_f32 v[146:147], v[82:83], v[38:39] op_sel:[0,0] op_sel_hi:[1,0]
    v_pk_fma_f32 v[146:147], v[114:115], v[38:39], v[146:147] op_sel:[0,1,0] op_sel_hi:[1,1,1] neg_lo:[0,1,0] neg_hi:[0,1,0]
    v_pk_mul_f32 v[114:115], v[114:115], v[38:39] op_sel:[0,0] op_sel_hi:[1,0] neg_lo:[0,1] neg_hi:[0,1]
    v_pk_fma_f32 v[114:115], v[82:83], v[38:39], v[114:115] op_sel:[0,1,0] op_sel_hi:[1,1,1] neg_lo:[0,1,0] neg_hi:[0,1,0]
    v_pk_mul_f32 v[148:149], v[84:85], v[38:39] op_sel:[0,0] op_sel_hi:[1,0]
    v_pk_fma_f32 v[148:149], v[116:117], v[38:39], v[148:149] op_sel:[0,1,0] op_sel_hi:[1,1,1] neg_lo:[0,1,0] neg_hi:[0,1,0]
    v_pk_mul_f32 v[116:117], v[116:117], v[38:39] op_sel:[0,0] op_sel_hi:[1,0] neg_lo:[0,1] neg_hi:[0,1]
    v_pk_fma_f32 v[116:117], v[84:85], v[38:39], v[116:117] op_sel:[0,1,0] op_sel_hi:[1,1,1] neg_lo:[0,1,0] neg_hi:[0,1,0]
    v_pk_mul_f32 v[150:151], v[86:87], v[38:39] op_sel:[0,0] op_sel_hi:[1,0]
    v_pk_fma_f32 v[150:151], v[118:119], v[38:39], v[150:151] op_sel:[0,1,0] op_sel_hi:[1,1,1] neg_lo:[0,1,0] neg_hi:[0,1,0]
    v_pk_mul_f32 v[118:119], v[118:119], v[38:39] op_sel:[0,0] op_sel_hi:[1,0] neg_lo:[0,1] neg_hi:[0,1]
    v_pk_fma_f32 v[118:119], v[86:87], v[38:39], v[118:119] op_sel:[0,1,0] op_sel_hi:[1,1,1] neg_lo:[0,1,0] neg_hi:[0,1,0]
    v_pk_mul_f32 v[152:153], v[88:89], v[38:39] op_sel:[0,0] op_sel_hi:[1,0]
    v_pk_fma_f32 v[152:153], v[120:121], v[38:39], v[152:153] op_sel:[0,1,0] op_sel_hi:[1,1,1] neg_lo:[0,1,0] neg_hi:[0,1,0]
    v_pk_mul_f32 v[120:121], v[120:121], v[38:39] op_sel:[0,0] op_sel_hi:[1,0] neg_lo:[0,1] neg_hi:[0,1]
    v_pk_fma_f32 v[120:121], v[88:89], v[38:39], v[120:121] op_sel:[0,1,0] op_sel_hi:[1,1,1] neg_lo:[0,1,0] neg_hi:[0,1,0]
    v_pk_mul_f32 v[154:155], v[90:91], v[38:39] op_sel:[0,0] op_sel_hi:[1,0]
    v_pk_fma_f32 v[154:155], v[122:123], v[38:39], v[154:155] op_sel:[0,1,0] op_sel_hi:[1,1,1] neg_lo:[0,1,0] neg_hi:[0,1,0]
    v_pk_mul_f32 v[122:123], v[122:123], v[38:39] op_sel:[0,0] op_sel_hi:[1,0] neg_lo:[0,1] neg_hi:[0,1]
    v_pk_fma_f32 v[122:123], v[90:91], v[38:39], v[122:123] op_sel:[0,1,0] op_sel_hi:[1,1,1] neg_lo:[0,1,0] neg_hi:[0,1,0]
    v_pk_mul_f32 v[156:157], v[92:93], v[38:39] op_sel:[0,0] op_sel_hi:[1,0]
    v_pk_fma_f32 v[156:157], v[124:125], v[38:39], v[156:157] op_sel:[0,1,0] op_sel_hi:[1,1,1] neg_lo:[0,1,0] neg_hi:[0,1,0]
    v_pk_mul_f32 v[124:125], v[124:125], v[38:39] op_sel:[0,0] op_sel_hi:[1,0] neg_lo:[0,1] neg_hi:[0,1]
    v_pk_fma_f32 v[124:125], v[92:93], v[38:39], v[124:125] op_sel:[0,1,0] op_sel_hi:[1,1,1] neg_lo:[0,1,0] neg_hi:[0,1,0]
    v_pk_mul_f32 v[158:159], v[94:95], v[38:39] op_sel:[0,0] op_sel_hi:[1,0]
    v_pk_fma_f32 v[158:159], v[126:127], v[38:39], v[158:159] op_sel:[0,1,0] op_sel_hi:[1,1,1] neg_lo:[0,1,0] neg_hi:[0,1,0]
    v_pk_mul_f32 v[126:127], v[126:127], v[38:39] op_sel:[0,0] op_sel_hi:[1,0] neg_lo:[0,1] neg_hi:[0,1]
    v_pk_fma_f32 v[126:127], v[94:95], v[38:39], v[126:127] op_sel:[0,1,0] op_sel_hi:[1,1,1] neg_lo:[0,1,0] neg_hi:[0,1,0]
    buffer_load_dword v242, v241, s[24:27], 0 offen offset:16 sc1
    s_lshr_b32 s53, s3, 1
    s_and_b32 s54, s3, 1
    v_and_b32 v8, 1, v3
    v_lshrrev_b32 v9, 2, v2
    v_lshl_add_u32 v8, v8, 3, v9
    v_lshlrev_b32 v14, 4, v8
    v_bfe_u32 v8, v2, 1, 1
    v_mul_u32_u24 v8, 320, v8
    v_add_u32 v14, v14, v8
    v_and_b32 v8, 1, v2
    v_lshl_add_u32 v14, v8, 3, v14
    v_lshrrev_b32 v8, 1, v3
    v_lshl_add_u32 v14, v8, 12, v14
    s_lshl_b32 s50, s53, 14
    v_add_u32 v14, s50, v14
    s_lshl_b32 m0, s3, 14
    v_add_u32 v6, s55, v15
    s_mul_i32 s50, s48, 9
    s_add_u32 s50, s50, s49
    s_lshl_b32 s50, s50, 7
    s_lshl_b32 s51, s3, 2
    s_add_u32 s50, s50, s51
    v_mov_b32 v58, s50
    v_mov_b32 v9, 0x7fffffff
    v_cmp_eq_u32 vcc, 0, v1
    s_nop 1
    v_cndmask_b32 v58, v9, v58, vcc
    v_mov_b32 v9, 1
    v_add_u32 v59, s55, v12
ac_poll:
    buffer_load_dwordx2 v[168:169], v244, s[40:43], 0 offen sc1
    buffer_load_dwordx2 v[170:171], v245, s[40:43], 0 offen sc1
    buffer_load_dwordx2 v[172:173], v246, s[40:43], 0 offen sc1
    buffer_load_dwordx2 v[174:175], v247, s[40:43], 0 offen sc1
    s_waitcnt vmcnt(0)
    v_max_u32 v44, v168, v169
    v_max3_u32 v44, v170, v171, v44
    v_max3_u32 v45, v172, v173, v174
    v_max3_u32 v44, v175, v45, v44
    v_cmp_eq_u32 vcc, -1, v44
    v_mov_b32 v160, v168
    v_mov_b32 v161, v169
    v_mov_b32 v162, v170
    v_mov_b32 v163, v171
    v_mov_b32 v164, v172
    v_mov_b32 v165, v173
    v_mov_b32 v166, v174
    v_mov_b32 v167, v175
    s_cmp_eq_u64 vcc, 0
    s_cbranch_scc1 ac_poll_ok
    s_sleep 2
    s_branch ac_poll
ac_poll_ok:
    v_cmp_eq_u32 vcc, s56, v242
    s_nop 0
    s_and_b32 s57, vcc_lo, 0x1ff
    v_mul_f32 v56, v30, v160
    v_mul_f32 v57, v30, v161
    v_fma_f32 v56, -v31, v161, v56
    v_fma_f32 v57, v31, v160, v57
    v_fma_f32 v56, v32, v162, v56
    v_fma_f32 v57, v32, v163, v57
    v_fma_f32 v56, -v33, v163, v56
    v_fma_f32 v57, v33, v162, v57
    v_fma_f32 v56, v34, v164, v56
    v_fma_f32 v57, v34, v165, v57
    v_fma_f32 v56, -v35, v165, v56
    v_fma_f32 v57, v35, v164, v57
    v_fma_f32 v56, v36, v166, v56
    v_fma_f32 v57, v36, v167, v57
    v_fma_f32 v56, -v37, v167, v56
    v_fma_f32 v57, v37, v166, v57
    v_mov_b32 v44, v56
    v_mov_b32 v45, v57
    s_nop 0
    v_permlane16_swap_b32 v44, v56
    v_permlane16_swap_b32 v45, v57
    v_add_f32 v56, v56, v44
    v_add_f32 v57, v57, v45
    v_mov_b32 v44, v56
    v_mov_b32 v45, v57
    s_nop 0
    v_permlane32_swap_b32 v44, v56
    v_permlane32_swap_b32 v45, v57
    v_add_f32 v56, v56, v44
    v_add_f32 v57, v57, v45
.p2align 3
    v_pk_fma_f32 v[52:53], v[24:25], v[56:57], v[52:53] op_sel:[0,0,0] op_sel_hi:[1,0,1]
    v_pk_fma_f32 v[54:55], v[24:25], v[56:57], v[54:55] op_sel:[0,1,0] op_sel_hi:[1,1,1]
    v_pk_fma_f32 v[52:53], v[26:27], v[56:57], v[52:53] op_sel:[0,1,0] op_sel_hi:[1,1,1] neg_lo:[0,1,0] neg_hi:[0,1,0]
    v_pk_fma_f32 v[54:55], v[26:27], v[56:57], v[54:55] op_sel:[0,0,0] op_sel_hi:[1,0,1]
    v_pk_fma_f32 v[128:129], v[52:53], v[192:193], v[128:129] op_sel:[0,0,0] op_sel_hi:[1,0,1]
    v_pk_fma_f32 v[96:97], v[54:55], v[192:193], v[96:97] op_sel:[0,0,0] op_sel_hi:[1,0,1] neg_lo:[0,1,0] neg_hi:[0,1,0]
    v_pk_fma_f32 v[128:129], v[54:55], v[192:193], v[128:129] op_sel:[0,1,0] op_sel_hi:[1,1,1] neg_lo:[0,1,0] neg_hi:[0,1,0]
    v_pk_fma_f32 v[96:97], v[52:53], v[192:193], v[96:97] op_sel:[0,1,0] op_sel_hi:[1,1,1] neg_lo:[0,1,0] neg_hi:[0,1,0]
    v_pk_fma_f32 v[130:131], v[52:53], v[194:195], v[130:131] op_sel:[0,0,0] op_sel_hi:[1,0,1]
    v_pk_fma_f32 v[98:99], v[54:55], v[194:195], v[98:99] op_sel:[0,0,0] op_sel_hi:[1,0,1] neg_lo:[0,1,0] neg_hi:[0,1,0]
    v_pk_fma_f32 v[130:131], v[54:55], v[194:195], v[130:131] op_sel:[0,1,0] op_sel_hi:[1,1,1] neg_lo:[0,1,0] neg_hi:[0,1,0]
    v_pk_fma_f32 v[98:99], v[52:53], v[194:195], v[98:99] op_sel:[0,1,0] op_sel_hi:[1,1,1] neg_lo:[0,1,0] neg_hi:[0,1,0]
    v_pk_fma_f32 v[132:133], v[52:53], v[196:197], v[132:133] op_sel:[0,0,0] op_sel_hi:[1,0,1]
    v_pk_fma_f32 v[100:101], v[54:55], v[196:197], v[100:101] op_sel:[0,0,0] op_sel_hi:[1,0,1] neg_lo:[0,1,0] neg_hi:[0,1,0]
    v_pk_fma_f32 v[132:133], v[54:55], v[196:197], v[132:133] op_sel:[0,1,0] op_sel_hi:[1,1,1] neg_lo:[0,1,0] neg_hi:[0,1,0]
    v_pk_fma_f32 v[100:101], v[52:53], v[196:197], v[100:101] op_sel:[0,1,0] op_sel_hi:[1,1,1] neg_lo:[0,1,0] neg_hi:[0,1,0]
    v_pk_fma_f32 v[134:135], v[52:53], v[198:199], v[134:135] op_sel:[0,0,0] op_sel_hi:[1,0,1]
    v_pk_fma_f32 v[102:103], v[54:55], v[198:199], v[102:103] op_sel:[0,0,0] op_sel_hi:[1,0,1] neg_lo:[0,1,0] neg_hi:[0,1,0]
    v_pk_fma_f32 v[134:135], v[54:55], v[198:199], v[134:135] op_sel:[0,1,0] op_sel_hi:[1,1,1] neg_lo:[0,1,0] neg_hi:[0,1,0]
    v_pk_fma_f32 v[102:103], v[52:53], v[198:199], v[102:103] op_sel:[0,1,0] op_sel_hi:[1,1,1] neg_lo:[0,1,0] neg_hi:[0,1,0]
    v_pk_fma_f32 v[136:137], v[52:53], v[200:201], v[136:137] op_sel:[0,0,0] op_sel_hi:[1,0,1]
    v_pk_fma_f32 v[104:105], v[54:55], v[200:201], v[104:105] op_sel:[0,0,0] op_sel_hi:[1,0,1] neg_lo:[0,1,0] neg_hi:[0,1,0]
    v_pk_fma_f32 v[136:137], v[54:55], v[200:201], v[136:137] op_sel:[0,1,0] op_sel_hi:[1,1,1] neg_lo:[0,1,0] neg_hi:[0,1,0]
    v_pk_fma_f32 v[104:105], v[52:53], v[200:201], v[104:105] op_sel:[0,1,0] op_sel_hi:[1,1,1] neg_lo:[0,1,0] neg_hi:[0,1,0]
    v_pk_fma_f32 v[138:139], v[52:53], v[202:203], v[138:139] op_sel:[0,0,0] op_sel_hi:[1,0,1]
    v_pk_fma_f32 v[106:107], v[54:55], v[202:203], v[106:107] op_sel:[0,0,0] op_sel_hi:[1,0,1] neg_lo:[0,1,0] neg_hi:[0,1,0]
    v_pk_fma_f32 v[138:139], v[54:55], v[202:203], v[138:139] op_sel:[0,1,0] op_sel_hi:[1,1,1] neg_lo:[0,1,0] neg_hi:[0,1,0]
    v_pk_fma_f32 v[106:107], v[52:53], v[202:203], v[106:107] op_sel:[0,1,0] op_sel_hi:[1,1,1] neg_lo:[0,1,0] neg_hi:[0,1,0]
    v_pk_fma_f32 v[140:141], v[52:53], v[204:205], v[140:141] op_sel:[0,0,0] op_sel_hi:[1,0,1]
    v_pk_fma_f32 v[108:109], v[54:55], v[204:205], v[108:109] op_sel:[0,0,0] op_sel_hi:[1,0,1] neg_lo:[0,1,0] neg_hi:[0,1,0]
    v_pk_fma_f32 v[140:141], v[54:55], v[204:205], v[140:141] op_sel:[0,1,0] op_sel_hi:[1,1,1] neg_lo:[0,1,0] neg_hi:[0,1,0]
    v_pk_fma_f32 v[108:109], v[52:53], v[204:205], v[108:109] op_sel:[0,1,0] op_sel_hi:[1,1,1] neg_lo:[0,1,0] neg_hi:[0,1,0]
    v_pk_fma_f32 v[142:143], v[52:53], v[206:207], v[142:143] op_sel:[0,0,0] op_sel_hi:[1,0,1]
    v_pk_fma_f32 v[110:111], v[54:55], v[206:207], v[110:111] op_sel:[0,0,0] op_sel_hi:[1,0,1] neg_lo:[0,1,0] neg_hi:[0,1,0]
    v_pk_fma_f32 v[142:143], v[54:55], v[206:207], v[142:143] op_sel:[0,1,0] op_sel_hi:[1,1,1] neg_lo:[0,1,0] neg_hi:[0,1,0]
    v_pk_fma_f32 v[110:111], v[52:53], v[206:207], v[110:111] op_sel:[0,1,0] op_sel_hi:[1,1,1] neg_lo:[0,1,0] neg_hi:[0,1,0]
    v_cvt_pk_bf16_f32 v64, v128, v130
    v_cvt_pk_bf16_f32 v65, v132, v134
    v_cvt_pk_bf16_f32 v66, v136, v138
    v_cvt_pk_bf16_f32 v67, v140, v142
    v_cvt_pk_bf16_f32 v72, v129, v131
    v_cvt_pk_bf16_f32 v73, v133, v135
    v_cvt_pk_bf16_f32 v74, v137, v139
    v_cvt_pk_bf16_f32 v75, v141, v143
    v_cvt_pk_bf16_f32 v80, v96, v98
    v_cvt_pk_bf16_f32 v81, v100, v102
    v_cvt_pk_bf16_f32 v82, v104, v106
    v_cvt_pk_bf16_f32 v83, v108, v110
    v_cvt_pk_bf16_f32 v88, v97, v99
    v_cvt_pk_bf16_f32 v89, v101, v103
    v_cvt_pk_bf16_f32 v90, v105, v107
    v_cvt_pk_bf16_f32 v91, v109, v111
    s_cmp_eq_u32 s57, 0x1ff
    s_cbranch_scc1 ac_hs0_f
    buffer_store_dwordx4 v[64:67], v243, s[36:39], s28 offen sc1
    buffer_store_dwordx4 v[72:75], v243, s[36:39], s30 offen sc1
    buffer_store_dwordx4 v[80:83], v243, s[36:39], s32 offen sc1
    buffer_store_dwordx4 v[88:91], v243, s[36:39], s34 offen sc1
    s_branch ac_hs0_j
ac_hs0_f:
    buffer_store_dwordx4 v[64:67], v243, s[36:39], s28 offen
    buffer_store_dwordx4 v[72:75], v243, s[36:39], s30 offen
    buffer_store_dwordx4 v[80:83], v243, s[36:39], s32 offen
    buffer_store_dwordx4 v[88:91], v243, s[36:39], s34 offen
ac_hs0_j:
.p2align 3
    v_pk_fma_f32 v[144:145], v[52:53], v[208:209], v[144:145] op_sel:[0,0,0] op_sel_hi:[1,0,1]
    v_pk_fma_f32 v[112:113], v[54:55], v[208:209], v[112:113] op_sel:[0,0,0] op_sel_hi:[1,0,1] neg_lo:[0,1,0] neg_hi:[0,1,0]
    v_pk_fma_f32 v[144:145], v[54:55], v[208:209], v[144:145] op_sel:[0,1,0] op_sel_hi:[1,1,1] neg_lo:[0,1,0] neg_hi:[0,1,0]
    v_pk_fma_f32 v[112:113], v[52:53], v[208:209], v[112:113] op_sel:[0,1,0] op_sel_hi:[1,1,1] neg_lo:[0,1,0] neg_hi:[0,1,0]
    v_pk_fma_f32 v[146:147], v[52:53], v[210:211], v[146:147] op_sel:[0,0,0] op_sel_hi:[1,0,1]
    v_pk_fma_f32 v[114:115], v[54:55], v[210:211], v[114:115] op_sel:[0,0,0] op_sel_hi:[1,0,1] neg_lo:[0,1,0] neg_hi:[0,1,0]
    v_pk_fma_f32 v[146:147], v[54:55], v[210:211], v[146:147] op_sel:[0,1,0] op_sel_hi:[1,1,1] neg_lo:[0,1,0] neg_hi:[0,1,0]
    v_pk_fma_f32 v[114:115], v[52:53], v[210:211], v[114:115] op_sel:[0,1,0] op_sel_hi:[1,1,1] neg_lo:[0,1,0] neg_hi:[0,1,0]
    v_pk_fma_f32 v[148:149], v[52:53], v[212:213], v[148:149] op_sel:[0,0,0] op_sel_hi:[1,0,1]
    v_pk_fma_f32 v[116:117], v[54:55], v[212:213], v[116:117] op_sel:[0,0,0] op_sel_hi:[1,0,1] neg_lo:[0,1,0] neg_hi:[0,1,0]
    v_pk_fma_f32 v[148:149], v[54:55], v[212:213], v[148:149] op_sel:[0,1,0] op_sel_hi:[1,1,1] neg_lo:[0,1,0] neg_hi:[0,1,0]
    v_pk_fma_f32 v[116:117], v[52:53], v[212:213], v[116:117] op_sel:[0,1,0] op_sel_hi:[1,1,1] neg_lo:[0,1,0] neg_hi:[0,1,0]
    v_pk_fma_f32 v[150:151], v[52:53], v[214:215], v[150:151] op_sel:[0,0,0] op_sel_hi:[1,0,1]
    v_pk_fma_f32 v[118:119], v[54:55], v[214:215], v[118:119] op_sel:[0,0,0] op_sel_hi:[1,0,1] neg_lo:[0,1,0] neg_hi:[0,1,0]
    v_pk_fma_f32 v[150:151], v[54:55], v[214:215], v[150:151] op_sel:[0,1,0] op_sel_hi:[1,1,1] neg_lo:[0,1,0] neg_hi:[0,1,0]
    v_pk_fma_f32 v[118:119], v[52:53], v[214:215], v[118:119] op_sel:[0,1,0] op_sel_hi:[1,1,1] neg_lo:[0,1,0] neg_hi:[0,1,0]
    v_pk_fma_f32 v[152:153], v[52:53], v[216:217], v[152:153] op_sel:[0,0,0] op_sel_hi:[1,0,1]
    v_pk_fma_f32 v[120:121], v[54:55], v[216:217], v[120:121] op_sel:[0,0,0] op_sel_hi:[1,0,1] neg_lo:[0,1,0] neg_hi:[0,1,0]
    v_pk_fma_f32 v[152:153], v[54:55], v[216:217], v[152:153] op_sel:[0,1,0] op_sel_hi:[1,1,1] neg_lo:[0,1,0] neg_hi:[0,1,0]
    v_pk_fma_f32 v[120:121], v[52:53], v[216:217], v[120:121] op_sel:[0,1,0] op_sel_hi:[1,1,1] neg_lo:[0,1,0] neg_hi:[0,1,0]
    v_pk_fma_f32 v[154:155], v[52:53], v[218:219], v[154:155] op_sel:[0,0,0] op_sel_hi:[1,0,1]
    v_pk_fma_f32 v[122:123], v[54:55], v[218:219], v[122:123] op_sel:[0,0,0] op_sel_hi:[1,0,1] neg_lo:[0,1,0] neg_hi:[0,1,0]
    v_pk_fma_f32 v[154:155], v[54:55], v[218:219], v[154:155] op_sel:[0,1,0] op_sel_hi:[1,1,1] neg_lo:[0,1,0] neg_hi:[0,1,0]
    v_pk_fma_f32 v[122:123], v[52:53], v[218:219], v[122:123] op_sel:[0,1,0] op_sel_hi:[1,1,1] neg_lo:[0,1,0] neg_hi:[0,1,0]
    v_pk_fma_f32 v[156:157], v[52:53], v[220:221], v[156:157] op_sel:[0,0,0] op_sel_hi:[1,0,1]
    v_pk_fma_f32 v[124:125], v[54:55], v[220:221], v[124:125] op_sel:[0,0,0] op_sel_hi:[1,0,1] neg_lo:[0,1,0] neg_hi:[0,1,0]
    v_pk_fma_f32 v[156:157], v[54:55], v[220:221], v[156:157] op_sel:[0,1,0] op_sel_hi:[1,1,1] neg_lo:[0,1,0] neg_hi:[0,1,0]
    v_pk_fma_f32 v[124:125], v[52:53], v[220:221], v[124:125] op_sel:[0,1,0] op_sel_hi:[1,1,1] neg_lo:[0,1,0] neg_hi:[0,1,0]
    v_pk_fma_f32 v[158:159], v[52:53], v[222:223], v[158:159] op_sel:[0,0,0] op_sel_hi:[1,0,1]
    v_pk_fma_f32 v[126:127], v[54:55], v[222:223], v[126:127] op_sel:[0,0,0] op_sel_hi:[1,0,1] neg_lo:[0,1,0] neg_hi:[0,1,0]
    v_pk_fma_f32 v[158:159], v[54:55], v[222:223], v[158:159] op_sel:[0,1,0] op_sel_hi:[1,1,1] neg_lo:[0,1,0] neg_hi:[0,1,0]
    v_pk_fma_f32 v[126:127], v[52:53], v[222:223], v[126:127] op_sel:[0,1,0] op_sel_hi:[1,1,1] neg_lo:[0,1,0] neg_hi:[0,1,0]
    v_cvt_pk_bf16_f32 v68, v144, v146
    v_cvt_pk_bf16_f32 v69, v148, v150
    v_cvt_pk_bf16_f32 v70, v152, v154
    v_cvt_pk_bf16_f32 v71, v156, v158
    v_cvt_pk_bf16_f32 v76, v145, v147
    v_cvt_pk_bf16_f32 v77, v149, v151
    v_cvt_pk_bf16_f32 v78, v153, v155
    v_cvt_pk_bf16_f32 v79, v157, v159
    v_cvt_pk_bf16_f32 v84, v112, v114
    v_cvt_pk_bf16_f32 v85, v116, v118
    v_cvt_pk_bf16_f32 v86, v120, v122
    v_cvt_pk_bf16_f32 v87, v124, v126
    v_cvt_pk_bf16_f32 v92, v113, v115
    v_cvt_pk_bf16_f32 v93, v117, v119
    v_cvt_pk_bf16_f32 v94, v121, v123
    v_cvt_pk_bf16_f32 v95, v125, v127
    s_cmp_eq_u32 s57, 0x1ff
    s_cbranch_scc1 ac_hs1_f
    buffer_store_dwordx4 v[68:71], v243, s[36:39], s29 offen sc1
    buffer_store_dwordx4 v[76:79], v243, s[36:39], s31 offen sc1
    buffer_store_dwordx4 v[84:87], v243, s[36:39], s33 offen sc1
    buffer_store_dwordx4 v[92:95], v243, s[36:39], s35 offen sc1
    s_branch ac_hs1_j
ac_hs1_f:
    buffer_store_dwordx4 v[68:71], v243, s[36:39], s29 offen
    buffer_store_dwordx4 v[76:79], v243, s[36:39], s31 offen
    buffer_store_dwordx4 v[84:87], v243, s[36:39], s33 offen
    buffer_store_dwordx4 v[92:95], v243, s[36:39], s35 offen
ac_hs1_j:
.p2align 3
    s_barrier
    s_waitcnt vmcnt(8)
    v_mov_b32 v4, v6
    v_xor_b32 v5, 64, v4
    ds_read_b128 v[112:115], v4 offset:0
    ds_read_b128 v[116:119], v4 offset:2048
    ds_read_b128 v[120:123], v5 offset:0
    ds_read_b128 v[124:127], v5 offset:2048
    ds_read_b128 v[128:131], v4 offset:16384
    ds_read_b128 v[132:135], v4 offset:18432
    ds_read_b128 v[136:139], v5 offset:16384
    ds_read_b128 v[140:143], v5 offset:18432
    ds_read_b128 v[144:147], v4 offset:32768
    ds_read_b128 v[148:151], v4 offset:34816
    ds_read_b128 v[152:155], v5 offset:32768
    ds_read_b128 v[156:159], v5 offset:34816
    ds_read_b128 v[160:163], v4 offset:49152
    ds_read_b128 v[164:167], v4 offset:51200
    ds_read_b128 v[168:171], v5 offset:49152
    ds_read_b128 v[172:175], v5 offset:51200
    s_waitcnt vmcnt(0)
    s_cmp_eq_u32 s57, 0x1ff
    s_cbranch_scc1 ac_fs_f
    buffer_store_dword v9, v58, s[24:27], 0 offen sc1
    s_branch ac_fs_j
ac_fs_f:
    buffer_store_dword v9, v58, s[24:27], 0 offen
ac_fs_j:
.p2align 3
    v_add_u32 v4, 65536, v6
    v_xor_b32 v5, 64, v4
    ds_read_b128 v[176:179], v4 offset:0
    ds_read_b128 v[180:183], v4 offset:2048
    ds_read_b128 v[184:187], v5 offset:0
    ds_read_b128 v[188:191], v5 offset:2048
    ds_read_b128 v[192:195], v4 offset:16384
    ds_read_b128 v[196:199], v4 offset:18432
    ds_read_b128 v[200:203], v5 offset:16384
    ds_read_b128 v[204:207], v5 offset:18432
    ds_read_b128 v[208:211], v4 offset:32768
    ds_read_b128 v[212:215], v4 offset:34816
    ds_read_b128 v[216:219], v5 offset:32768
    ds_read_b128 v[220:223], v5 offset:34816
    ds_read_b128 v[224:227], v4 offset:49152
    ds_read_b128 v[228:231], v4 offset:51200
    ds_read_b128 v[232:235], v5 offset:49152
    ds_read_b128 v[236:239], v5 offset:51200
    v_add_u32 v4, 131072, v6
    v_xor_b32 v5, 64, v4
    ds_read_b128 v[240:243], v4 offset:0
    ds_read_b128 v[244:247], v4 offset:2048
    ds_read_b128 v[248:251], v5 offset:0
    ds_read_b128 v[252:255], v5 offset:2048
    ds_write_b128 v59, v[64:67] offset:0
    ds_write_b128 v59, v[68:71] offset:1024
    ds_write_b128 v59, v[72:75] offset:2048
    ds_write_b128 v59, v[76:79] offset:3072
    ds_write_b128 v59, v[80:83] offset:16384
    ds_write_b128 v59, v[84:87] offset:17408
    ds_write_b128 v59, v[88:91] offset:18432
    ds_write_b128 v59, v[92:95] offset:19456
    s_waitcnt lgkmcnt(0)
    v_mov_b32 v10, v14
    v_xor_b32 v11, 64, v10
    s_barrier
    ds_read_b64_tr_b16 v[80:81], v10 offset:0
    ds_read_b64_tr_b16 v[82:83], v11 offset:0
    ds_read_b64_tr_b16 v[84:85], v10 offset:1024
    ds_read_b64_tr_b16 v[86:87], v11 offset:1024
    ds_read_b64_tr_b16 v[88:89], v10 offset:2048
    ds_read_b64_tr_b16 v[90:91], v11 offset:2048
    ds_read_b64_tr_b16 v[92:93], v10 offset:3072
    ds_read_b64_tr_b16 v[94:95], v11 offset:3072
    s_waitcnt lgkmcnt(6)
    v_mfma_f32_16x16x32_bf16 v[16:19], v[80:83], v[112:115], 0
    ds_read_b64_tr_b16 v[96:97], v10 offset:512
    v_mfma_f32_16x16x32_bf16 v[20:23], v[80:83], v[116:119], 0
    ds_read_b64_tr_b16 v[98:99], v11 offset:512
    s_waitcnt lgkmcnt(6)
    v_mfma_f32_16x16x32_bf16 v[24:27], v[84:87], v[112:115], 0
    ds_read_b64_tr_b16 v[100:101], v10 offset:1536
    v_mfma_f32_16x16x32_bf16 v[28:31], v[84:87], v[116:119], 0
    ds_read_b64_tr_b16 v[102:103], v11 offset:1536
    s_waitcnt lgkmcnt(6)
    v_mfma_f32_16x16x32_bf16 v[32:35], v[88:91], v[112:115], 0
    ds_read_b64_tr_b16 v[104:105], v10 offset:2560
    v_mfma_f32_16x16x32_bf16 v[36:39], v[88:91], v[116:119], 0
    ds_read_b64_tr_b16 v[106:107], v11 offset:2560
    s_waitcnt lgkmcnt(6)
    v_mfma_f32_16x16x32_bf16 v[40:43], v[92:95], v[112:115], 0
    ds_read_b64_tr_b16 v[108:109], v10 offset:3584
    v_mfma_f32_16x16x32_bf16 v[44:47], v[92:95], v[116:119], 0
    ds_read_b64_tr_b16 v[110:111], v11 offset:3584
    s_waitcnt lgkmcnt(6)
    v_mfma_f32_16x16x32_bf16 v[48:51], v[96:99], v[112:115], 0
    ds_read_b64_tr_b16 v[80:81], v10 offset:8192
    v_mfma_f32_16x16x32_bf16 v[52:55], v[96:99], v[116:119], 0
    ds_read_b64_tr_b16 v[82:83], v11 offset:8192
    s_waitcnt lgkmcnt(6)
    v_mfma_f32_16x16x32_bf16 v[56:59], v[100:103], v[112:115], 0
    ds_read_b64_tr_b16 v[84:85], v10 offset:9216
    v_mfma_f32_16x16x32_bf16 v[60:63], v[100:103], v[116:119], 0
    ds_read_b64_tr_b16 v[86:87], v11 offset:9216
    s_waitcnt lgkmcnt(6)
    v_mfma_f32_16x16x32_bf16 v[64:67], v[104:107], v[112:115], 0
    ds_read_b64_tr_b16 v[88:89], v10 offset:10240
    v_mfma_f32_16x16x32_bf16 v[68:71], v[104:107], v[116:119], 0
    ds_read_b64_tr_b16 v[90:91], v11 offset:10240
    s_waitcnt lgkmcnt(6)
    v_mfma_f32_16x16x32_bf16 v[72:75], v[108:111], v[112:115], 0
    ds_read_b64_tr_b16 v[92:93], v10 offset:11264
    v_mfma_f32_16x16x32_bf16 v[76:79], v[108:111], v[116:119], 0
    ds_read_b64_tr_b16 v[94:95], v11 offset:11264
    s_waitcnt lgkmcnt(6)
    v_mfma_f32_16x16x32_bf16 v[16:19], v[80:83], v[120:123], v[16:19]
    ds_read_b64_tr_b16 v[96:97], v10 offset:8704
    v_mfma_f32_16x16x32_bf16 v[20:23], v[80:83], v[124:127], v[20:23]
    ds_read_b64_tr_b16 v[98:99], v11 offset:8704
    s_waitcnt lgkmcnt(6)
    v_mfma_f32_16x16x32_bf16 v[24:27], v[84:87], v[120:123], v[24:27]
    ds_read_b64_tr_b16 v[100:101], v10 offset:9728
    v_mfma_f32_16x16x32_bf16 v[28:31], v[84:87], v[124:127], v[28:31]
    ds_read_b64_tr_b16 v[102:103], v11 offset:9728
    s_waitcnt lgkmcnt(6)
    v_mfma_f32_16x16x32_bf16 v[32:35], v[88:91], v[120:123], v[32:35]
    ds_read_b64_tr_b16 v[104:105], v10 offset:10752
    v_mfma_f32_16x16x32_bf16 v[36:39], v[88:91], v[124:127], v[36:39]
    ds_read_b64_tr_b16 v[106:107], v11 offset:10752
    s_waitcnt lgkmcnt(6)
    v_mfma_f32_16x16x32_bf16 v[40:43], v[92:95], v[120:123], v[40:43]
    ds_read_b64_tr_b16 v[108:109], v10 offset:11776
    v_mfma_f32_16x16x32_bf16 v[44:47], v[92:95], v[124:127], v[44:47]
    ds_read_b64_tr_b16 v[110:111], v11 offset:11776
    v_add_u32 v10, 32768, v14
    v_xor_b32 v11, 64, v10
    s_barrier
    s_waitcnt lgkmcnt(6)
    v_mfma_f32_16x16x32_bf16 v[48:51], v[96:99], v[120:123], v[48:51]
    ds_read_b64_tr_b16 v[80:81], v10 offset:0
    v_mfma_f32_16x16x32_bf16 v[52:55], v[96:99], v[124:127], v[52:55]
    ds_read_b64_tr_b16 v[82:83], v11 offset:0
    s_waitcnt lgkmcnt(6)
    v_mfma_f32_16x16x32_bf16 v[56:59], v[100:103], v[120:123], v[56:59]
    ds_read_b64_tr_b16 v[84:85], v10 offset:1024
    v_mfma_f32_16x16x32_bf16 v[60:63], v[100:103], v[124:127], v[60:63]
    ds_read_b64_tr_b16 v[86:87], v11 offset:1024
    s_waitcnt lgkmcnt(6)
    v_mfma_f32_16x16x32_bf16 v[64:67], v[104:107], v[120:123], v[64:67]
    ds_read_b64_tr_b16 v[88:89], v10 offset:2048
    v_mfma_f32_16x16x32_bf16 v[68:71], v[104:107], v[124:127], v[68:71]
    ds_read_b64_tr_b16 v[90:91], v11 offset:2048
    s_waitcnt lgkmcnt(6)
    v_mfma_f32_16x16x32_bf16 v[72:75], v[108:111], v[120:123], v[72:75]
    ds_read_b64_tr_b16 v[92:93], v10 offset:3072
    v_mfma_f32_16x16x32_bf16 v[76:79], v[108:111], v[124:127], v[76:79]
    ds_read_b64_tr_b16 v[94:95], v11 offset:3072
    s_waitcnt lgkmcnt(6)
    v_mfma_f32_16x16x32_bf16 v[16:19], v[80:83], v[128:131], v[16:19]
    ds_read_b64_tr_b16 v[96:97], v10 offset:512
    v_mfma_f32_16x16x32_bf16 v[20:23], v[80:83], v[132:135], v[20:23]
    ds_read_b64_tr_b16 v[98:99], v11 offset:512
    s_waitcnt lgkmcnt(6)
    v_mfma_f32_16x16x32_bf16 v[24:27], v[84:87], v[128:131], v[24:27]
    ds_read_b64_tr_b16 v[100:101], v10 offset:1536
    v_mfma_f32_16x16x32_bf16 v[28:31], v[84:87], v[132:135], v[28:31]
    ds_read_b64_tr_b16 v[102:103], v11 offset:1536
    s_waitcnt lgkmcnt(6)
    v_mfma_f32_16x16x32_bf16 v[32:35], v[88:91], v[128:131], v[32:35]
    ds_read_b64_tr_b16 v[104:105], v10 offset:2560
    v_mfma_f32_16x16x32_bf16 v[36:39], v[88:91], v[132:135], v[36:39]
    ds_read_b64_tr_b16 v[106:107], v11 offset:2560
    s_waitcnt lgkmcnt(6)
    v_mfma_f32_16x16x32_bf16 v[40:43], v[92:95], v[128:131], v[40:43]
    ds_read_b64_tr_b16 v[108:109], v10 offset:3584
    v_mfma_f32_16x16x32_bf16 v[44:47], v[92:95], v[132:135], v[44:47]
    ds_read_b64_tr_b16 v[110:111], v11 offset:3584
    s_waitcnt lgkmcnt(6)
    v_mfma_f32_16x16x32_bf16 v[48:51], v[96:99], v[128:131], v[48:51]
    ds_read_b64_tr_b16 v[80:81], v10 offset:8192
    v_mfma_f32_16x16x32_bf16 v[52:55], v[96:99], v[132:135], v[52:55]
    ds_read_b64_tr_b16 v[82:83], v11 offset:8192
    s_waitcnt lgkmcnt(6)
    v_mfma_f32_16x16x32_bf16 v[56:59], v[100:103], v[128:131], v[56:59]
    ds_read_b64_tr_b16 v[84:85], v10 offset:9216
    v_mfma_f32_16x16x32_bf16 v[60:63], v[100:103], v[132:135], v[60:63]
    ds_read_b64_tr_b16 v[86:87], v11 offset:9216
    s_waitcnt lgkmcnt(6)
    v_mfma_f32_16x16x32_bf16 v[64:67], v[104:107], v[128:131], v[64:67]
    ds_read_b64_tr_b16 v[88:89], v10 offset:10240
    v_mfma_f32_16x16x32_bf16 v[68:71], v[104:107], v[132:135], v[68:71]
    ds_read_b64_tr_b16 v[90:91], v11 offset:10240
    s_waitcnt lgkmcnt(6)
    v_mfma_f32_16x16x32_bf16 v[72:75], v[108:111], v[128:131], v[72:75]
    ds_read_b64_tr_b16 v[92:93], v10 offset:11264
    v_mfma_f32_16x16x32_bf16 v[76:79], v[108:111], v[132:135], v[76:79]
    ds_read_b64_tr_b16 v[94:95], v11 offset:11264
    s_waitcnt lgkmcnt(6)
    v_mfma_f32_16x16x32_bf16 v[16:19], v[80:83], v[136:139], v[16:19]
    ds_read_b64_tr_b16 v[96:97], v10 offset:8704
    v_mfma_f32_16x16x32_bf16 v[20:23], v[80:83], v[140:143], v[20:23]
    ds_read_b64_tr_b16 v[98:99], v11 offset:8704
    s_waitcnt lgkmcnt(6)
    v_mfma_f32_16x16x32_bf16 v[24:27], v[84:87], v[136:139], v[24:27]
    ds_read_b64_tr_b16 v[100:101], v10 offset:9728
    v_mfma_f32_16x16x32_bf16 v[28:31], v[84:87], v[140:143], v[28:31]
    ds_read_b64_tr_b16 v[102:103], v11 offset:9728
    s_waitcnt lgkmcnt(6)
    v_mfma_f32_16x16x32_bf16 v[32:35], v[88:91], v[136:139], v[32:35]
    ds_read_b64_tr_b16 v[104:105], v10 offset:10752
    v_mfma_f32_16x16x32_bf16 v[36:39], v[88:91], v[140:143], v[36:39]
    ds_read_b64_tr_b16 v[106:107], v11 offset:10752
    s_waitcnt lgkmcnt(6)
    v_mfma_f32_16x16x32_bf16 v[40:43], v[92:95], v[136:139], v[40:43]
    ds_read_b64_tr_b16 v[108:109], v10 offset:11776
    v_mfma_f32_16x16x32_bf16 v[44:47], v[92:95], v[140:143], v[44:47]
    ds_read_b64_tr_b16 v[110:111], v11 offset:11776
    v_add_u32 v10, 65536, v14
    v_xor_b32 v11, 64, v10
    s_barrier
    s_waitcnt lgkmcnt(6)
    v_mfma_f32_16x16x32_bf16 v[48:51], v[96:99], v[136:139], v[48:51]
    ds_read_b64_tr_b16 v[80:81], v10 offset:0
    v_mfma_f32_16x16x32_bf16 v[52:55], v[96:99], v[140:143], v[52:55]
    ds_read_b64_tr_b16 v[82:83], v11 offset:0
    s_waitcnt lgkmcnt(6)
    v_mfma_f32_16x16x32_bf16 v[56:59], v[100:103], v[136:139], v[56:59]
    ds_read_b64_tr_b16 v[84:85], v10 offset:1024
    v_mfma_f32_16x16x32_bf16 v[60:63], v[100:103], v[140:143], v[60:63]
    ds_read_b64_tr_b16 v[86:87], v11 offset:1024
    s_waitcnt lgkmcnt(6)
    v_mfma_f32_16x16x32_bf16 v[64:67], v[104:107], v[136:139], v[64:67]
    ds_read_b64_tr_b16 v[88:89], v10 offset:2048
    v_mfma_f32_16x16x32_bf16 v[68:71], v[104:107], v[140:143], v[68:71]
    ds_read_b64_tr_b16 v[90:91], v11 offset:2048
    s_waitcnt lgkmcnt(6)
    v_mfma_f32_16x16x32_bf16 v[72:75], v[108:111], v[136:139], v[72:75]
    ds_read_b64_tr_b16 v[92:93], v10 offset:3072
    v_mfma_f32_16x16x32_bf16 v[76:79], v[108:111], v[140:143], v[76:79]
    ds_read_b64_tr_b16 v[94:95], v11 offset:3072
    s_waitcnt lgkmcnt(6)
    v_mfma_f32_16x16x32_bf16 v[16:19], v[80:83], v[144:147], v[16:19]
    ds_read_b64_tr_b16 v[96:97], v10 offset:512
    v_mfma_f32_16x16x32_bf16 v[20:23], v[80:83], v[148:151], v[20:23]
    ds_read_b64_tr_b16 v[98:99], v11 offset:512
    s_waitcnt lgkmcnt(6)
    v_mfma_f32_16x16x32_bf16 v[24:27], v[84:87], v[144:147], v[24:27]
    ds_read_b64_tr_b16 v[100:101], v10 offset:1536
    v_mfma_f32_16x16x32_bf16 v[28:31], v[84:87], v[148:151], v[28:31]
    ds_read_b64_tr_b16 v[102:103], v11 offset:1536
    s_waitcnt lgkmcnt(6)
    v_mfma_f32_16x16x32_bf16 v[32:35], v[88:91], v[144:147], v[32:35]
    ds_read_b64_tr_b16 v[104:105], v10 offset:2560
    v_mfma_f32_16x16x32_bf16 v[36:39], v[88:91], v[148:151], v[36:39]
    ds_read_b64_tr_b16 v[106:107], v11 offset:2560
    s_waitcnt lgkmcnt(6)
    v_mfma_f32_16x16x32_bf16 v[40:43], v[92:95], v[144:147], v[40:43]
    ds_read_b64_tr_b16 v[108:109], v10 offset:3584
    v_mfma_f32_16x16x32_bf16 v[44:47], v[92:95], v[148:151], v[44:47]
    ds_read_b64_tr_b16 v[110:111], v11 offset:3584
    s_waitcnt lgkmcnt(6)
    v_mfma_f32_16x16x32_bf16 v[48:51], v[96:99], v[144:147], v[48:51]
    ds_read_b64_tr_b16 v[80:81], v10 offset:8192
    v_mfma_f32_16x16x32_bf16 v[52:55], v[96:99], v[148:151], v[52:55]
    ds_read_b64_tr_b16 v[82:83], v11 offset:8192
    s_waitcnt lgkmcnt(6)
    v_mfma_f32_16x16x32_bf16 v[56:59], v[100:103], v[144:147], v[56:59]
    ds_read_b64_tr_b16 v[84:85], v10 offset:9216
    v_mfma_f32_16x16x32_bf16 v[60:63], v[100:103], v[148:151], v[60:63]
    ds_read_b64_tr_b16 v[86:87], v11 offset:9216
    s_waitcnt lgkmcnt(6)
    v_mfma_f32_16x16x32_bf16 v[64:67], v[104:107], v[144:147], v[64:67]
    ds_read_b64_tr_b16 v[88:89], v10 offset:10240
    v_mfma_f32_16x16x32_bf16 v[68:71], v[104:107], v[148:151], v[68:71]
    ds_read_b64_tr_b16 v[90:91], v11 offset:10240
    s_waitcnt lgkmcnt(6)
    v_mfma_f32_16x16x32_bf16 v[72:75], v[108:111], v[144:147], v[72:75]
    ds_read_b64_tr_b16 v[92:93], v10 offset:11264
    v_mfma_f32_16x16x32_bf16 v[76:79], v[108:111], v[148:151], v[76:79]
    ds_read_b64_tr_b16 v[94:95], v11 offset:11264
    s_waitcnt lgkmcnt(6)
    v_mfma_f32_16x16x32_bf16 v[16:19], v[80:83], v[152:155], v[16:19]
    ds_read_b64_tr_b16 v[96:97], v10 offset:8704
    v_mfma_f32_16x16x32_bf16 v[20:23], v[80:83], v[156:159], v[20:23]
    ds_read_b64_tr_b16 v[98:99], v11 offset:8704
    s_waitcnt lgkmcnt(6)
    v_mfma_f32_16x16x32_bf16 v[24:27], v[84:87], v[152:155], v[24:27]
    ds_read_b64_tr_b16 v[100:101], v10 offset:9728
    v_mfma_f32_16x16x32_bf16 v[28:31], v[84:87], v[156:159], v[28:31]
    ds_read_b64_tr_b16 v[102:103], v11 offset:9728
    s_waitcnt lgkmcnt(6)
    v_mfma_f32_16x16x32_bf16 v[32:35], v[88:91], v[152:155], v[32:35]
    ds_read_b64_tr_b16 v[104:105], v10 offset:10752
    v_mfma_f32_16x16x32_bf16 v[36:39], v[88:91], v[156:159], v[36:39]
    ds_read_b64_tr_b16 v[106:107], v11 offset:10752
    s_waitcnt lgkmcnt(6)
    v_mfma_f32_16x16x32_bf16 v[40:43], v[92:95], v[152:155], v[40:43]
    ds_read_b64_tr_b16 v[108:109], v10 offset:11776
    v_mfma_f32_16x16x32_bf16 v[44:47], v[92:95], v[156:159], v[44:47]
    ds_read_b64_tr_b16 v[110:111], v11 offset:11776
    v_add_u32 v10, 98304, v14
    v_xor_b32 v11, 64, v10
    s_barrier
    s_waitcnt lgkmcnt(6)
    v_mfma_f32_16x16x32_bf16 v[48:51], v[96:99], v[152:155], v[48:51]
    ds_read_b64_tr_b16 v[80:81], v10 offset:0
    v_mfma_f32_16x16x32_bf16 v[52:55], v[96:99], v[156:159], v[52:55]
    ds_read_b64_tr_b16 v[82:83], v11 offset:0
    s_waitcnt lgkmcnt(6)
    v_mfma_f32_16x16x32_bf16 v[56:59], v[100:103], v[152:155], v[56:59]
    ds_read_b64_tr_b16 v[84:85], v10 offset:1024
    v_mfma_f32_16x16x32_bf16 v[60:63], v[100:103], v[156:159], v[60:63]
    ds_read_b64_tr_b16 v[86:87], v11 offset:1024
    s_waitcnt lgkmcnt(6)
    v_mfma_f32_16x16x32_bf16 v[64:67], v[104:107], v[152:155], v[64:67]
    ds_read_b64_tr_b16 v[88:89], v10 offset:2048
    v_mfma_f32_16x16x32_bf16 v[68:71], v[104:107], v[156:159], v[68:71]
    ds_read_b64_tr_b16 v[90:91], v11 offset:2048
    s_waitcnt lgkmcnt(6)
    v_mfma_f32_16x16x32_bf16 v[72:75], v[108:111], v[152:155], v[72:75]
    ds_read_b64_tr_b16 v[92:93], v10 offset:3072
    v_mfma_f32_16x16x32_bf16 v[76:79], v[108:111], v[156:159], v[76:79]
    ds_read_b64_tr_b16 v[94:95], v11 offset:3072
    s_waitcnt lgkmcnt(6)
    v_mfma_f32_16x16x32_bf16 v[16:19], v[80:83], v[160:163], v[16:19]
    ds_read_b64_tr_b16 v[96:97], v10 offset:512
    v_mfma_f32_16x16x32_bf16 v[20:23], v[80:83], v[164:167], v[20:23]
    ds_read_b64_tr_b16 v[98:99], v11 offset:512
    s_waitcnt lgkmcnt(6)
    v_mfma_f32_16x16x32_bf16 v[24:27], v[84:87], v[160:163], v[24:27]
    ds_read_b64_tr_b16 v[100:101], v10 offset:1536
    v_mfma_f32_16x16x32_bf16 v[28:31], v[84:87], v[164:167], v[28:31]
    ds_read_b64_tr_b16 v[102:103], v11 offset:1536
    s_waitcnt lgkmcnt(6)
    v_mfma_f32_16x16x32_bf16 v[32:35], v[88:91], v[160:163], v[32:35]
    ds_read_b64_tr_b16 v[104:105], v10 offset:2560
    v_mfma_f32_16x16x32_bf16 v[36:39], v[88:91], v[164:167], v[36:39]
    ds_read_b64_tr_b16 v[106:107], v11 offset:2560
    s_waitcnt lgkmcnt(6)
    v_mfma_f32_16x16x32_bf16 v[40:43], v[92:95], v[160:163], v[40:43]
    ds_read_b64_tr_b16 v[108:109], v10 offset:3584
    v_mfma_f32_16x16x32_bf16 v[44:47], v[92:95], v[164:167], v[44:47]
    ds_read_b64_tr_b16 v[110:111], v11 offset:3584
    s_waitcnt lgkmcnt(6)
    v_mfma_f32_16x16x32_bf16 v[48:51], v[96:99], v[160:163], v[48:51]
    ds_read_b64_tr_b16 v[80:81], v10 offset:8192
    v_mfma_f32_16x16x32_bf16 v[52:55], v[96:99], v[164:167], v[52:55]
    ds_read_b64_tr_b16 v[82:83], v11 offset:8192
    s_waitcnt lgkmcnt(6)
    v_mfma_f32_16x16x32_bf16 v[56:59], v[100:103], v[160:163], v[56:59]
    ds_read_b64_tr_b16 v[84:85], v10 offset:9216
    v_mfma_f32_16x16x32_bf16 v[60:63], v[100:103], v[164:167], v[60:63]
    ds_read_b64_tr_b16 v[86:87], v11 offset:9216
    s_waitcnt lgkmcnt(6)
    v_mfma_f32_16x16x32_bf16 v[64:67], v[104:107], v[160:163], v[64:67]
    ds_read_b64_tr_b16 v[88:89], v10 offset:10240
    v_mfma_f32_16x16x32_bf16 v[68:71], v[104:107], v[164:167], v[68:71]
    ds_read_b64_tr_b16 v[90:91], v11 offset:10240
    s_waitcnt lgkmcnt(6)
    v_mfma_f32_16x16x32_bf16 v[72:75], v[108:111], v[160:163], v[72:75]
    ds_read_b64_tr_b16 v[92:93], v10 offset:11264
    v_mfma_f32_16x16x32_bf16 v[76:79], v[108:111], v[164:167], v[76:79]
    ds_read_b64_tr_b16 v[94:95], v11 offset:11264
    s_waitcnt lgkmcnt(6)
    v_mfma_f32_16x16x32_bf16 v[16:19], v[80:83], v[168:171], v[16:19]
    ds_read_b64_tr_b16 v[96:97], v10 offset:8704
    v_mfma_f32_16x16x32_bf16 v[20:23], v[80:83], v[172:175], v[20:23]
    ds_read_b64_tr_b16 v[98:99], v11 offset:8704
    s_waitcnt lgkmcnt(6)
    v_mfma_f32_16x16x32_bf16 v[24:27], v[84:87], v[168:171], v[24:27]
    ds_read_b64_tr_b16 v[100:101], v10 offset:9728
    v_mfma_f32_16x16x32_bf16 v[28:31], v[84:87], v[172:175], v[28:31]
    ds_read_b64_tr_b16 v[102:103], v11 offset:9728
    s_waitcnt lgkmcnt(6)
    v_mfma_f32_16x16x32_bf16 v[32:35], v[88:91], v[168:171], v[32:35]
    ds_read_b64_tr_b16 v[104:105], v10 offset:10752
    v_mfma_f32_16x16x32_bf16 v[36:39], v[88:91], v[172:175], v[36:39]
    ds_read_b64_tr_b16 v[106:107], v11 offset:10752
    s_waitcnt lgkmcnt(6)
    v_mfma_f32_16x16x32_bf16 v[40:43], v[92:95], v[168:171], v[40:43]
    ds_read_b64_tr_b16 v[108:109], v10 offset:11776
    v_mfma_f32_16x16x32_bf16 v[44:47], v[92:95], v[172:175], v[44:47]
    ds_read_b64_tr_b16 v[110:111], v11 offset:11776
    v_add_u32 v10, 131072, v14
    v_xor_b32 v11, 64, v10
    s_barrier
    s_waitcnt lgkmcnt(6)
    v_mfma_f32_16x16x32_bf16 v[48:51], v[96:99], v[168:171], v[48:51]
    ds_read_b64_tr_b16 v[80:81], v10 offset:0
    v_mfma_f32_16x16x32_bf16 v[52:55], v[96:99], v[172:175], v[52:55]
    ds_read_b64_tr_b16 v[82:83], v11 offset:0
    s_waitcnt lgkmcnt(6)
    v_mfma_f32_16x16x32_bf16 v[56:59], v[100:103], v[168:171], v[56:59]
    ds_read_b64_tr_b16 v[84:85], v10 offset:1024
    v_mfma_f32_16x16x32_bf16 v[60:63], v[100:103], v[172:175], v[60:63]
    ds_read_b64_tr_b16 v[86:87], v11 offset:1024
    s_waitcnt lgkmcnt(6)
    v_mfma_f32_16x16x32_bf16 v[64:67], v[104:107], v[168:171], v[64:67]
    ds_read_b64_tr_b16 v[88:89], v10 offset:2048
    v_mfma_f32_16x16x32_bf16 v[68:71], v[104:107], v[172:175], v[68:71]
    ds_read_b64_tr_b16 v[90:91], v11 offset:2048
    s_waitcnt lgkmcnt(6)
    v_mfma_f32_16x16x32_bf16 v[72:75], v[108:111], v[168:171], v[72:75]
    ds_read_b64_tr_b16 v[92:93], v10 offset:3072
    v_mfma_f32_16x16x32_bf16 v[76:79], v[108:111], v[172:175], v[76:79]
    ds_read_b64_tr_b16 v[94:95], v11 offset:3072
    s_waitcnt lgkmcnt(6)
    v_mfma_f32_16x16x32_bf16 v[16:19], v[80:83], v[176:179], v[16:19]
    ds_read_b64_tr_b16 v[96:97], v10 offset:512
    v_mfma_f32_16x16x32_bf16 v[20:23], v[80:83], v[180:183], v[20:23]
    ds_read_b64_tr_b16 v[98:99], v11 offset:512
    s_waitcnt lgkmcnt(6)
    v_mfma_f32_16x16x32_bf16 v[24:27], v[84:87], v[176:179], v[24:27]
    ds_read_b64_tr_b16 v[100:101], v10 offset:1536
    v_mfma_f32_16x16x32_bf16 v[28:31], v[84:87], v[180:183], v[28:31]
    ds_read_b64_tr_b16 v[102:103], v11 offset:1536
    s_waitcnt lgkmcnt(6)
    v_mfma_f32_16x16x32_bf16 v[32:35], v[88:91], v[176:179], v[32:35]
    ds_read_b64_tr_b16 v[104:105], v10 offset:2560
    v_mfma_f32_16x16x32_bf16 v[36:39], v[88:91], v[180:183], v[36:39]
    ds_read_b64_tr_b16 v[106:107], v11 offset:2560
    s_waitcnt lgkmcnt(6)
    v_mfma_f32_16x16x32_bf16 v[40:43], v[92:95], v[176:179], v[40:43]
    ds_read_b64_tr_b16 v[108:109], v10 offset:3584
    v_mfma_f32_16x16x32_bf16 v[44:47], v[92:95], v[180:183], v[44:47]
    ds_read_b64_tr_b16 v[110:111], v11 offset:3584
    s_waitcnt lgkmcnt(6)
    v_mfma_f32_16x16x32_bf16 v[48:51], v[96:99], v[176:179], v[48:51]
    ds_read_b64_tr_b16 v[80:81], v10 offset:8192
    v_mfma_f32_16x16x32_bf16 v[52:55], v[96:99], v[180:183], v[52:55]
    ds_read_b64_tr_b16 v[82:83], v11 offset:8192
    s_waitcnt lgkmcnt(6)
    v_mfma_f32_16x16x32_bf16 v[56:59], v[100:103], v[176:179], v[56:59]
    ds_read_b64_tr_b16 v[84:85], v10 offset:9216
    v_mfma_f32_16x16x32_bf16 v[60:63], v[100:103], v[180:183], v[60:63]
    ds_read_b64_tr_b16 v[86:87], v11 offset:9216
    s_waitcnt lgkmcnt(6)
    v_mfma_f32_16x16x32_bf16 v[64:67], v[104:107], v[176:179], v[64:67]
    ds_read_b64_tr_b16 v[88:89], v10 offset:10240
    v_mfma_f32_16x16x32_bf16 v[68:71], v[104:107], v[180:183], v[68:71]
    ds_read_b64_tr_b16 v[90:91], v11 offset:10240
    s_waitcnt lgkmcnt(6)
    v_mfma_f32_16x16x32_bf16 v[72:75], v[108:111], v[176:179], v[72:75]
    ds_read_b64_tr_b16 v[92:93], v10 offset:11264
    v_mfma_f32_16x16x32_bf16 v[76:79], v[108:111], v[180:183], v[76:79]
    ds_read_b64_tr_b16 v[94:95], v11 offset:11264
    s_waitcnt lgkmcnt(6)
    v_mfma_f32_16x16x32_bf16 v[16:19], v[80:83], v[184:187], v[16:19]
    ds_read_b64_tr_b16 v[96:97], v10 offset:8704
    v_mfma_f32_16x16x32_bf16 v[20:23], v[80:83], v[188:191], v[20:23]
    ds_read_b64_tr_b16 v[98:99], v11 offset:8704
    s_waitcnt lgkmcnt(6)
    v_mfma_f32_16x16x32_bf16 v[24:27], v[84:87], v[184:187], v[24:27]
    ds_read_b64_tr_b16 v[100:101], v10 offset:9728
    v_mfma_f32_16x16x32_bf16 v[28:31], v[84:87], v[188:191], v[28:31]
    ds_read_b64_tr_b16 v[102:103], v11 offset:9728
    s_waitcnt lgkmcnt(6)
    v_mfma_f32_16x16x32_bf16 v[32:35], v[88:91], v[184:187], v[32:35]
    ds_read_b64_tr_b16 v[104:105], v10 offset:10752
    v_mfma_f32_16x16x32_bf16 v[36:39], v[88:91], v[188:191], v[36:39]
    ds_read_b64_tr_b16 v[106:107], v11 offset:10752
    s_waitcnt lgkmcnt(6)
    v_mfma_f32_16x16x32_bf16 v[40:43], v[92:95], v[184:187], v[40:43]
    ds_read_b64_tr_b16 v[108:109], v10 offset:11776
    v_mfma_f32_16x16x32_bf16 v[44:47], v[92:95], v[188:191], v[44:47]
    ds_read_b64_tr_b16 v[110:111], v11 offset:11776
    v_mov_b32 v10, v14
    v_xor_b32 v11, 64, v10
    s_barrier
    s_waitcnt lgkmcnt(6)
    v_mfma_f32_16x16x32_bf16 v[48:51], v[96:99], v[184:187], v[48:51]
    ds_read_b64_tr_b16 v[80:81], v10 offset:0
    v_mfma_f32_16x16x32_bf16 v[52:55], v[96:99], v[188:191], v[52:55]
    ds_read_b64_tr_b16 v[82:83], v11 offset:0
    s_waitcnt lgkmcnt(6)
    v_mfma_f32_16x16x32_bf16 v[56:59], v[100:103], v[184:187], v[56:59]
    ds_read_b64_tr_b16 v[84:85], v10 offset:1024
    v_mfma_f32_16x16x32_bf16 v[60:63], v[100:103], v[188:191], v[60:63]
    ds_read_b64_tr_b16 v[86:87], v11 offset:1024
    s_waitcnt lgkmcnt(6)
    v_mfma_f32_16x16x32_bf16 v[64:67], v[104:107], v[184:187], v[64:67]
    ds_read_b64_tr_b16 v[88:89], v10 offset:2048
    v_mfma_f32_16x16x32_bf16 v[68:71], v[104:107], v[188:191], v[68:71]
    ds_read_b64_tr_b16 v[90:91], v11 offset:2048
    s_waitcnt lgkmcnt(6)
    v_mfma_f32_16x16x32_bf16 v[72:75], v[108:111], v[184:187], v[72:75]
    ds_read_b64_tr_b16 v[92:93], v10 offset:3072
    v_mfma_f32_16x16x32_bf16 v[76:79], v[108:111], v[188:191], v[76:79]
    ds_read_b64_tr_b16 v[94:95], v11 offset:3072
    s_waitcnt lgkmcnt(6)
    v_mfma_f32_16x16x32_bf16 v[16:19], v[80:83], v[192:195], v[16:19]
    ds_read_b64_tr_b16 v[96:97], v10 offset:512
    v_mfma_f32_16x16x32_bf16 v[20:23], v[80:83], v[196:199], v[20:23]
    ds_read_b64_tr_b16 v[98:99], v11 offset:512
    s_waitcnt lgkmcnt(6)
    v_mfma_f32_16x16x32_bf16 v[24:27], v[84:87], v[192:195], v[24:27]
    ds_read_b64_tr_b16 v[100:101], v10 offset:1536
    v_mfma_f32_16x16x32_bf16 v[28:31], v[84:87], v[196:199], v[28:31]
    ds_read_b64_tr_b16 v[102:103], v11 offset:1536
    s_waitcnt lgkmcnt(6)
    v_mfma_f32_16x16x32_bf16 v[32:35], v[88:91], v[192:195], v[32:35]
    ds_read_b64_tr_b16 v[104:105], v10 offset:2560
    v_mfma_f32_16x16x32_bf16 v[36:39], v[88:91], v[196:199], v[36:39]
    ds_read_b64_tr_b16 v[106:107], v11 offset:2560
    s_waitcnt lgkmcnt(6)
    v_mfma_f32_16x16x32_bf16 v[40:43], v[92:95], v[192:195], v[40:43]
    ds_read_b64_tr_b16 v[108:109], v10 offset:3584
    v_mfma_f32_16x16x32_bf16 v[44:47], v[92:95], v[196:199], v[44:47]
    ds_read_b64_tr_b16 v[110:111], v11 offset:3584
    s_waitcnt lgkmcnt(6)
    v_mfma_f32_16x16x32_bf16 v[48:51], v[96:99], v[192:195], v[48:51]
    ds_read_b64_tr_b16 v[80:81], v10 offset:8192
    v_mfma_f32_16x16x32_bf16 v[52:55], v[96:99], v[196:199], v[52:55]
    ds_read_b64_tr_b16 v[82:83], v11 offset:8192
    s_waitcnt lgkmcnt(6)
    v_mfma_f32_16x16x32_bf16 v[56:59], v[100:103], v[192:195], v[56:59]
    ds_read_b64_tr_b16 v[84:85], v10 offset:9216
    v_mfma_f32_16x16x32_bf16 v[60:63], v[100:103], v[196:199], v[60:63]
    ds_read_b64_tr_b16 v[86:87], v11 offset:9216
    s_waitcnt lgkmcnt(6)
    v_mfma_f32_16x16x32_bf16 v[64:67], v[104:107], v[192:195], v[64:67]
    ds_read_b64_tr_b16 v[88:89], v10 offset:10240
    v_mfma_f32_16x16x32_bf16 v[68:71], v[104:107], v[196:199], v[68:71]
    ds_read_b64_tr_b16 v[90:91], v11 offset:10240
    s_waitcnt lgkmcnt(6)
    v_mfma_f32_16x16x32_bf16 v[72:75], v[108:111], v[192:195], v[72:75]
    ds_read_b64_tr_b16 v[92:93], v10 offset:11264
    v_mfma_f32_16x16x32_bf16 v[76:79], v[108:111], v[196:199], v[76:79]
    ds_read_b64_tr_b16 v[94:95], v11 offset:11264
    s_waitcnt lgkmcnt(6)
    v_mfma_f32_16x16x32_bf16 v[16:19], v[80:83], v[200:203], v[16:19]
    ds_read_b64_tr_b16 v[96:97], v10 offset:8704
    v_mfma_f32_16x16x32_bf16 v[20:23], v[80:83], v[204:207], v[20:23]
    ds_read_b64_tr_b16 v[98:99], v11 offset:8704
    s_waitcnt lgkmcnt(6)
    v_mfma_f32_16x16x32_bf16 v[24:27], v[84:87], v[200:203], v[24:27]
    ds_read_b64_tr_b16 v[100:101], v10 offset:9728
    v_mfma_f32_16x16x32_bf16 v[28:31], v[84:87], v[204:207], v[28:31]
    ds_read_b64_tr_b16 v[102:103], v11 offset:9728
    s_waitcnt lgkmcnt(6)
    v_mfma_f32_16x16x32_bf16 v[32:35], v[88:91], v[200:203], v[32:35]
    ds_read_b64_tr_b16 v[104:105], v10 offset:10752
    v_mfma_f32_16x16x32_bf16 v[36:39], v[88:91], v[204:207], v[36:39]
    ds_read_b64_tr_b16 v[106:107], v11 offset:10752
    s_waitcnt lgkmcnt(6)
    v_mfma_f32_16x16x32_bf16 v[40:43], v[92:95], v[200:203], v[40:43]
    ds_read_b64_tr_b16 v[108:109], v10 offset:11776
    v_mfma_f32_16x16x32_bf16 v[44:47], v[92:95], v[204:207], v[44:47]
    ds_read_b64_tr_b16 v[110:111], v11 offset:11776
    v_add_u32 v10, 32768, v14
    v_xor_b32 v11, 64, v10
    s_barrier
    s_waitcnt lgkmcnt(6)
    v_mfma_f32_16x16x32_bf16 v[48:51], v[96:99], v[200:203], v[48:51]
    ds_read_b64_tr_b16 v[80:81], v10 offset:0
    v_mfma_f32_16x16x32_bf16 v[52:55], v[96:99], v[204:207], v[52:55]
    ds_read_b64_tr_b16 v[82:83], v11 offset:0
    s_waitcnt lgkmcnt(6)
    v_mfma_f32_16x16x32_bf16 v[56:59], v[100:103], v[200:203], v[56:59]
    ds_read_b64_tr_b16 v[84:85], v10 offset:1024
    v_mfma_f32_16x16x32_bf16 v[60:63], v[100:103], v[204:207], v[60:63]
    ds_read_b64_tr_b16 v[86:87], v11 offset:1024
    s_waitcnt lgkmcnt(6)
    v_mfma_f32_16x16x32_bf16 v[64:67], v[104:107], v[200:203], v[64:67]
    ds_read_b64_tr_b16 v[88:89], v10 offset:2048
    v_mfma_f32_16x16x32_bf16 v[68:71], v[104:107], v[204:207], v[68:71]
    ds_read_b64_tr_b16 v[90:91], v11 offset:2048
    s_waitcnt lgkmcnt(6)
    v_mfma_f32_16x16x32_bf16 v[72:75], v[108:111], v[200:203], v[72:75]
    ds_read_b64_tr_b16 v[92:93], v10 offset:3072
    v_mfma_f32_16x16x32_bf16 v[76:79], v[108:111], v[204:207], v[76:79]
    ds_read_b64_tr_b16 v[94:95], v11 offset:3072
    s_waitcnt lgkmcnt(6)
    v_mfma_f32_16x16x32_bf16 v[16:19], v[80:83], v[208:211], v[16:19]
    ds_read_b64_tr_b16 v[96:97], v10 offset:512
    v_mfma_f32_16x16x32_bf16 v[20:23], v[80:83], v[212:215], v[20:23]
    ds_read_b64_tr_b16 v[98:99], v11 offset:512
    s_waitcnt lgkmcnt(6)
    v_mfma_f32_16x16x32_bf16 v[24:27], v[84:87], v[208:211], v[24:27]
    ds_read_b64_tr_b16 v[100:101], v10 offset:1536
    v_mfma_f32_16x16x32_bf16 v[28:31], v[84:87], v[212:215], v[28:31]
    ds_read_b64_tr_b16 v[102:103], v11 offset:1536
    s_waitcnt lgkmcnt(6)
    v_mfma_f32_16x16x32_bf16 v[32:35], v[88:91], v[208:211], v[32:35]
    ds_read_b64_tr_b16 v[104:105], v10 offset:2560
    v_mfma_f32_16x16x32_bf16 v[36:39], v[88:91], v[212:215], v[36:39]
    ds_read_b64_tr_b16 v[106:107], v11 offset:2560
    s_waitcnt lgkmcnt(6)
    v_mfma_f32_16x16x32_bf16 v[40:43], v[92:95], v[208:211], v[40:43]
    ds_read_b64_tr_b16 v[108:109], v10 offset:3584
    v_mfma_f32_16x16x32_bf16 v[44:47], v[92:95], v[212:215], v[44:47]
    ds_read_b64_tr_b16 v[110:111], v11 offset:3584
    s_waitcnt lgkmcnt(6)
    v_mfma_f32_16x16x32_bf16 v[48:51], v[96:99], v[208:211], v[48:51]
    ds_read_b64_tr_b16 v[80:81], v10 offset:8192
    v_mfma_f32_16x16x32_bf16 v[52:55], v[96:99], v[212:215], v[52:55]
    ds_read_b64_tr_b16 v[82:83], v11 offset:8192
    s_waitcnt lgkmcnt(6)
    v_mfma_f32_16x16x32_bf16 v[56:59], v[100:103], v[208:211], v[56:59]
    ds_read_b64_tr_b16 v[84:85], v10 offset:9216
    v_mfma_f32_16x16x32_bf16 v[60:63], v[100:103], v[212:215], v[60:63]
    ds_read_b64_tr_b16 v[86:87], v11 offset:9216
    s_waitcnt lgkmcnt(6)
    v_mfma_f32_16x16x32_bf16 v[64:67], v[104:107], v[208:211], v[64:67]
    ds_read_b64_tr_b16 v[88:89], v10 offset:10240
    v_mfma_f32_16x16x32_bf16 v[68:71], v[104:107], v[212:215], v[68:71]
    ds_read_b64_tr_b16 v[90:91], v11 offset:10240
    s_waitcnt lgkmcnt(6)
    v_mfma_f32_16x16x32_bf16 v[72:75], v[108:111], v[208:211], v[72:75]
    ds_read_b64_tr_b16 v[92:93], v10 offset:11264
    v_mfma_f32_16x16x32_bf16 v[76:79], v[108:111], v[212:215], v[76:79]
    ds_read_b64_tr_b16 v[94:95], v11 offset:11264
    s_waitcnt lgkmcnt(6)
    v_mfma_f32_16x16x32_bf16 v[16:19], v[80:83], v[216:219], v[16:19]
    ds_read_b64_tr_b16 v[96:97], v10 offset:8704
    v_mfma_f32_16x16x32_bf16 v[20:23], v[80:83], v[220:223], v[20:23]
    ds_read_b64_tr_b16 v[98:99], v11 offset:8704
    s_waitcnt lgkmcnt(6)
    v_mfma_f32_16x16x32_bf16 v[24:27], v[84:87], v[216:219], v[24:27]
    ds_read_b64_tr_b16 v[100:101], v10 offset:9728
    v_mfma_f32_16x16x32_bf16 v[28:31], v[84:87], v[220:223], v[28:31]
    ds_read_b64_tr_b16 v[102:103], v11 offset:9728
    s_waitcnt lgkmcnt(6)
    v_mfma_f32_16x16x32_bf16 v[32:35], v[88:91], v[216:219], v[32:35]
    ds_read_b64_tr_b16 v[104:105], v10 offset:10752
    v_mfma_f32_16x16x32_bf16 v[36:39], v[88:91], v[220:223], v[36:39]
    ds_read_b64_tr_b16 v[106:107], v11 offset:10752
    s_waitcnt lgkmcnt(6)
    v_mfma_f32_16x16x32_bf16 v[40:43], v[92:95], v[216:219], v[40:43]
    ds_read_b64_tr_b16 v[108:109], v10 offset:11776
    v_mfma_f32_16x16x32_bf16 v[44:47], v[92:95], v[220:223], v[44:47]
    ds_read_b64_tr_b16 v[110:111], v11 offset:11776
    v_add_u32 v10, 65536, v14
    v_xor_b32 v11, 64, v10
    s_barrier
    s_waitcnt lgkmcnt(6)
    v_mfma_f32_16x16x32_bf16 v[48:51], v[96:99], v[216:219], v[48:51]
    ds_read_b64_tr_b16 v[80:81], v10 offset:0
    v_mfma_f32_16x16x32_bf16 v[52:55], v[96:99], v[220:223], v[52:55]
    ds_read_b64_tr_b16 v[82:83], v11 offset:0
    s_waitcnt lgkmcnt(6)
    v_mfma_f32_16x16x32_bf16 v[56:59], v[100:103], v[216:219], v[56:59]
    ds_read_b64_tr_b16 v[84:85], v10 offset:1024
    v_mfma_f32_16x16x32_bf16 v[60:63], v[100:103], v[220:223], v[60:63]
    ds_read_b64_tr_b16 v[86:87], v11 offset:1024
    s_waitcnt lgkmcnt(6)
    v_mfma_f32_16x16x32_bf16 v[64:67], v[104:107], v[216:219], v[64:67]
    ds_read_b64_tr_b16 v[88:89], v10 offset:2048
    v_mfma_f32_16x16x32_bf16 v[68:71], v[104:107], v[220:223], v[68:71]
    ds_read_b64_tr_b16 v[90:91], v11 offset:2048
    s_waitcnt lgkmcnt(6)
    v_mfma_f32_16x16x32_bf16 v[72:75], v[108:111], v[216:219], v[72:75]
    ds_read_b64_tr_b16 v[92:93], v10 offset:3072
    v_mfma_f32_16x16x32_bf16 v[76:79], v[108:111], v[220:223], v[76:79]
    ds_read_b64_tr_b16 v[94:95], v11 offset:3072
    s_waitcnt lgkmcnt(6)
    v_mfma_f32_16x16x32_bf16 v[16:19], v[80:83], v[224:227], v[16:19]
    ds_read_b64_tr_b16 v[96:97], v10 offset:512
    v_mfma_f32_16x16x32_bf16 v[20:23], v[80:83], v[228:231], v[20:23]
    ds_read_b64_tr_b16 v[98:99], v11 offset:512
    s_waitcnt lgkmcnt(6)
    v_mfma_f32_16x16x32_bf16 v[24:27], v[84:87], v[224:227], v[24:27]
    ds_read_b64_tr_b16 v[100:101], v10 offset:1536
    v_mfma_f32_16x16x32_bf16 v[28:31], v[84:87], v[228:231], v[28:31]
    ds_read_b64_tr_b16 v[102:103], v11 offset:1536
    s_waitcnt lgkmcnt(6)
    v_mfma_f32_16x16x32_bf16 v[32:35], v[88:91], v[224:227], v[32:35]
    ds_read_b64_tr_b16 v[104:105], v10 offset:2560
    v_mfma_f32_16x16x32_bf16 v[36:39], v[88:91], v[228:231], v[36:39]
    ds_read_b64_tr_b16 v[106:107], v11 offset:2560
    s_waitcnt lgkmcnt(6)
    v_mfma_f32_16x16x32_bf16 v[40:43], v[92:95], v[224:227], v[40:43]
    ds_read_b64_tr_b16 v[108:109], v10 offset:3584
    v_mfma_f32_16x16x32_bf16 v[44:47], v[92:95], v[228:231], v[44:47]
    ds_read_b64_tr_b16 v[110:111], v11 offset:3584
    s_waitcnt lgkmcnt(6)
    v_mfma_f32_16x16x32_bf16 v[48:51], v[96:99], v[224:227], v[48:51]
    ds_read_b64_tr_b16 v[80:81], v10 offset:8192
    v_mfma_f32_16x16x32_bf16 v[52:55], v[96:99], v[228:231], v[52:55]
    ds_read_b64_tr_b16 v[82:83], v11 offset:8192
    s_waitcnt lgkmcnt(6)
    v_mfma_f32_16x16x32_bf16 v[56:59], v[100:103], v[224:227], v[56:59]
    ds_read_b64_tr_b16 v[84:85], v10 offset:9216
    v_mfma_f32_16x16x32_bf16 v[60:63], v[100:103], v[228:231], v[60:63]
    ds_read_b64_tr_b16 v[86:87], v11 offset:9216
    s_waitcnt lgkmcnt(6)
    v_mfma_f32_16x16x32_bf16 v[64:67], v[104:107], v[224:227], v[64:67]
    ds_read_b64_tr_b16 v[88:89], v10 offset:10240
    v_mfma_f32_16x16x32_bf16 v[68:71], v[104:107], v[228:231], v[68:71]
    ds_read_b64_tr_b16 v[90:91], v11 offset:10240
    s_waitcnt lgkmcnt(6)
    v_mfma_f32_16x16x32_bf16 v[72:75], v[108:111], v[224:227], v[72:75]
    ds_read_b64_tr_b16 v[92:93], v10 offset:11264
    v_mfma_f32_16x16x32_bf16 v[76:79], v[108:111], v[228:231], v[76:79]
    ds_read_b64_tr_b16 v[94:95], v11 offset:11264
    s_waitcnt lgkmcnt(6)
    v_mfma_f32_16x16x32_bf16 v[16:19], v[80:83], v[232:235], v[16:19]
    ds_read_b64_tr_b16 v[96:97], v10 offset:8704
    v_mfma_f32_16x16x32_bf16 v[20:23], v[80:83], v[236:239], v[20:23]
    ds_read_b64_tr_b16 v[98:99], v11 offset:8704
    s_waitcnt lgkmcnt(6)
    v_mfma_f32_16x16x32_bf16 v[24:27], v[84:87], v[232:235], v[24:27]
    ds_read_b64_tr_b16 v[100:101], v10 offset:9728
    v_mfma_f32_16x16x32_bf16 v[28:31], v[84:87], v[236:239], v[28:31]
    ds_read_b64_tr_b16 v[102:103], v11 offset:9728
    s_waitcnt lgkmcnt(6)
    v_mfma_f32_16x16x32_bf16 v[32:35], v[88:91], v[232:235], v[32:35]
    ds_read_b64_tr_b16 v[104:105], v10 offset:10752
    v_mfma_f32_16x16x32_bf16 v[36:39], v[88:91], v[236:239], v[36:39]
    ds_read_b64_tr_b16 v[106:107], v11 offset:10752
    s_waitcnt lgkmcnt(6)
    v_mfma_f32_16x16x32_bf16 v[40:43], v[92:95], v[232:235], v[40:43]
    ds_read_b64_tr_b16 v[108:109], v10 offset:11776
    v_mfma_f32_16x16x32_bf16 v[44:47], v[92:95], v[236:239], v[44:47]
    ds_read_b64_tr_b16 v[110:111], v11 offset:11776
    v_add_u32 v10, 98304, v14
    v_xor_b32 v11, 64, v10
    s_barrier
    s_waitcnt lgkmcnt(6)
    v_mfma_f32_16x16x32_bf16 v[48:51], v[96:99], v[232:235], v[48:51]
    ds_read_b64_tr_b16 v[80:81], v10 offset:0
    v_mfma_f32_16x16x32_bf16 v[52:55], v[96:99], v[236:239], v[52:55]
    ds_read_b64_tr_b16 v[82:83], v11 offset:0
    s_waitcnt lgkmcnt(6)
    v_mfma_f32_16x16x32_bf16 v[56:59], v[100:103], v[232:235], v[56:59]
    ds_read_b64_tr_b16 v[84:85], v10 offset:8192
    v_mfma_f32_16x16x32_bf16 v[60:63], v[100:103], v[236:239], v[60:63]
    ds_read_b64_tr_b16 v[86:87], v11 offset:8192
    s_waitcnt lgkmcnt(6)
    v_mfma_f32_16x16x32_bf16 v[64:67], v[104:107], v[232:235], v[64:67]
    ds_read_b64_tr_b16 v[88:89], v10 offset:1024
    v_mfma_f32_16x16x32_bf16 v[68:71], v[104:107], v[236:239], v[68:71]
    ds_read_b64_tr_b16 v[90:91], v11 offset:1024
    s_waitcnt lgkmcnt(6)
    v_mfma_f32_16x16x32_bf16 v[72:75], v[108:111], v[232:235], v[72:75]
    ds_read_b64_tr_b16 v[92:93], v10 offset:9216
    v_mfma_f32_16x16x32_bf16 v[76:79], v[108:111], v[236:239], v[76:79]
    ds_read_b64_tr_b16 v[94:95], v11 offset:9216
    s_waitcnt lgkmcnt(6)
    v_mfma_f32_16x16x32_bf16 v[16:19], v[80:83], v[240:243], v[16:19]
    ds_read_b64_tr_b16 v[96:97], v10 offset:2048
    v_mfma_f32_16x16x32_bf16 v[20:23], v[80:83], v[244:247], v[20:23]
    ds_read_b64_tr_b16 v[98:99], v11 offset:2048
    s_waitcnt lgkmcnt(6)
    v_mfma_f32_16x16x32_bf16 v[16:19], v[84:87], v[248:251], v[16:19]
    ds_read_b64_tr_b16 v[100:101], v10 offset:10240
    v_mfma_f32_16x16x32_bf16 v[20:23], v[84:87], v[252:255], v[20:23]
    ds_read_b64_tr_b16 v[102:103], v11 offset:10240
    s_waitcnt lgkmcnt(6)
    v_mfma_f32_16x16x32_bf16 v[24:27], v[88:91], v[240:243], v[24:27]
    ds_read_b64_tr_b16 v[104:105], v10 offset:3072
    v_mfma_f32_16x16x32_bf16 v[28:31], v[88:91], v[244:247], v[28:31]
    ds_read_b64_tr_b16 v[106:107], v11 offset:3072
    s_waitcnt lgkmcnt(6)
    v_mfma_f32_16x16x32_bf16 v[24:27], v[92:95], v[248:251], v[24:27]
    ds_read_b64_tr_b16 v[108:109], v10 offset:11264
    v_mfma_f32_16x16x32_bf16 v[28:31], v[92:95], v[252:255], v[28:31]
    ds_read_b64_tr_b16 v[110:111], v11 offset:11264
    s_waitcnt lgkmcnt(6)
    v_mfma_f32_16x16x32_bf16 v[32:35], v[96:99], v[240:243], v[32:35]
    ds_read_b64_tr_b16 v[80:81], v10 offset:512
    ds_write_addtid_b32 v16 offset:0
    ds_write_addtid_b32 v17 offset:256
    v_mfma_f32_16x16x32_bf16 v[36:39], v[96:99], v[244:247], v[36:39]
    ds_read_b64_tr_b16 v[82:83], v11 offset:512
    ds_write_addtid_b32 v18 offset:512
    ds_write_addtid_b32 v19 offset:768
    s_waitcnt lgkmcnt(10)
    v_mfma_f32_16x16x32_bf16 v[32:35], v[100:103], v[248:251], v[32:35]
    ds_read_b64_tr_b16 v[84:85], v10 offset:8704
    ds_write_addtid_b32 v20 offset:1024
    ds_write_addtid_b32 v21 offset:1280
    v_mfma_f32_16x16x32_bf16 v[36:39], v[100:103], v[252:255], v[36:39]
    ds_read_b64_tr_b16 v[86:87], v11 offset:8704
    ds_write_addtid_b32 v22 offset:1536
    ds_write_addtid_b32 v23 offset:1792
    s_waitcnt lgkmcnt(14)
    v_mfma_f32_16x16x32_bf16 v[40:43], v[104:107], v[240:243], v[40:43]
    ds_read_b64_tr_b16 v[88:89], v10 offset:1536
    ds_write_addtid_b32 v24 offset:2048
    ds_write_addtid_b32 v25 offset:2304
    v_mfma_f32_16x16x32_bf16 v[44:47], v[104:107], v[244:247], v[44:47]
    ds_read_b64_tr_b16 v[90:91], v11 offset:1536
    ds_write_addtid_b32 v26 offset:2560
    ds_write_addtid_b32 v27 offset:2816
    s_waitcnt lgkmcnt(14)
    v_mfma_f32_16x16x32_bf16 v[40:43], v[108:111], v[248:251], v[40:43]
    ds_read_b64_tr_b16 v[92:93], v10 offset:9728
    ds_write_addtid_b32 v28 offset:3072
    ds_write_addtid_b32 v29 offset:3328
    v_mfma_f32_16x16x32_bf16 v[44:47], v[108:111], v[252:255], v[44:47]
    ds_read_b64_tr_b16 v[94:95], v11 offset:9728
    ds_write_addtid_b32 v30 offset:3584
    ds_write_addtid_b32 v31 offset:3840
    v_mfma_f32_16x16x32_bf16 v[48:51], v[80:83], v[240:243], v[48:51]
    ds_read_b64_tr_b16 v[96:97], v10 offset:2560
    ds_write_addtid_b32 v32 offset:4096
    ds_write_addtid_b32 v33 offset:4352
    v_mfma_f32_16x16x32_bf16 v[52:55], v[80:83], v[244:247], v[52:55]
    ds_read_b64_tr_b16 v[98:99], v11 offset:2560
    ds_write_addtid_b32 v34 offset:4608
    ds_write_addtid_b32 v35 offset:4864
    s_waitcnt lgkmcnt(14)
    v_mfma_f32_16x16x32_bf16 v[48:51], v[84:87], v[248:251], v[48:51]
    ds_read_b64_tr_b16 v[100:101], v10 offset:10752
    ds_write_addtid_b32 v36 offset:5120
    ds_write_addtid_b32 v37 offset:5376
    v_mfma_f32_16x16x32_bf16 v[52:55], v[84:87], v[252:255], v[52:55]
    ds_read_b64_tr_b16 v[102:103], v11 offset:10752
    ds_write_addtid_b32 v38 offset:5632
    ds_write_addtid_b32 v39 offset:5888
    v_mfma_f32_16x16x32_bf16 v[56:59], v[88:91], v[240:243], v[56:59]
    ds_read_b64_tr_b16 v[104:105], v10 offset:3584
    ds_write_addtid_b32 v40 offset:6144
    ds_write_addtid_b32 v41 offset:6400
    v_mfma_f32_16x16x32_bf16 v[60:63], v[88:91], v[244:247], v[60:63]
    ds_read_b64_tr_b16 v[106:107], v11 offset:3584
    ds_write_addtid_b32 v42 offset:6656
    ds_write_addtid_b32 v43 offset:6912
    s_waitcnt lgkmcnt(14)
    v_mfma_f32_16x16x32_bf16 v[56:59], v[92:95], v[248:251], v[56:59]
    ds_read_b64_tr_b16 v[108:109], v10 offset:11776
    ds_write_addtid_b32 v44 offset:7168
    ds_write_addtid_b32 v45 offset:7424
    v_mfma_f32_16x16x32_bf16 v[60:63], v[92:95], v[252:255], v[60:63]
    ds_read_b64_tr_b16 v[110:111], v11 offset:11776
    ds_write_addtid_b32 v46 offset:7680
    ds_write_addtid_b32 v47 offset:7936
    s_waitcnt lgkmcnt(0)
    s_barrier
    v_mfma_f32_16x16x32_bf16 v[64:67], v[96:99], v[240:243], v[64:67]
    ds_write_addtid_b32 v48 offset:8192
    ds_write_addtid_b32 v49 offset:8448
    v_mfma_f32_16x16x32_bf16 v[68:71], v[96:99], v[244:247], v[68:71]
    ds_write_addtid_b32 v50 offset:8704
    ds_write_addtid_b32 v51 offset:8960
    v_mfma_f32_16x16x32_bf16 v[64:67], v[100:103], v[248:251], v[64:67]
    ds_write_addtid_b32 v52 offset:9216
    ds_write_addtid_b32 v53 offset:9472
    v_mfma_f32_16x16x32_bf16 v[68:71], v[100:103], v[252:255], v[68:71]
    ds_write_addtid_b32 v54 offset:9728
    ds_write_addtid_b32 v55 offset:9984
    v_mfma_f32_16x16x32_bf16 v[72:75], v[104:107], v[240:243], v[72:75]
    ds_write_addtid_b32 v56 offset:10240
    ds_write_addtid_b32 v57 offset:10496
    v_mfma_f32_16x16x32_bf16 v[76:79], v[104:107], v[244:247], v[76:79]
    ds_write_addtid_b32 v58 offset:10752
    ds_write_addtid_b32 v59 offset:11008
    v_mfma_f32_16x16x32_bf16 v[72:75], v[108:111], v[248:251], v[72:75]
    ds_write_addtid_b32 v60 offset:11264
    ds_write_addtid_b32 v61 offset:11520
    v_mfma_f32_16x16x32_bf16 v[76:79], v[108:111], v[252:255], v[76:79]
    ds_write_addtid_b32 v62 offset:11776
    ds_write_addtid_b32 v63 offset:12032
    ds_write_addtid_b32 v64 offset:12288
    ds_write_addtid_b32 v65 offset:12544
    ds_write_addtid_b32 v66 offset:12800
    ds_write_addtid_b32 v67 offset:13056
    ds_write_addtid_b32 v68 offset:13312
    ds_write_addtid_b32 v69 offset:13568
    ds_write_addtid_b32 v70 offset:13824
    ds_write_addtid_b32 v71 offset:14080
    ds_write_addtid_b32 v72 offset:14336
    ds_write_addtid_b32 v73 offset:14592
    ds_write_addtid_b32 v74 offset:14848
    ds_write_addtid_b32 v75 offset:15104
    ds_write_addtid_b32 v76 offset:15360
    ds_write_addtid_b32 v77 offset:15616
    ds_write_addtid_b32 v78 offset:15872
    ds_write_addtid_b32 v79 offset:16128
    s_waitcnt lgkmcnt(0)
    s_barrier
    s_endpgm
role_b:
    s_cmp_lt_u32 s2, 184
    s_cbranch_scc1 role_p
    s_cmp_lt_u32 s3, 4
    s_cbranch_scc1 role_bc
role_bh:
    s_sub_u32 s49, s2, 184
    s_and_b32 s48, s49, 7
    s_mul_i32 s48, s48, 9
    s_lshr_b32 s49, s49, 3
    s_add_u32 s48, s48, s49
    s_mov_b32 s51, s49
    s_and_b32 s52, s3, 3
    v_and_b32 v1, 63, v0
    v_mul_u32_u24 v4, 2304, v1
    s_lshl_b32 s49, s48, 4
    s_mul_i32 s55, s52, 294912
    s_add_u32 s55, s55, s49
    v_mov_b32 v3, 0x7fffffff
    v_mov_b32 v5, 146304
    v_cmp_eq_u32 vcc, 0, v1
    s_nop 1
    v_cndmask_b32 v5, v3, v5, vcc
    s_sub_u32 s50, s55, 1152
    v_mov_b32 v6, s50
    v_cndmask_b32 v6, v3, v6, vcc
    v_cmp_eq_u32 vcc, 256, v0
    s_nop 1
    v_cndmask_b32 v6, v6, v3, vcc
    v_bfe_u32 v7, v0, 1, 7
    v_and_b32 v8, 1, v0
    v_lshl_add_u32 v3, v8, 3, s49
    s_waitcnt lgkmcnt(0)
    s_mov_b64 s[4:5], s[82:83]
    s_mov_b64 s[8:9], s[94:95]
    s_mov_b64 s[10:11], s[96:97]
    s_mov_b64 s[12:13], s[98:99]
    s_mov_b64 s[14:15], s[100:101]
    s_mov_b64 s[16:17], s[70:71]
    s_mov_b64 s[18:19], s[72:73]
    s_mov_b64 s[20:21], s[74:75]
    s_mov_b64 s[22:23], s[76:77]
    s_mov_b32 s24, s4
    s_mov_b32 s25, s5
    s_mov_b32 s26, 2359296
    s_mov_b32 s27, 0x00020000
    s_barrier
    buffer_load_dwordx4 v[24:27], v6, s[24:27], 0 offen
    s_add_u32 s49, s55, 0
    buffer_load_dwordx4 v[16:19], v4, s[24:27], s49 offen
    buffer_load_dwordx4 v[20:23], v4, s[24:27], s49 offen offset:1152
    s_add_u32 s49, s55, 0
    buffer_load_dwordx4 v[36:39], v5, s[24:27], s49 offen
    s_add_u32 s49, s55, 147456
    buffer_load_dwordx4 v[28:31], v4, s[24:27], s49 offen
    buffer_load_dwordx4 v[32:35], v4, s[24:27], s49 offen offset:1152
    global_load_dwordx2 v[64:65], v3, s[8:9]
    s_add_u32 s49, s55, 1032192
    buffer_load_dwordx4 v[48:51], v5, s[24:27], s49 offen
    s_add_u32 s49, s55, 1179648
    buffer_load_dwordx4 v[40:43], v4, s[24:27], s49 offen
    buffer_load_dwordx4 v[44:47], v4, s[24:27], s49 offen offset:1152
    s_mov_b32 s28, s10
    s_mov_b32 s29, s11
    s_mov_b32 s30, 9437184
    s_mov_b32 s31, 0x00020000
    s_mov_b32 s53, 0x05040100
    s_mov_b32 s54, 0x07060302
    v_mul_u32_u24 v9, 33344, v8
    v_lshl_add_u32 v9, v7, 4, v9
    v_mul_u32_u24 v10, 36864, v7
    v_lshl_add_u32 v10, v8, 4, v10
    s_lshl_b32 s56, s52, 9
    v_mov_b32 v192, 0
    v_bfe_u32 v2, v1, 3, 2
    v_and_b32 v3, 7, v1
    v_cmp_gt_u32 vcc, 32, v1
    v_or_b32 v193, 2, v2
    s_nop 0
    v_cndmask_b32 v2, v193, v2, vcc
    v_cndmask_b32 v3, 8, v3, vcc
    v_mul_u32_u24 v2, 4160, v2
    v_lshl_add_u32 v2, v3, 2, v2
    s_mul_i32 s50, s52, 16640
    s_lshr_b32 s49, s52, 1
    s_lshl_b32 s49, s49, 6
    s_add_u32 s50, s50, s49
    s_add_u32 s50, s50, 73728
    v_add_u32 v2, s50, v2
    ds_write_b32 v2, v192
    s_waitcnt vmcnt(7)
    v_mov_b32_dpp v24, v20 wave_shr:1 row_mask:0xf bank_mask:0xf
    v_mov_b32_dpp v25, v21 wave_shr:1 row_mask:0xf bank_mask:0xf
    v_mov_b32_dpp v26, v22 wave_shr:1 row_mask:0xf bank_mask:0xf
    v_mov_b32_dpp v27, v23 wave_shr:1 row_mask:0xf bank_mask:0xf
    s_add_u32 m0, s56, 73728
.p2align 3
    v_perm_b32 v200, v20, v16, s53
    v_perm_b32 v201, v16, v24, s53
    ds_write_addtid_b32 v200 offset:32
    ds_write_addtid_b32 v201 offset:4192
    ds_write_addtid_b32 v200 offset:8356
    ds_write_addtid_b32 v201 offset:12516
    v_perm_b32 v202, v20, v16, s54
    v_perm_b32 v203, v16, v24, s54
    ds_write_addtid_b32 v202 offset:16672
    ds_write_addtid_b32 v203 offset:20832
    ds_write_addtid_b32 v202 offset:24996
    ds_write_addtid_b32 v203 offset:29156
    v_perm_b32 v204, v22, v18, s53
    v_perm_b32 v205, v18, v26, s53
    ds_write_addtid_b32 v204 offset:33376
    ds_write_addtid_b32 v205 offset:37536
    ds_write_addtid_b32 v204 offset:41700
    ds_write_addtid_b32 v205 offset:45860
    v_perm_b32 v206, v22, v18, s54
    v_perm_b32 v207, v18, v26, s54
    ds_write_addtid_b32 v206 offset:50016
    ds_write_addtid_b32 v207 offset:54176
    ds_write_addtid_b32 v206 offset:58340
    ds_write_addtid_b32 v207 offset:62500
    s_waitcnt vmcnt(4)
    v_mov_b32_dpp v36, v32 wave_shr:1 row_mask:0xf bank_mask:0xf
    v_mov_b32_dpp v37, v33 wave_shr:1 row_mask:0xf bank_mask:0xf
    v_mov_b32_dpp v38, v34 wave_shr:1 row_mask:0xf bank_mask:0xf
    v_mov_b32_dpp v39, v35 wave_shr:1 row_mask:0xf bank_mask:0xf
    s_add_u32 m0, s56, 73984
.p2align 3
    v_perm_b32 v200, v32, v28, s53
    v_perm_b32 v201, v28, v36, s53
    ds_write_addtid_b32 v200 offset:32
    ds_write_addtid_b32 v201 offset:4192
    ds_write_addtid_b32 v200 offset:8356
    ds_write_addtid_b32 v201 offset:12516
    v_perm_b32 v202, v32, v28, s54
    v_perm_b32 v203, v28, v36, s54
    ds_write_addtid_b32 v202 offset:16672
    ds_write_addtid_b32 v203 offset:20832
    ds_write_addtid_b32 v202 offset:24996
    ds_write_addtid_b32 v203 offset:29156
    v_perm_b32 v204, v34, v30, s53
    v_perm_b32 v205, v30, v38, s53
    ds_write_addtid_b32 v204 offset:33376
    ds_write_addtid_b32 v205 offset:37536
    ds_write_addtid_b32 v204 offset:41700
    ds_write_addtid_b32 v205 offset:45860
    v_perm_b32 v206, v34, v30, s54
    v_perm_b32 v207, v30, v38, s54
    ds_write_addtid_b32 v206 offset:50016
    ds_write_addtid_b32 v207 offset:54176
    ds_write_addtid_b32 v206 offset:58340
    ds_write_addtid_b32 v207 offset:62500
    s_waitcnt lgkmcnt(0)
    s_add_u32 s49, s55, 1179648
    buffer_load_dwordx4 v[60:63], v5, s[24:27], s49 offen
    s_add_u32 s49, s55, 1327104
    buffer_load_dwordx4 v[52:55], v4, s[24:27], s49 offen
    buffer_load_dwordx4 v[56:59], v4, s[24:27], s49 offen offset:1152
    s_setprio 1
    s_barrier
    s_waitcnt vmcnt(3)
    v_mov_b32_dpp v48, v44 wave_shr:1 row_mask:0xf bank_mask:0xf
    v_mov_b32_dpp v49, v45 wave_shr:1 row_mask:0xf bank_mask:0xf
    v_mov_b32_dpp v50, v46 wave_shr:1 row_mask:0xf bank_mask:0xf
    v_mov_b32_dpp v51, v47 wave_shr:1 row_mask:0xf bank_mask:0xf
    s_add_u32 m0, s56, 75776
.p2align 3
    v_perm_b32 v200, v44, v40, s53
    v_perm_b32 v201, v40, v48, s53
    ds_write_addtid_b32 v200 offset:32
    ds_write_addtid_b32 v201 offset:4192
    ds_write_addtid_b32 v200 offset:8356
    ds_write_addtid_b32 v201 offset:12516
    v_perm_b32 v202, v44, v40, s54
    v_perm_b32 v203, v40, v48, s54
    ds_write_addtid_b32 v202 offset:16672
    ds_write_addtid_b32 v203 offset:20832
    ds_write_addtid_b32 v202 offset:24996
    ds_write_addtid_b32 v203 offset:29156
    v_perm_b32 v204, v46, v42, s53
    v_perm_b32 v205, v42, v50, s53
    ds_write_addtid_b32 v204 offset:33376
    ds_write_addtid_b32 v205 offset:37536
    ds_write_addtid_b32 v204 offset:41700
    ds_write_addtid_b32 v205 offset:45860
    v_perm_b32 v206, v46, v42, s54
    v_perm_b32 v207, v42, v50, s54
    ds_write_addtid_b32 v206 offset:50016
    ds_write_addtid_b32 v207 offset:54176
    ds_write_addtid_b32 v206 offset:58340
    ds_write_addtid_b32 v207 offset:62500
    s_waitcnt vmcnt(0)
    v_mov_b32_dpp v60, v56 wave_shr:1 row_mask:0xf bank_mask:0xf
    v_mov_b32_dpp v61, v57 wave_shr:1 row_mask:0xf bank_mask:0xf
    v_mov_b32_dpp v62, v58 wave_shr:1 row_mask:0xf bank_mask:0xf
    v_mov_b32_dpp v63, v59 wave_shr:1 row_mask:0xf bank_mask:0xf
    s_add_u32 m0, s56, 76032
.p2align 3
    v_perm_b32 v200, v56, v52, s53
    v_perm_b32 v201, v52, v60, s53
    ds_write_addtid_b32 v200 offset:32
    ds_write_addtid_b32 v201 offset:4192
    ds_write_addtid_b32 v200 offset:8356
    ds_write_addtid_b32 v201 offset:12516
    v_perm_b32 v202, v56, v52, s54
    v_perm_b32 v203, v52, v60, s54
    ds_write_addtid_b32 v202 offset:16672
    ds_write_addtid_b32 v203 offset:20832
    ds_write_addtid_b32 v202 offset:24996
    ds_write_addtid_b32 v203 offset:29156
    v_perm_b32 v204, v58, v54, s53
    v_perm_b32 v205, v54, v62, s53
    ds_write_addtid_b32 v204 offset:33376
    ds_write_addtid_b32 v205 offset:37536
    ds_write_addtid_b32 v204 offset:41700
    ds_write_addtid_b32 v205 offset:45860
    v_perm_b32 v206, v58, v54, s54
    v_perm_b32 v207, v54, v62, s54
    ds_write_addtid_b32 v206 offset:50016
    ds_write_addtid_b32 v207 offset:54176
    ds_write_addtid_b32 v206 offset:58340
    ds_write_addtid_b32 v207 offset:62500
    s_waitcnt lgkmcnt(0)
    s_and_b32 s49, s2, 7
    s_mul_i32 s49, s49, 1179648
    s_lshl_b32 s50, s51, 8
    s_add_u32 s49, s49, s50
    v_and_b32 v2, 255, v0
    v_mul_u32_u24 v2, 4608, v2
    buffer_load_dword v250, v2, s[28:31], s49 offen
    buffer_load_dword v251, v2, s[28:31], s49 offen offset:128
    s_barrier
    v_mov_b32 v192, 0
    v_bfe_u32 v2, v1, 3, 2
    v_and_b32 v3, 7, v1
    v_cmp_gt_u32 vcc, 32, v1
    v_or_b32 v193, 2, v2
    s_nop 0
    v_cndmask_b32 v2, v193, v2, vcc
    v_cndmask_b32 v3, 8, v3, vcc
    v_mul_u32_u24 v2, 4160, v2
    v_lshl_add_u32 v2, v3, 2, v2
    s_mul_i32 s50, s52, 16640
    s_lshr_b32 s49, s52, 1
    s_lshl_b32 s49, s49, 6
    s_add_u32 s50, s50, s49
    v_add_u32 v2, s50, v2
    ds_write_b32 v2, v192
    s_add_u32 m0, s56, 0
.p2align 3
    v_perm_b32 v200, v21, v17, s53
    v_perm_b32 v201, v17, v25, s53
    ds_write_addtid_b32 v200 offset:32
    ds_write_addtid_b32 v201 offset:4192
    ds_write_addtid_b32 v200 offset:8356
    ds_write_addtid_b32 v201 offset:12516
    v_perm_b32 v202, v21, v17, s54
    v_perm_b32 v203, v17, v25, s54
    ds_write_addtid_b32 v202 offset:16672
    ds_write_addtid_b32 v203 offset:20832
    ds_write_addtid_b32 v202 offset:24996
    ds_write_addtid_b32 v203 offset:29156
    v_perm_b32 v204, v23, v19, s53
    v_perm_b32 v205, v19, v27, s53
    ds_write_addtid_b32 v204 offset:33376
    ds_write_addtid_b32 v205 offset:37536
    ds_write_addtid_b32 v204 offset:41700
    ds_write_addtid_b32 v205 offset:45860
    v_perm_b32 v206, v23, v19, s54
    v_perm_b32 v207, v19, v27, s54
    ds_write_addtid_b32 v206 offset:50016
    ds_write_addtid_b32 v207 offset:54176
    ds_write_addtid_b32 v206 offset:58340
    ds_write_addtid_b32 v207 offset:62500
    s_add_u32 m0, s56, 256
.p2align 3
    v_perm_b32 v200, v33, v29, s53
    v_perm_b32 v201, v29, v37, s53
    ds_write_addtid_b32 v200 offset:32
    ds_write_addtid_b32 v201 offset:4192
    ds_write_addtid_b32 v200 offset:8356
    ds_write_addtid_b32 v201 offset:12516
    v_perm_b32 v202, v33, v29, s54
    v_perm_b32 v203, v29, v37, s54
    ds_write_addtid_b32 v202 offset:16672
    ds_write_addtid_b32 v203 offset:20832
    ds_write_addtid_b32 v202 offset:24996
    ds_write_addtid_b32 v203 offset:29156
    v_perm_b32 v204, v35, v31, s53
    v_perm_b32 v205, v31, v39, s53
    ds_write_addtid_b32 v204 offset:33376
    ds_write_addtid_b32 v205 offset:37536
    ds_write_addtid_b32 v204 offset:41700
    ds_write_addtid_b32 v205 offset:45860
    v_perm_b32 v206, v35, v31, s54
    v_perm_b32 v207, v31, v39, s54
    ds_write_addtid_b32 v206 offset:50016
    ds_write_addtid_b32 v207 offset:54176
    ds_write_addtid_b32 v206 offset:58340
    ds_write_addtid_b32 v207 offset:62500
    s_add_u32 m0, s56, 2048
.p2align 3
    v_perm_b32 v200, v45, v41, s53
    v_perm_b32 v201, v41, v49, s53
    ds_write_addtid_b32 v200 offset:32
    ds_write_addtid_b32 v201 offset:4192
    ds_write_addtid_b32 v200 offset:8356
    ds_write_addtid_b32 v201 offset:12516
    v_perm_b32 v202, v45, v41, s54
    v_perm_b32 v203, v41, v49, s54
    ds_write_addtid_b32 v202 offset:16672
    ds_write_addtid_b32 v203 offset:20832
    ds_write_addtid_b32 v202 offset:24996
    ds_write_addtid_b32 v203 offset:29156
    v_perm_b32 v204, v47, v43, s53
    v_perm_b32 v205, v43, v51, s53
    ds_write_addtid_b32 v204 offset:33376
    ds_write_addtid_b32 v205 offset:37536
    ds_write_addtid_b32 v204 offset:41700
    ds_write_addtid_b32 v205 offset:45860
    v_perm_b32 v206, v47, v43, s54
    v_perm_b32 v207, v43, v51, s54
    ds_write_addtid_b32 v206 offset:50016
    ds_write_addtid_b32 v207 offset:54176
    ds_write_addtid_b32 v206 offset:58340
    ds_write_addtid_b32 v207 offset:62500
    s_add_u32 m0, s56, 2304
.p2align 3
    v_perm_b32 v200, v57, v53, s53
    v_perm_b32 v201, v53, v61, s53
    ds_write_addtid_b32 v200 offset:32
    ds_write_addtid_b32 v201 offset:4192
    ds_write_addtid_b32 v200 offset:8356
    ds_write_addtid_b32 v201 offset:12516
    v_perm_b32 v202, v57, v53, s54
    v_perm_b32 v203, v53, v61, s54
    ds_write_addtid_b32 v202 offset:16672
    ds_write_addtid_b32 v203 offset:20832
    ds_write_addtid_b32 v202 offset:24996
    ds_write_addtid_b32 v203 offset:29156
    v_perm_b32 v204, v59, v55, s53
    v_perm_b32 v205, v55, v63, s53
    ds_write_addtid_b32 v204 offset:33376
    ds_write_addtid_b32 v205 offset:37536
    ds_write_addtid_b32 v204 offset:41700
    ds_write_addtid_b32 v205 offset:45860
    v_perm_b32 v206, v59, v55, s54
    v_perm_b32 v207, v55, v63, s54
    ds_write_addtid_b32 v206 offset:50016
    ds_write_addtid_b32 v207 offset:54176
    ds_write_addtid_b32 v206 offset:58340
    ds_write_addtid_b32 v207 offset:62500
    s_waitcnt lgkmcnt(0)
    s_barrier
    v_add_u32 v2, 73728, v9
    ds_read_b128 v[16:19], v2 offset:32
    ds_read_b128 v[20:23], v2 offset:16672
    ds_read_b128 v[24:27], v2 offset:2080
    ds_read_b128 v[28:31], v2 offset:18720
    ds_read_b128 v[32:35], v9 offset:32
    ds_read_b128 v[36:39], v9 offset:16672
    ds_read_b128 v[40:43], v9 offset:2080
    ds_read_b128 v[44:47], v9 offset:18720
    v_mov_b32 v9, v2
    s_setprio 0
    v_lshlrev_b32 v12, 16, v64
    v_and_b32 v13, 0xffff0000, v64
    v_lshlrev_b32 v14, 16, v65
    v_and_b32 v15, 0xffff0000, v65
    s_waitcnt lgkmcnt(0)
    v_lshlrev_b32 v128, 16, v24
    v_lshlrev_b32 v129, 16, v28
    v_lshlrev_b32 v130, 16, v40
    v_lshlrev_b32 v131, 16, v44
    v_mul_f32 v128, v128, v12
    v_mul_f32 v129, v129, v13
    v_mul_f32 v130, v130, v14
    v_mul_f32 v131, v131, v15
    v_cvt_pk_bf16_f32 v128, 0, v128
    v_cvt_pk_bf16_f32 v129, 0, v129
    v_cvt_pk_bf16_f32 v130, 0, v130
    v_cvt_pk_bf16_f32 v131, 0, v131
    v_and_b32 v132, 0xffff0000, v24
    v_and_b32 v133, 0xffff0000, v28
    v_and_b32 v134, 0xffff0000, v40
    v_and_b32 v135, 0xffff0000, v44
    v_mul_f32 v132, v132, v12
    v_mul_f32 v133, v133, v13
    v_mul_f32 v134, v134, v14
    v_mul_f32 v135, v135, v15
    v_cvt_pk_bf16_f32 v132, 0, v132
    v_cvt_pk_bf16_f32 v133, 0, v133
    v_cvt_pk_bf16_f32 v134, 0, v134
    v_cvt_pk_bf16_f32 v135, 0, v135
    v_lshlrev_b32 v136, 16, v25
    v_lshlrev_b32 v137, 16, v29
    v_lshlrev_b32 v138, 16, v41
    v_lshlrev_b32 v139, 16, v45
    v_mul_f32 v136, v136, v12
    v_mul_f32 v137, v137, v13
    v_mul_f32 v138, v138, v14
    v_mul_f32 v139, v139, v15
    v_cvt_pk_bf16_f32 v136, 0, v136
    v_cvt_pk_bf16_f32 v137, 0, v137
    v_cvt_pk_bf16_f32 v138, 0, v138
    v_cvt_pk_bf16_f32 v139, 0, v139
    v_and_b32 v140, 0xffff0000, v25
    v_and_b32 v141, 0xffff0000, v29
    v_and_b32 v142, 0xffff0000, v41
    v_and_b32 v143, 0xffff0000, v45
    v_mul_f32 v140, v140, v12
    v_mul_f32 v141, v141, v13
    v_mul_f32 v142, v142, v14
    v_mul_f32 v143, v143, v15
    v_cvt_pk_bf16_f32 v140, 0, v140
    v_cvt_pk_bf16_f32 v141, 0, v141
    v_cvt_pk_bf16_f32 v142, 0, v142
    v_cvt_pk_bf16_f32 v143, 0, v143
    v_lshlrev_b32 v144, 16, v26
    v_lshlrev_b32 v145, 16, v30
    v_lshlrev_b32 v146, 16, v42
    v_lshlrev_b32 v147, 16, v46
    v_mul_f32 v144, v144, v12
    v_mul_f32 v145, v145, v13
    v_mul_f32 v146, v146, v14
    v_mul_f32 v147, v147, v15
    v_cvt_pk_bf16_f32 v144, 0, v144
    v_cvt_pk_bf16_f32 v145, 0, v145
    v_cvt_pk_bf16_f32 v146, 0, v146
    v_cvt_pk_bf16_f32 v147, 0, v147
    v_and_b32 v148, 0xffff0000, v26
    v_and_b32 v149, 0xffff0000, v30
    v_and_b32 v150, 0xffff0000, v42
    v_and_b32 v151, 0xffff0000, v46
    v_mul_f32 v148, v148, v12
    v_mul_f32 v149, v149, v13
    v_mul_f32 v150, v150, v14
    v_mul_f32 v151, v151, v15
    v_cvt_pk_bf16_f32 v148, 0, v148
    v_cvt_pk_bf16_f32 v149, 0, v149
    v_cvt_pk_bf16_f32 v150, 0, v150
    v_cvt_pk_bf16_f32 v151, 0, v151
    v_lshlrev_b32 v152, 16, v27
    v_lshlrev_b32 v153, 16, v31
    v_lshlrev_b32 v154, 16, v43
    v_lshlrev_b32 v155, 16, v47
    v_mul_f32 v152, v152, v12
    v_mul_f32 v153, v153, v13
    v_mul_f32 v154, v154, v14
    v_mul_f32 v155, v155, v15
    v_cvt_pk_bf16_f32 v152, 0, v152
    v_cvt_pk_bf16_f32 v153, 0, v153
    v_cvt_pk_bf16_f32 v154, 0, v154
    v_cvt_pk_bf16_f32 v155, 0, v155
    v_and_b32 v156, 0xffff0000, v27
    v_and_b32 v157, 0xffff0000, v31
    v_and_b32 v158, 0xffff0000, v43
    v_and_b32 v159, 0xffff0000, v47
    v_mul_f32 v156, v156, v12
    v_mul_f32 v157, v157, v13
    v_mul_f32 v158, v158, v14
    v_mul_f32 v159, v159, v15
    v_cvt_pk_bf16_f32 v156, 0, v156
    v_cvt_pk_bf16_f32 v157, 0, v157
    v_cvt_pk_bf16_f32 v158, 0, v158
    v_cvt_pk_bf16_f32 v159, 0, v159
    v_lshlrev_b32 v96, 16, v16
    v_lshlrev_b32 v97, 16, v20
    v_lshlrev_b32 v98, 16, v32
    v_lshlrev_b32 v99, 16, v36
    v_mul_f32 v96, v96, v12
    v_mul_f32 v97, v97, v13
    v_mul_f32 v98, v98, v14
    v_mul_f32 v99, v99, v15
    v_cvt_pk_bf16_f32 v96, 0, v96
    v_cvt_pk_bf16_f32 v97, 0, v97
    v_cvt_pk_bf16_f32 v98, 0, v98
    v_cvt_pk_bf16_f32 v99, 0, v99
    v_and_b32 v100, 0xffff0000, v16
    v_and_b32 v101, 0xffff0000, v20
    v_and_b32 v102, 0xffff0000, v32
    v_and_b32 v103, 0xffff0000, v36
    v_mul_f32 v100, v100, v12
    v_mul_f32 v101, v101, v13
    v_mul_f32 v102, v102, v14
    v_mul_f32 v103, v103, v15
    v_cvt_pk_bf16_f32 v100, 0, v100
    v_cvt_pk_bf16_f32 v101, 0, v101
    v_cvt_pk_bf16_f32 v102, 0, v102
    v_cvt_pk_bf16_f32 v103, 0, v103
    v_lshlrev_b32 v104, 16, v17
    v_lshlrev_b32 v105, 16, v21
    v_lshlrev_b32 v106, 16, v33
    v_lshlrev_b32 v107, 16, v37
    v_mul_f32 v104, v104, v12
    v_mul_f32 v105, v105, v13
    v_mul_f32 v106, v106, v14
    v_mul_f32 v107, v107, v15
    v_cvt_pk_bf16_f32 v104, 0, v104
    v_cvt_pk_bf16_f32 v105, 0, v105
    v_cvt_pk_bf16_f32 v106, 0, v106
    v_cvt_pk_bf16_f32 v107, 0, v107
    v_and_b32 v108, 0xffff0000, v17
    v_and_b32 v109, 0xffff0000, v21
    v_and_b32 v110, 0xffff0000, v33
    v_and_b32 v111, 0xffff0000, v37
    v_mul_f32 v108, v108, v12
    v_mul_f32 v109, v109, v13
    v_mul_f32 v110, v110, v14
    v_mul_f32 v111, v111, v15
    v_cvt_pk_bf16_f32 v108, 0, v108
    v_cvt_pk_bf16_f32 v109, 0, v109
    v_cvt_pk_bf16_f32 v110, 0, v110
    v_cvt_pk_bf16_f32 v111, 0, v111
    v_lshlrev_b32 v112, 16, v18
    v_lshlrev_b32 v113, 16, v22
    v_lshlrev_b32 v114, 16, v34
    v_lshlrev_b32 v115, 16, v38
    v_mul_f32 v112, v112, v12
    v_mul_f32 v113, v113, v13
    v_mul_f32 v114, v114, v14
    v_mul_f32 v115, v115, v15
    v_cvt_pk_bf16_f32 v112, 0, v112
    v_cvt_pk_bf16_f32 v113, 0, v113
    v_cvt_pk_bf16_f32 v114, 0, v114
    v_cvt_pk_bf16_f32 v115, 0, v115
    v_and_b32 v116, 0xffff0000, v18
    v_and_b32 v117, 0xffff0000, v22
    v_and_b32 v118, 0xffff0000, v34
    v_and_b32 v119, 0xffff0000, v38
    v_mul_f32 v116, v116, v12
    v_mul_f32 v117, v117, v13
    v_mul_f32 v118, v118, v14
    v_mul_f32 v119, v119, v15
    v_cvt_pk_bf16_f32 v116, 0, v116
    v_cvt_pk_bf16_f32 v117, 0, v117
    v_cvt_pk_bf16_f32 v118, 0, v118
    v_cvt_pk_bf16_f32 v119, 0, v119
    v_lshlrev_b32 v120, 16, v19
    v_lshlrev_b32 v121, 16, v23
    v_lshlrev_b32 v122, 16, v35
    v_lshlrev_b32 v123, 16, v39
    v_mul_f32 v120, v120, v12
    v_mul_f32 v121, v121, v13
    v_mul_f32 v122, v122, v14
    v_mul_f32 v123, v123, v15
    v_cvt_pk_bf16_f32 v120, 0, v120
    v_cvt_pk_bf16_f32 v121, 0, v121
    v_cvt_pk_bf16_f32 v122, 0, v122
    v_cvt_pk_bf16_f32 v123, 0, v123
    v_and_b32 v124, 0xffff0000, v19
    v_and_b32 v125, 0xffff0000, v23
    v_and_b32 v126, 0xffff0000, v35
    v_and_b32 v127, 0xffff0000, v39
    v_mul_f32 v124, v124, v12
    v_mul_f32 v125, v125, v13
    v_mul_f32 v126, v126, v14
    v_mul_f32 v127, v127, v15
    v_cvt_pk_bf16_f32 v124, 0, v124
    v_cvt_pk_bf16_f32 v125, 0, v125
    v_cvt_pk_bf16_f32 v126, 0, v126
    v_cvt_pk_bf16_f32 v127, 0, v127
    v_mul_u32_u24 v9, 33344, v8
    v_lshrrev_b32 v2, 5, v7
    v_lshl_add_u32 v9, v2, 9, v9
    v_bfe_u32 v2, v7, 1, 4
    v_lshl_add_u32 v9, v2, 2, v9
    v_and_b32 v2, 1, v7
    v_lshl_add_u32 v9, v2, 7, v9
    v_add_u32 v9, 73728, v9
    s_barrier
    s_setprio 1
    ds_read_b32 v16, v9 offset:4160
    ds_read_b32 v17, v9 offset:4416
    ds_read_b32 v18, v9 offset:4224
    ds_read_b32 v19, v9 offset:4480
    ds_read_b32 v20, v9 offset:20800
    ds_read_b32 v21, v9 offset:21056
    ds_read_b32 v22, v9 offset:20864
    ds_read_b32 v23, v9 offset:21120
    ds_read_b32 v24, v9 offset:6208
    ds_read_b32 v25, v9 offset:6464
    ds_read_b32 v26, v9 offset:6272
    ds_read_b32 v27, v9 offset:6528
    ds_read_b32 v28, v9 offset:22848
    ds_read_b32 v29, v9 offset:23104
    ds_read_b32 v30, v9 offset:22912
    ds_read_b32 v31, v9 offset:23168
    s_waitcnt lgkmcnt(0)
    s_setprio 0
    v_lshlrev_b32 v160, 16, v24
    v_lshlrev_b32 v161, 16, v28
    v_add_f32 v128, v128, v160
    v_add_f32 v129, v129, v161
    v_cvt_pk_bf16_f32 v128, 0, v128
    v_cvt_pk_bf16_f32 v129, 0, v129
    v_and_b32 v162, 0xffff0000, v24
    v_and_b32 v163, 0xffff0000, v28
    v_add_f32 v132, v132, v162
    v_add_f32 v133, v133, v163
    v_cvt_pk_bf16_f32 v132, 0, v132
    v_cvt_pk_bf16_f32 v133, 0, v133
    v_lshlrev_b32 v164, 16, v25
    v_lshlrev_b32 v165, 16, v29
    v_add_f32 v136, v136, v164
    v_add_f32 v137, v137, v165
    v_cvt_pk_bf16_f32 v136, 0, v136
    v_cvt_pk_bf16_f32 v137, 0, v137
    v_and_b32 v166, 0xffff0000, v25
    v_and_b32 v167, 0xffff0000, v29
    v_add_f32 v140, v140, v166
    v_add_f32 v141, v141, v167
    v_cvt_pk_bf16_f32 v140, 0, v140
    v_cvt_pk_bf16_f32 v141, 0, v141
    v_lshlrev_b32 v160, 16, v26
    v_lshlrev_b32 v161, 16, v30
    v_add_f32 v144, v144, v160
    v_add_f32 v145, v145, v161
    v_cvt_pk_bf16_f32 v144, 0, v144
    v_cvt_pk_bf16_f32 v145, 0, v145
    v_and_b32 v162, 0xffff0000, v26
    v_and_b32 v163, 0xffff0000, v30
    v_add_f32 v148, v148, v162
    v_add_f32 v149, v149, v163
    v_cvt_pk_bf16_f32 v148, 0, v148
    v_cvt_pk_bf16_f32 v149, 0, v149
    v_lshlrev_b32 v164, 16, v27
    v_lshlrev_b32 v165, 16, v31
    v_add_f32 v152, v152, v164
    v_add_f32 v153, v153, v165
    v_cvt_pk_bf16_f32 v152, 0, v152
    v_cvt_pk_bf16_f32 v153, 0, v153
    v_and_b32 v166, 0xffff0000, v27
    v_and_b32 v167, 0xffff0000, v31
    v_add_f32 v156, v156, v166
    v_add_f32 v157, v157, v167
    v_cvt_pk_bf16_f32 v156, 0, v156
    v_cvt_pk_bf16_f32 v157, 0, v157
    v_lshlrev_b32 v160, 16, v16
    v_lshlrev_b32 v161, 16, v20
    v_add_f32 v96, v96, v160
    v_add_f32 v97, v97, v161
    v_cvt_pk_bf16_f32 v96, 0, v96
    v_cvt_pk_bf16_f32 v97, 0, v97
    v_and_b32 v162, 0xffff0000, v16
    v_and_b32 v163, 0xffff0000, v20
    v_add_f32 v100, v100, v162
    v_add_f32 v101, v101, v163
    v_cvt_pk_bf16_f32 v100, 0, v100
    v_cvt_pk_bf16_f32 v101, 0, v101
    v_lshlrev_b32 v164, 16, v17
    v_lshlrev_b32 v165, 16, v21
    v_add_f32 v104, v104, v164
    v_add_f32 v105, v105, v165
    v_cvt_pk_bf16_f32 v104, 0, v104
    v_cvt_pk_bf16_f32 v105, 0, v105
    v_and_b32 v166, 0xffff0000, v17
    v_and_b32 v167, 0xffff0000, v21
    v_add_f32 v108, v108, v166
    v_add_f32 v109, v109, v167
    v_cvt_pk_bf16_f32 v108, 0, v108
    v_cvt_pk_bf16_f32 v109, 0, v109
    v_lshlrev_b32 v160, 16, v18
    v_lshlrev_b32 v161, 16, v22
    v_add_f32 v112, v112, v160
    v_add_f32 v113, v113, v161
    v_cvt_pk_bf16_f32 v112, 0, v112
    v_cvt_pk_bf16_f32 v113, 0, v113
    v_and_b32 v162, 0xffff0000, v18
    v_and_b32 v163, 0xffff0000, v22
    v_add_f32 v116, v116, v162
    v_add_f32 v117, v117, v163
    v_cvt_pk_bf16_f32 v116, 0, v116
    v_cvt_pk_bf16_f32 v117, 0, v117
    v_lshlrev_b32 v164, 16, v19
    v_lshlrev_b32 v165, 16, v23
    v_add_f32 v120, v120, v164
    v_add_f32 v121, v121, v165
    v_cvt_pk_bf16_f32 v120, 0, v120
    v_cvt_pk_bf16_f32 v121, 0, v121
    v_and_b32 v166, 0xffff0000, v19
    v_and_b32 v167, 0xffff0000, v23
    v_add_f32 v124, v124, v166
    v_add_f32 v125, v125, v167
    v_cvt_pk_bf16_f32 v124, 0, v124
    v_cvt_pk_bf16_f32 v125, 0, v125
    s_setprio 1
    s_lshl_b32 s49, s48, 5
    s_add_u32 s49, s49, 2304
    s_barrier
    ds_read_b32 v16, v9 offset:8320
    ds_read_b32 v17, v9 offset:8576
    ds_read_b32 v18, v9 offset:8384
    ds_read_b32 v19, v9 offset:8640
    ds_read_b32 v20, v9 offset:24960
    ds_read_b32 v21, v9 offset:25216
    ds_read_b32 v22, v9 offset:25024
    ds_read_b32 v23, v9 offset:25280
    s_waitcnt lgkmcnt(0)
    v_lshlrev_b32 v160, 16, v16
    v_lshlrev_b32 v161, 16, v20
    v_add_f32 v98, v98, v160
    v_add_f32 v99, v99, v161
    v_cvt_pk_bf16_f32 v98, 0, v98
    v_cvt_pk_bf16_f32 v99, 0, v99
    buffer_store_dwordx4 v[96:99], v10, s[28:31], s49 offen nt
    s_add_u32 s49, s49, 4608
    v_and_b32 v162, 0xffff0000, v16
    v_and_b32 v163, 0xffff0000, v20
    v_add_f32 v102, v102, v162
    v_add_f32 v103, v103, v163
    v_cvt_pk_bf16_f32 v102, 0, v102
    v_cvt_pk_bf16_f32 v103, 0, v103
    buffer_store_dwordx4 v[100:103], v10, s[28:31], s49 offen nt
    s_add_u32 s49, s49, 4608
    v_lshlrev_b32 v164, 16, v17
    v_lshlrev_b32 v165, 16, v21
    v_add_f32 v106, v106, v164
    v_add_f32 v107, v107, v165
    v_cvt_pk_bf16_f32 v106, 0, v106
    v_cvt_pk_bf16_f32 v107, 0, v107
    buffer_store_dwordx4 v[104:107], v10, s[28:31], s49 offen nt
    s_add_u32 s49, s49, 4608
    v_and_b32 v166, 0xffff0000, v17
    v_and_b32 v167, 0xffff0000, v21
    v_add_f32 v110, v110, v166
    v_add_f32 v111, v111, v167
    v_cvt_pk_bf16_f32 v110, 0, v110
    v_cvt_pk_bf16_f32 v111, 0, v111
    buffer_store_dwordx4 v[108:111], v10, s[28:31], s49 offen nt
    s_add_u32 s49, s49, 4608
    v_lshlrev_b32 v160, 16, v18
    v_lshlrev_b32 v161, 16, v22
    v_add_f32 v114, v114, v160
    v_add_f32 v115, v115, v161
    v_cvt_pk_bf16_f32 v114, 0, v114
    v_cvt_pk_bf16_f32 v115, 0, v115
    buffer_store_dwordx4 v[112:115], v10, s[28:31], s49 offen nt
    s_add_u32 s49, s49, 4608
    v_and_b32 v162, 0xffff0000, v18
    v_and_b32 v163, 0xffff0000, v22
    v_add_f32 v118, v118, v162
    v_add_f32 v119, v119, v163
    v_cvt_pk_bf16_f32 v118, 0, v118
    v_cvt_pk_bf16_f32 v119, 0, v119
    buffer_store_dwordx4 v[116:119], v10, s[28:31], s49 offen nt
    s_add_u32 s49, s49, 4608
    v_lshlrev_b32 v164, 16, v19
    v_lshlrev_b32 v165, 16, v23
    v_add_f32 v122, v122, v164
    v_add_f32 v123, v123, v165
    v_cvt_pk_bf16_f32 v122, 0, v122
    v_cvt_pk_bf16_f32 v123, 0, v123
    buffer_store_dwordx4 v[120:123], v10, s[28:31], s49 offen nt
    s_add_u32 s49, s49, 4608
    v_and_b32 v166, 0xffff0000, v19
    v_and_b32 v167, 0xffff0000, v23
    v_add_f32 v126, v126, v166
    v_add_f32 v127, v127, v167
    v_cvt_pk_bf16_f32 v126, 0, v126
    v_cvt_pk_bf16_f32 v127, 0, v127
    buffer_store_dwordx4 v[124:127], v10, s[28:31], s49 offen nt
    s_lshl_b32 s49, s48, 5
    s_add_u32 s49, s49, 4720896
    s_barrier
    ds_read_b32 v24, v9 offset:10368
    ds_read_b32 v25, v9 offset:10624
    ds_read_b32 v26, v9 offset:10432
    ds_read_b32 v27, v9 offset:10688
    ds_read_b32 v28, v9 offset:27008
    ds_read_b32 v29, v9 offset:27264
    ds_read_b32 v30, v9 offset:27072
    ds_read_b32 v31, v9 offset:27328
    s_waitcnt lgkmcnt(0)
    v_lshlrev_b32 v160, 16, v24
    v_lshlrev_b32 v161, 16, v28
    v_add_f32 v130, v130, v160
    v_add_f32 v131, v131, v161
    v_cvt_pk_bf16_f32 v130, 0, v130
    v_cvt_pk_bf16_f32 v131, 0, v131
    buffer_store_dwordx4 v[128:131], v10, s[28:31], s49 offen nt
    s_add_u32 s49, s49, 4608
    v_and_b32 v162, 0xffff0000, v24
    v_and_b32 v163, 0xffff0000, v28
    v_add_f32 v134, v134, v162
    v_add_f32 v135, v135, v163
    v_cvt_pk_bf16_f32 v134, 0, v134
    v_cvt_pk_bf16_f32 v135, 0, v135
    buffer_store_dwordx4 v[132:135], v10, s[28:31], s49 offen nt
    s_add_u32 s49, s49, 4608
    v_lshlrev_b32 v164, 16, v25
    v_lshlrev_b32 v165, 16, v29
    v_add_f32 v138, v138, v164
    v_add_f32 v139, v139, v165
    v_cvt_pk_bf16_f32 v138, 0, v138
    v_cvt_pk_bf16_f32 v139, 0, v139
    buffer_store_dwordx4 v[136:139], v10, s[28:31], s49 offen nt
    s_add_u32 s49, s49, 4608
    v_and_b32 v166, 0xffff0000, v25
    v_and_b32 v167, 0xffff0000, v29
    v_add_f32 v142, v142, v166
    v_add_f32 v143, v143, v167
    v_cvt_pk_bf16_f32 v142, 0, v142
    v_cvt_pk_bf16_f32 v143, 0, v143
    buffer_store_dwordx4 v[140:143], v10, s[28:31], s49 offen nt
    s_add_u32 s49, s49, 4608
    v_lshlrev_b32 v160, 16, v26
    v_lshlrev_b32 v161, 16, v30
    v_add_f32 v146, v146, v160
    v_add_f32 v147, v147, v161
    v_cvt_pk_bf16_f32 v146, 0, v146
    v_cvt_pk_bf16_f32 v147, 0, v147
    buffer_store_dwordx4 v[144:147], v10, s[28:31], s49 offen nt
    s_add_u32 s49, s49, 4608
    v_and_b32 v162, 0xffff0000, v26
    v_and_b32 v163, 0xffff0000, v30
    v_add_f32 v150, v150, v162
    v_add_f32 v151, v151, v163
    v_cvt_pk_bf16_f32 v150, 0, v150
    v_cvt_pk_bf16_f32 v151, 0, v151
    buffer_store_dwordx4 v[148:151], v10, s[28:31], s49 offen nt
    s_add_u32 s49, s49, 4608
    v_lshlrev_b32 v164, 16, v27
    v_lshlrev_b32 v165, 16, v31
    v_add_f32 v154, v154, v164
    v_add_f32 v155, v155, v165
    v_cvt_pk_bf16_f32 v154, 0, v154
    v_cvt_pk_bf16_f32 v155, 0, v155
    buffer_store_dwordx4 v[152:155], v10, s[28:31], s49 offen nt
    s_add_u32 s49, s49, 4608
    v_and_b32 v166, 0xffff0000, v27
    v_and_b32 v167, 0xffff0000, v31
    v_add_f32 v158, v158, v166
    v_add_f32 v159, v159, v167
    v_cvt_pk_bf16_f32 v158, 0, v158
    v_cvt_pk_bf16_f32 v159, 0, v159
    buffer_store_dwordx4 v[156:159], v10, s[28:31], s49 offen nt
    s_endpgm
role_bc:
    s_sub_u32 s49, s2, 184
    s_and_b32 s48, s49, 7
    s_mul_i32 s48, s48, 9
    s_lshr_b32 s49, s49, 3
    s_add_u32 s48, s48, s49
    s_lshr_b32 s49, s3, 1
    s_lshl_b32 s49, s49, 1
    s_add_u32 s49, s49, s3
    s_lshl_b32 s51, s48, 3
    s_add_u32 s51, s51, s49
    v_and_b32 v1, 63, v0
    v_and_b32 v2, 15, v0
    v_lshrrev_b32 v3, 4, v1
    s_mul_i32 s53, s3, 9216
    s_waitcnt lgkmcnt(0)
    s_mov_b64 s[4:5], s[82:83]
    s_mov_b64 s[6:7], s[84:85]
    s_mov_b64 s[8:9], s[86:87]
    s_mov_b64 s[10:11], s[88:89]
    s_mov_b64 s[12:13], s[90:91]
    s_mov_b64 s[14:15], s[92:93]
    s_mov_b64 s[16:17], s[98:99]
    s_mov_b64 s[18:19], s[100:101]
    s_lshl_b32 s49, s51, 8
    v_lshl_add_u32 v24, v1, 2, s49
    s_lshl_b32 s49, s51, 1
    v_mov_b32 v25, s49
    global_load_dword v12, v24, s[6:7]
    global_load_dword v13, v24, s[8:9]
    global_load_dword v14, v24, s[10:11]
    global_load_dword v15, v24, s[12:13]
    global_load_ushort v16, v25, s[14:15]
    s_barrier
    v_lshl_add_u32 v24, v3, 4, s53
    v_mul_u32_u24 v25, 288, v2
    v_add_u32 v17, v24, v25
    v_cmp_gt_u32 vcc, 8, v2
    v_lshlrev_b32 v21, 2, v2
    v_and_b32 v21, 31, v21
    v_mov_b32 v18, 0x43222100
    v_mov_b32 v25, 0x87666544
    v_cndmask_b32 v18, v25, v18, vcc
    v_bfe_u32 v18, v18, v21, 4
    v_mul_u32_u24 v18, 288, v18
    v_add_u32 v18, v18, v24
    v_mov_b32 v19, 0x44322210
    v_mov_b32 v25, 0x99877765
    v_cndmask_b32 v19, v25, v19, vcc
    v_bfe_u32 v19, v19, v21, 4
    v_mul_u32_u24 v19, 288, v19
    v_add_u32 v19, 2592, v19
    v_add_u32 v19, v19, v24
    v_mov_b32 v20, 0x55432210
    v_mov_b32 v25, 0xbba98876
    v_cndmask_b32 v20, v25, v20, vcc
    v_bfe_u32 v20, v20, v21, 4
    v_mul_u32_u24 v20, 288, v20
    v_add_u32 v20, 5472, v20
    v_add_u32 v20, v20, v24
    s_mul_i32 s49, s3, 4608
    s_add_u32 s49, s49, 140832
    v_lshlrev_b32 v4, 5, v2
    v_sub_u32 v7, s49, v4
    v_lshlrev_b32 v4, 3, v3
    v_sub_u32 v9, v7, v4
    v_lshrrev_b32 v4, 1, v3
    v_lshlrev_b32 v4, 9, v4
    v_and_b32 v5, 1, v3
    v_lshl_add_u32 v4, v5, 4, v4
    v_sub_u32 v10, v7, v4
    v_lshlrev_b32 v4, 9, v3
    v_sub_u32 v11, v7, v4
    v_lshl_add_u32 v7, v3, 4, v7
    s_mul_i32 s52, s3, 16640
    s_lshr_b32 s49, s3, 1
    s_lshl_b32 s49, s49, 6
    s_add_u32 s52, s52, s49
    s_add_u32 s52, s52, 73728
    v_sub_u32 v4, 3, v2
    v_and_b32 v4, 3, v4
    v_add3_u32 v5, v2, v4, 1
    v_lshl_add_u32 v5, v3, 3, v5
    v_mul_u32_u24 v6, 4160, v4
    v_lshl_add_u32 v6, v5, 1, v6
    v_add_u32 v6, s52, v6
    v_lshlrev_b32 v8, 5, v2
    v_lshl_add_u32 v8, v3, 3, v8
    v_add_u32 v8, s52, v8
    v_mov_b32 v128, 0
    v_mov_b32 v129, 0
    v_mov_b32 v130, 0
    v_mov_b32 v131, 0
    s_mul_i32 s49, s3, 4608
    s_add_u32 s49, s49, 140352
    v_min_u32 v4, 29, v1
    v_lshl_add_u32 v4, v4, 4, s49
    ds_write_b128 v4, v[128:131] offset:4096
    s_mov_b32 s36, s16
    s_mov_b32 s37, s17
    s_mov_b32 s38, 256
    s_mov_b32 s39, 0x00020000
    s_add_u32 s40, s18, 8480768
    s_addc_u32 s41, s19, 0
    s_mov_b32 s42, 9216
    s_mov_b32 s43, 0x00020000
    s_add_u32 s44, s18, 9437184
    s_addc_u32 s45, s19, 0
    s_mov_b32 s46, 1179648
    s_mov_b32 s47, 0x00020000
    v_and_b32 v200, 3, v0
    v_lshlrev_b32 v200, 2, v200
    s_lshl_b32 s49, s48, 7
    s_lshl_b32 s50, s3, 2
    s_add_u32 s49, s49, s50
    v_mov_b32 v201, s49
    v_lshlrev_b32 v203, 4, v1
    s_lshl_b32 s54, s48, 2
    s_add_u32 s54, s54, s3
    s_lshl_b32 s54, s54, 12
    s_waitcnt vmcnt(0)
    v_and_b32 v24, 0x7fff7fff, v14
    v_and_b32 v25, 0x7fff7fff, v15
    v_pk_max_u16 v24, v24, v25
    v_lshlrev_b32 v25, 16, v24
    v_max_u32 v24, v24, v25
    v_lshlrev_b32 v23, 16, v16
    v_mul_f32 v23, 0x3fb8aa3b, v23
    v_max_u32_dpp v24, v24, v24 row_shr:1 row_mask:0xf bank_mask:0xf
    v_exp_f32 v23, v23
    s_nop 0
    v_max_u32_dpp v24, v24, v24 row_shr:2 row_mask:0xf bank_mask:0xf
    s_nop 1
    v_max_u32_dpp v24, v24, v24 row_shr:4 row_mask:0xf bank_mask:0xf
    s_nop 1
    v_max_u32_dpp v24, v24, v24 row_shr:8 row_mask:0xf bank_mask:0xf
    v_cvt_pk_bf16_f32 v23, 0, v23
    s_nop 0
    v_max_u32_dpp v24, v24, v24 row_bcast:15 row_mask:0xa bank_mask:0xf
    s_nop 1
    v_max_u32_dpp v24, v24, v24 row_bcast:31 row_mask:0xc bank_mask:0xf
    s_nop 0
    v_readlane_b32 s56, v24, 63
    s_nop 0
    s_lshr_b32 s56, s56, 23
    s_sub_u32 s56, 262, s56
    s_min_u32 s56, s56, 253
    s_sub_u32 s57, 255, s56
    s_lshl_b32 s56, s56, 23
    s_lshl_b32 s57, s57, 23
    v_lshlrev_b32 v21, 16, v12
    v_lshlrev_b32 v22, 16, v13
    v_lshlrev_b32 v110, 16, v14
    v_lshlrev_b32 v111, 16, v15
    v_mul_f32 v21, 0x3fb8aa3b, v21
    v_exp_f32 v21, v21
    v_mul_f32 v22, v22, v23
    v_cvt_pk_bf16_f32 v21, 0, v21
    v_mul_f32 v22, 0.15915494, v22
    v_mul_f32 v21, v21, v23
    v_mul_f32 v21, 0xbfb8aa3b, v21
    v_mul_f32 v110, s56, v110
    v_mul_f32 v111, s56, v111
    v_exp_f32 v24, v21
    v_rndne_f32 v96, v22
    v_sub_f32 v25, v22, v96
    v_cos_f32 v96, v25
    v_sin_f32 v97, v25
    v_mul_f32 v96, v96, v24
    v_mul_f32 v97, v97, v24
    v_mul_f32 v24, 0x41800000, v21
    v_mul_f32 v25, 0x41800000, v22
    v_exp_f32 v24, v24
    v_rndne_f32 v104, v25
    v_sub_f32 v25, v25, v104
    v_cos_f32 v104, v25
    v_sin_f32 v105, v25
    v_mul_f32 v104, v104, v24
    v_mul_f32 v105, v105, v24
    v_mul_f32 v24, 0x43800000, v21
    v_mul_f32 v25, 0x43800000, v22
    v_exp_f32 v24, v24
    v_rndne_f32 v112, v25
    v_sub_f32 v25, v25, v112
    v_cos_f32 v112, v25
    v_sin_f32 v113, v25
    v_mul_f32 v112, v112, v24
    v_mul_f32 v113, v113, v24
.p2align 3
    v_cvt_pk_f16_f32 v26, v96, v97
    v_pk_mul_f32 v[98:99], v[96:97], v[96:97] op_sel:[0,0] op_sel_hi:[1,0]
    v_pk_fma_f32 v[98:99], v[96:97], v[96:97], v[98:99] op_sel:[1,1,0] op_sel_hi:[0,1,1] neg_lo:[1,0,0]
    v_cvt_pk_f16_f32 v27, v98, v99
    v_pk_mul_f32 v[114:115], v[98:99], v[96:97] op_sel:[0,0] op_sel_hi:[1,0]
    v_pk_fma_f32 v[114:115], v[98:99], v[96:97], v[114:115] op_sel:[1,1,0] op_sel_hi:[0,1,1] neg_lo:[1,0,0]
    v_cvt_pk_f16_f32 v28, v114, v115
    v_pk_mul_f32 v[100:101], v[98:99], v[98:99] op_sel:[0,0] op_sel_hi:[1,0]
    v_pk_fma_f32 v[100:101], v[98:99], v[98:99], v[100:101] op_sel:[1,1,0] op_sel_hi:[0,1,1] neg_lo:[1,0,0]
    v_cvt_pk_f16_f32 v29, v100, v101
    v_pk_mul_f32 v[102:103], v[100:101], v[100:101] op_sel:[0,0] op_sel_hi:[1,0]
    v_pk_fma_f32 v[102:103], v[100:101], v[100:101], v[102:103] op_sel:[1,1,0] op_sel_hi:[0,1,1] neg_lo:[1,0,0]
    v_cvt_pk_f16_f32 v30, v102, v103
    v_pk_mul_f32 v[114:115], v[102:103], v[100:101] op_sel:[0,0] op_sel_hi:[1,0]
    v_pk_fma_f32 v[114:115], v[102:103], v[100:101], v[114:115] op_sel:[1,1,0] op_sel_hi:[0,1,1] neg_lo:[1,0,0]
    v_cvt_pk_f16_f32 v31, v114, v115
    v_cvt_pk_f16_f32 v32, v104, v105
    v_pk_mul_f32 v[106:107], v[104:105], v[104:105] op_sel:[0,0] op_sel_hi:[1,0]
    v_pk_fma_f32 v[106:107], v[104:105], v[104:105], v[106:107] op_sel:[1,1,0] op_sel_hi:[0,1,1] neg_lo:[1,0,0]
    v_cvt_pk_f16_f32 v33, v106, v107
    v_pk_mul_f32 v[114:115], v[106:107], v[104:105] op_sel:[0,0] op_sel_hi:[1,0]
    v_pk_fma_f32 v[114:115], v[106:107], v[104:105], v[114:115] op_sel:[1,1,0] op_sel_hi:[0,1,1] neg_lo:[1,0,0]
    v_cvt_pk_f16_f32 v34, v114, v115
    v_pk_mul_f32 v[108:109], v[106:107], v[106:107] op_sel:[0,0] op_sel_hi:[1,0]
    v_pk_fma_f32 v[108:109], v[106:107], v[106:107], v[108:109] op_sel:[1,1,0] op_sel_hi:[0,1,1] neg_lo:[1,0,0]
    v_cvt_pk_f16_f32 v35, v110, -v111
    v_pk_mul_f32 v[114:115], v[110:111], v[108:109] op_sel:[0,0] op_sel_hi:[1,0]
    v_pk_fma_f32 v[114:115], v[110:111], v[108:109], v[114:115] op_sel:[1,1,0] op_sel_hi:[0,1,1] neg_lo:[1,0,0]
    v_cvt_pk_f16_f32 v36, v114, -v115
    v_pk_mul_f32 v[116:117], v[114:115], v[108:109] op_sel:[0,0] op_sel_hi:[1,0]
    v_pk_fma_f32 v[116:117], v[114:115], v[108:109], v[116:117] op_sel:[1,1,0] op_sel_hi:[0,1,1] neg_lo:[1,0,0]
    v_cvt_pk_f16_f32 v37, v116, -v117
    v_pk_mul_f32 v[114:115], v[116:117], v[108:109] op_sel:[0,0] op_sel_hi:[1,0]
    v_pk_fma_f32 v[114:115], v[116:117], v[108:109], v[114:115] op_sel:[1,1,0] op_sel_hi:[0,1,1] neg_lo:[1,0,0]
    v_cvt_pk_f16_f32 v38, v114, -v115
    v_cvt_pk_f16_f32 v39, v112, v113
    v_pk_mul_f32 v[114:115], v[112:113], v[112:113] op_sel:[0,0] op_sel_hi:[1,0]
    v_pk_fma_f32 v[114:115], v[112:113], v[112:113], v[114:115] op_sel:[1,1,0] op_sel_hi:[0,1,1] neg_lo:[1,0,0]
    v_cvt_pk_f16_f32 v40, v114, v115
    v_pk_mul_f32 v[116:117], v[114:115], v[112:113] op_sel:[0,0] op_sel_hi:[1,0]
    v_pk_fma_f32 v[116:117], v[114:115], v[112:113], v[116:117] op_sel:[1,1,0] op_sel_hi:[0,1,1] neg_lo:[1,0,0]
    v_cvt_pk_f16_f32 v41, v116, v117
    v_pk_mul_f32 v[114:115], v[116:117], v[112:113] op_sel:[0,0] op_sel_hi:[1,0]
    v_pk_fma_f32 v[114:115], v[116:117], v[112:113], v[114:115] op_sel:[1,1,0] op_sel_hi:[0,1,1] neg_lo:[1,0,0]
    v_cvt_pk_f16_f32 v42, v114, v115
    v_pk_mul_f32 v[116:117], v[114:115], v[112:113] op_sel:[0,0] op_sel_hi:[1,0]
    v_pk_fma_f32 v[116:117], v[114:115], v[112:113], v[116:117] op_sel:[1,1,0] op_sel_hi:[0,1,1] neg_lo:[1,0,0]
    v_cvt_pk_f16_f32 v43, v116, v117
    v_pk_mul_f32 v[114:115], v[116:117], v[112:113] op_sel:[0,0] op_sel_hi:[1,0]
    v_pk_fma_f32 v[114:115], v[116:117], v[112:113], v[114:115] op_sel:[1,1,0] op_sel_hi:[0,1,1] neg_lo:[1,0,0]
    v_cvt_pk_f16_f32 v44, v114, v115
    v_pk_mul_f32 v[116:117], v[114:115], v[112:113] op_sel:[0,0] op_sel_hi:[1,0]
    v_pk_fma_f32 v[116:117], v[114:115], v[112:113], v[116:117] op_sel:[1,1,0] op_sel_hi:[0,1,1] neg_lo:[1,0,0]
    v_cvt_pk_f16_f32 v45, v116, v117
    v_and_b32 v21, 0xffff0000, v12
    v_and_b32 v22, 0xffff0000, v13
    v_and_b32 v110, 0xffff0000, v14
    v_and_b32 v111, 0xffff0000, v15
    v_mul_f32 v21, 0x3fb8aa3b, v21
    v_exp_f32 v21, v21
    v_mul_f32 v22, v22, v23
    v_cvt_pk_bf16_f32 v21, 0, v21
    v_mul_f32 v22, 0.15915494, v22
    v_mul_f32 v21, v21, v23
    v_mul_f32 v21, 0xbfb8aa3b, v21
    v_mul_f32 v110, s56, v110
    v_mul_f32 v111, s56, v111
    v_exp_f32 v24, v21
    v_rndne_f32 v96, v22
    v_sub_f32 v25, v22, v96
    v_cos_f32 v96, v25
    v_sin_f32 v97, v25
    v_mul_f32 v96, v96, v24
    v_mul_f32 v97, v97, v24
    v_mul_f32 v24, 0x41800000, v21
    v_mul_f32 v25, 0x41800000, v22
    v_exp_f32 v24, v24
    v_rndne_f32 v104, v25
    v_sub_f32 v25, v25, v104
    v_cos_f32 v104, v25
    v_sin_f32 v105, v25
    v_mul_f32 v104, v104, v24
    v_mul_f32 v105, v105, v24
    v_mul_f32 v24, 0x43800000, v21
    v_mul_f32 v25, 0x43800000, v22
    v_exp_f32 v24, v24
    v_rndne_f32 v112, v25
    v_sub_f32 v25, v25, v112
    v_cos_f32 v112, v25
    v_sin_f32 v113, v25
    v_mul_f32 v112, v112, v24
    v_mul_f32 v113, v113, v24
.p2align 3
    v_cvt_pk_f16_f32 v46, v96, v97
    v_pk_mul_f32 v[98:99], v[96:97], v[96:97] op_sel:[0,0] op_sel_hi:[1,0]
    v_pk_fma_f32 v[98:99], v[96:97], v[96:97], v[98:99] op_sel:[1,1,0] op_sel_hi:[0,1,1] neg_lo:[1,0,0]
    v_cvt_pk_f16_f32 v47, v98, v99
    v_pk_mul_f32 v[114:115], v[98:99], v[96:97] op_sel:[0,0] op_sel_hi:[1,0]
    v_pk_fma_f32 v[114:115], v[98:99], v[96:97], v[114:115] op_sel:[1,1,0] op_sel_hi:[0,1,1] neg_lo:[1,0,0]
    v_cvt_pk_f16_f32 v48, v114, v115
    v_pk_mul_f32 v[100:101], v[98:99], v[98:99] op_sel:[0,0] op_sel_hi:[1,0]
    v_pk_fma_f32 v[100:101], v[98:99], v[98:99], v[100:101] op_sel:[1,1,0] op_sel_hi:[0,1,1] neg_lo:[1,0,0]
    v_cvt_pk_f16_f32 v49, v100, v101
    v_pk_mul_f32 v[102:103], v[100:101], v[100:101] op_sel:[0,0] op_sel_hi:[1,0]
    v_pk_fma_f32 v[102:103], v[100:101], v[100:101], v[102:103] op_sel:[1,1,0] op_sel_hi:[0,1,1] neg_lo:[1,0,0]
    v_cvt_pk_f16_f32 v50, v102, v103
    v_pk_mul_f32 v[114:115], v[102:103], v[100:101] op_sel:[0,0] op_sel_hi:[1,0]
    v_pk_fma_f32 v[114:115], v[102:103], v[100:101], v[114:115] op_sel:[1,1,0] op_sel_hi:[0,1,1] neg_lo:[1,0,0]
    v_cvt_pk_f16_f32 v51, v114, v115
    v_cvt_pk_f16_f32 v52, v104, v105
    v_pk_mul_f32 v[106:107], v[104:105], v[104:105] op_sel:[0,0] op_sel_hi:[1,0]
    v_pk_fma_f32 v[106:107], v[104:105], v[104:105], v[106:107] op_sel:[1,1,0] op_sel_hi:[0,1,1] neg_lo:[1,0,0]
    v_cvt_pk_f16_f32 v53, v106, v107
    v_pk_mul_f32 v[114:115], v[106:107], v[104:105] op_sel:[0,0] op_sel_hi:[1,0]
    v_pk_fma_f32 v[114:115], v[106:107], v[104:105], v[114:115] op_sel:[1,1,0] op_sel_hi:[0,1,1] neg_lo:[1,0,0]
    v_cvt_pk_f16_f32 v54, v114, v115
    v_pk_mul_f32 v[108:109], v[106:107], v[106:107] op_sel:[0,0] op_sel_hi:[1,0]
    v_pk_fma_f32 v[108:109], v[106:107], v[106:107], v[108:109] op_sel:[1,1,0] op_sel_hi:[0,1,1] neg_lo:[1,0,0]
    v_cvt_pk_f16_f32 v55, v110, -v111
    v_pk_mul_f32 v[114:115], v[110:111], v[108:109] op_sel:[0,0] op_sel_hi:[1,0]
    v_pk_fma_f32 v[114:115], v[110:111], v[108:109], v[114:115] op_sel:[1,1,0] op_sel_hi:[0,1,1] neg_lo:[1,0,0]
    v_cvt_pk_f16_f32 v56, v114, -v115
    v_pk_mul_f32 v[116:117], v[114:115], v[108:109] op_sel:[0,0] op_sel_hi:[1,0]
    v_pk_fma_f32 v[116:117], v[114:115], v[108:109], v[116:117] op_sel:[1,1,0] op_sel_hi:[0,1,1] neg_lo:[1,0,0]
    v_cvt_pk_f16_f32 v57, v116, -v117
    v_pk_mul_f32 v[114:115], v[116:117], v[108:109] op_sel:[0,0] op_sel_hi:[1,0]
    v_pk_fma_f32 v[114:115], v[116:117], v[108:109], v[114:115] op_sel:[1,1,0] op_sel_hi:[0,1,1] neg_lo:[1,0,0]
    v_cvt_pk_f16_f32 v58, v114, -v115
    v_cvt_pk_f16_f32 v59, v112, v113
    v_pk_mul_f32 v[114:115], v[112:113], v[112:113] op_sel:[0,0] op_sel_hi:[1,0]
    v_pk_fma_f32 v[114:115], v[112:113], v[112:113], v[114:115] op_sel:[1,1,0] op_sel_hi:[0,1,1] neg_lo:[1,0,0]
    v_cvt_pk_f16_f32 v60, v114, v115
    v_pk_mul_f32 v[116:117], v[114:115], v[112:113] op_sel:[0,0] op_sel_hi:[1,0]
    v_pk_fma_f32 v[116:117], v[114:115], v[112:113], v[116:117] op_sel:[1,1,0] op_sel_hi:[0,1,1] neg_lo:[1,0,0]
    v_cvt_pk_f16_f32 v61, v116, v117
    v_pk_mul_f32 v[114:115], v[116:117], v[112:113] op_sel:[0,0] op_sel_hi:[1,0]
    v_pk_fma_f32 v[114:115], v[116:117], v[112:113], v[114:115] op_sel:[1,1,0] op_sel_hi:[0,1,1] neg_lo:[1,0,0]
    v_cvt_pk_f16_f32 v62, v114, v115
    v_pk_mul_f32 v[116:117], v[114:115], v[112:113] op_sel:[0,0] op_sel_hi:[1,0]
    v_pk_fma_f32 v[116:117], v[114:115], v[112:113], v[116:117] op_sel:[1,1,0] op_sel_hi:[0,1,1] neg_lo:[1,0,0]
    v_cvt_pk_f16_f32 v63, v116, v117
    v_pk_mul_f32 v[114:115], v[116:117], v[112:113] op_sel:[0,0] op_sel_hi:[1,0]
    v_pk_fma_f32 v[114:115], v[116:117], v[112:113], v[114:115] op_sel:[1,1,0] op_sel_hi:[0,1,1] neg_lo:[1,0,0]
    v_cvt_pk_f16_f32 v64, v114, v115
    v_pk_mul_f32 v[116:117], v[114:115], v[112:113] op_sel:[0,0] op_sel_hi:[1,0]
    v_pk_fma_f32 v[116:117], v[114:115], v[112:113], v[116:117] op_sel:[1,1,0] op_sel_hi:[0,1,1] neg_lo:[1,0,0]
    v_cvt_pk_f16_f32 v65, v116, v117
    v_mov_b32 v24, 0x3c00
    s_mov_b32 m0, s53
    s_nop 0
.p2align 3
    ds_write_addtid_b32 v24 offset:0
    ds_write_addtid_b32 v26 offset:288
    ds_write_addtid_b32 v27 offset:576
    ds_write_addtid_b32 v28 offset:864
    ds_write_addtid_b32 v29 offset:1152
    v_pk_mul_f16 v70, v29, v26 op_sel:[0,0] op_sel_hi:[1,0]
    v_pk_fma_f16 v70, v29, v26, v70 op_sel:[1,1,0] op_sel_hi:[0,1,1] neg_lo:[1,0,0]
    ds_write_addtid_b32 v70 offset:1440
    v_pk_mul_f16 v66, v29, v27 op_sel:[0,0] op_sel_hi:[1,0]
    v_pk_fma_f16 v66, v29, v27, v66 op_sel:[1,1,0] op_sel_hi:[0,1,1] neg_lo:[1,0,0]
    ds_write_addtid_b32 v66 offset:1728
    v_pk_mul_f16 v71, v29, v28 op_sel:[0,0] op_sel_hi:[1,0]
    v_pk_fma_f16 v71, v29, v28, v71 op_sel:[1,1,0] op_sel_hi:[0,1,1] neg_lo:[1,0,0]
    ds_write_addtid_b32 v71 offset:2016
    ds_write_addtid_b32 v30 offset:2304
    v_pk_mul_f16 v72, v30, v26 op_sel:[0,0] op_sel_hi:[1,0]
    v_pk_fma_f16 v72, v30, v26, v72 op_sel:[1,1,0] op_sel_hi:[0,1,1] neg_lo:[1,0,0]
    ds_write_addtid_b32 v72 offset:2592
    v_pk_mul_f16 v67, v30, v27 op_sel:[0,0] op_sel_hi:[1,0]
    v_pk_fma_f16 v67, v30, v27, v67 op_sel:[1,1,0] op_sel_hi:[0,1,1] neg_lo:[1,0,0]
    ds_write_addtid_b32 v67 offset:2880
    v_pk_mul_f16 v73, v30, v28 op_sel:[0,0] op_sel_hi:[1,0]
    v_pk_fma_f16 v73, v30, v28, v73 op_sel:[1,1,0] op_sel_hi:[0,1,1] neg_lo:[1,0,0]
    ds_write_addtid_b32 v73 offset:3168
    ds_write_addtid_b32 v31 offset:3456
    v_pk_mul_f16 v74, v31, v26 op_sel:[0,0] op_sel_hi:[1,0]
    v_pk_fma_f16 v74, v31, v26, v74 op_sel:[1,1,0] op_sel_hi:[0,1,1] neg_lo:[1,0,0]
    ds_write_addtid_b32 v74 offset:3744
    v_pk_mul_f16 v68, v31, v27 op_sel:[0,0] op_sel_hi:[1,0]
    v_pk_fma_f16 v68, v31, v27, v68 op_sel:[1,1,0] op_sel_hi:[0,1,1] neg_lo:[1,0,0]
    ds_write_addtid_b32 v68 offset:4032
    v_pk_mul_f16 v75, v31, v28 op_sel:[0,0] op_sel_hi:[1,0]
    v_pk_fma_f16 v75, v31, v28, v75 op_sel:[1,1,0] op_sel_hi:[0,1,1] neg_lo:[1,0,0]
    ds_write_addtid_b32 v75 offset:4320
    ds_write_addtid_b32 v35 offset:4608
    v_pk_mul_f16 v76, v35, v32 op_sel:[0,0] op_sel_hi:[1,0]
    v_pk_fma_f16 v76, v35, v32, v76 op_sel:[1,1,0] op_sel_hi:[0,1,1] neg_hi:[1,0,0]
    ds_write_addtid_b32 v76 offset:4896
    v_pk_mul_f16 v69, v35, v33 op_sel:[0,0] op_sel_hi:[1,0]
    v_pk_fma_f16 v69, v35, v33, v69 op_sel:[1,1,0] op_sel_hi:[0,1,1] neg_hi:[1,0,0]
    ds_write_addtid_b32 v69 offset:5184
    v_pk_mul_f16 v70, v35, v34 op_sel:[0,0] op_sel_hi:[1,0]
    v_pk_fma_f16 v70, v35, v34, v70 op_sel:[1,1,0] op_sel_hi:[0,1,1] neg_hi:[1,0,0]
    ds_write_addtid_b32 v70 offset:5472
    ds_write_addtid_b32 v36 offset:5760
    v_pk_mul_f16 v71, v36, v32 op_sel:[0,0] op_sel_hi:[1,0]
    v_pk_fma_f16 v71, v36, v32, v71 op_sel:[1,1,0] op_sel_hi:[0,1,1] neg_hi:[1,0,0]
    ds_write_addtid_b32 v71 offset:6048
    v_pk_mul_f16 v72, v36, v33 op_sel:[0,0] op_sel_hi:[1,0]
    v_pk_fma_f16 v72, v36, v33, v72 op_sel:[1,1,0] op_sel_hi:[0,1,1] neg_hi:[1,0,0]
    ds_write_addtid_b32 v72 offset:6336
    v_pk_mul_f16 v73, v36, v34 op_sel:[0,0] op_sel_hi:[1,0]
    v_pk_fma_f16 v73, v36, v34, v73 op_sel:[1,1,0] op_sel_hi:[0,1,1] neg_hi:[1,0,0]
    ds_write_addtid_b32 v73 offset:6624
    ds_write_addtid_b32 v37 offset:6912
    v_pk_mul_f16 v74, v37, v32 op_sel:[0,0] op_sel_hi:[1,0]
    v_pk_fma_f16 v74, v37, v32, v74 op_sel:[1,1,0] op_sel_hi:[0,1,1] neg_hi:[1,0,0]
    ds_write_addtid_b32 v74 offset:7200
    v_pk_mul_f16 v75, v37, v33 op_sel:[0,0] op_sel_hi:[1,0]
    v_pk_fma_f16 v75, v37, v33, v75 op_sel:[1,1,0] op_sel_hi:[0,1,1] neg_hi:[1,0,0]
    ds_write_addtid_b32 v75 offset:7488
    v_pk_mul_f16 v76, v37, v34 op_sel:[0,0] op_sel_hi:[1,0]
    v_pk_fma_f16 v76, v37, v34, v76 op_sel:[1,1,0] op_sel_hi:[0,1,1] neg_hi:[1,0,0]
    ds_write_addtid_b32 v76 offset:7776
    ds_write_addtid_b32 v38 offset:8064
    v_pk_mul_f16 v69, v38, v32 op_sel:[0,0] op_sel_hi:[1,0]
    v_pk_fma_f16 v69, v38, v32, v69 op_sel:[1,1,0] op_sel_hi:[0,1,1] neg_hi:[1,0,0]
    ds_write_addtid_b32 v69 offset:8352
    v_pk_mul_f16 v70, v38, v33 op_sel:[0,0] op_sel_hi:[1,0]
    v_pk_fma_f16 v70, v38, v33, v70 op_sel:[1,1,0] op_sel_hi:[0,1,1] neg_hi:[1,0,0]
    ds_write_addtid_b32 v70 offset:8640
    v_pk_mul_f16 v71, v38, v34 op_sel:[0,0] op_sel_hi:[1,0]
    v_pk_fma_f16 v71, v38, v34, v71 op_sel:[1,1,0] op_sel_hi:[0,1,1] neg_hi:[1,0,0]
    ds_write_addtid_b32 v71 offset:8928
    ds_read_b128 v[96:99], v17 offset:0
    ds_read_b128 v[100:103], v17 offset:4608
    ds_read_b128 v[104:107], v17 offset:64
    ds_read_b128 v[108:111], v17 offset:4672
    ds_read_b128 v[112:115], v17 offset:128
    ds_read_b128 v[116:119], v17 offset:4736
    ds_read_b128 v[120:123], v17 offset:192
    ds_read_b128 v[124:127], v17 offset:4800
.p2align 3
    ds_write_addtid_b32 v39 offset:0
    v_pk_mul_f16 v72, v39, v27 op_sel:[0,0] op_sel_hi:[1,0]
    v_pk_fma_f16 v72, v39, v27, v72 op_sel:[1,1,0] op_sel_hi:[0,1,1] neg_lo:[1,0,0]
    ds_write_addtid_b32 v72 offset:288
    v_pk_mul_f16 v73, v39, v29 op_sel:[0,0] op_sel_hi:[1,0]
    v_pk_fma_f16 v73, v39, v29, v73 op_sel:[1,1,0] op_sel_hi:[0,1,1] neg_lo:[1,0,0]
    ds_write_addtid_b32 v73 offset:576
    v_pk_mul_f16 v74, v39, v66 op_sel:[0,0] op_sel_hi:[1,0]
    v_pk_fma_f16 v74, v39, v66, v74 op_sel:[1,1,0] op_sel_hi:[0,1,1] neg_lo:[1,0,0]
    ds_write_addtid_b32 v74 offset:864
    v_pk_mul_f16 v75, v39, v30 op_sel:[0,0] op_sel_hi:[1,0]
    v_pk_fma_f16 v75, v39, v30, v75 op_sel:[1,1,0] op_sel_hi:[0,1,1] neg_lo:[1,0,0]
    ds_write_addtid_b32 v75 offset:1152
    v_pk_mul_f16 v76, v39, v67 op_sel:[0,0] op_sel_hi:[1,0]
    v_pk_fma_f16 v76, v39, v67, v76 op_sel:[1,1,0] op_sel_hi:[0,1,1] neg_lo:[1,0,0]
    ds_write_addtid_b32 v76 offset:1440
    v_pk_mul_f16 v69, v39, v31 op_sel:[0,0] op_sel_hi:[1,0]
    v_pk_fma_f16 v69, v39, v31, v69 op_sel:[1,1,0] op_sel_hi:[0,1,1] neg_lo:[1,0,0]
    ds_write_addtid_b32 v69 offset:1728
    v_pk_mul_f16 v70, v39, v68 op_sel:[0,0] op_sel_hi:[1,0]
    v_pk_fma_f16 v70, v39, v68, v70 op_sel:[1,1,0] op_sel_hi:[0,1,1] neg_lo:[1,0,0]
    ds_write_addtid_b32 v70 offset:2016
    v_pk_mul_f16 v71, v39, v32 op_sel:[0,0] op_sel_hi:[1,0]
    v_pk_fma_f16 v71, v39, v32, v71 op_sel:[1,1,0] op_sel_hi:[0,1,1] neg_lo:[1,0,0]
    ds_write_addtid_b32 v71 offset:2304
    ds_write_addtid_b32 v40 offset:2592
    v_pk_mul_f16 v72, v40, v29 op_sel:[0,0] op_sel_hi:[1,0]
    v_pk_fma_f16 v72, v40, v29, v72 op_sel:[1,1,0] op_sel_hi:[0,1,1] neg_lo:[1,0,0]
    ds_write_addtid_b32 v72 offset:2880
    v_pk_mul_f16 v73, v40, v30 op_sel:[0,0] op_sel_hi:[1,0]
    v_pk_fma_f16 v73, v40, v30, v73 op_sel:[1,1,0] op_sel_hi:[0,1,1] neg_lo:[1,0,0]
    ds_write_addtid_b32 v73 offset:3168
    v_pk_mul_f16 v74, v40, v31 op_sel:[0,0] op_sel_hi:[1,0]
    v_pk_fma_f16 v74, v40, v31, v74 op_sel:[1,1,0] op_sel_hi:[0,1,1] neg_lo:[1,0,0]
    ds_write_addtid_b32 v74 offset:3456
    v_pk_mul_f16 v75, v40, v32 op_sel:[0,0] op_sel_hi:[1,0]
    v_pk_fma_f16 v75, v40, v32, v75 op_sel:[1,1,0] op_sel_hi:[0,1,1] neg_lo:[1,0,0]
    ds_write_addtid_b32 v75 offset:3744
    ds_write_addtid_b32 v41 offset:4032
    v_pk_mul_f16 v76, v41, v29 op_sel:[0,0] op_sel_hi:[1,0]
    v_pk_fma_f16 v76, v41, v29, v76 op_sel:[1,1,0] op_sel_hi:[0,1,1] neg_lo:[1,0,0]
    ds_write_addtid_b32 v76 offset:4320
    v_pk_mul_f16 v69, v41, v30 op_sel:[0,0] op_sel_hi:[1,0]
    v_pk_fma_f16 v69, v41, v30, v69 op_sel:[1,1,0] op_sel_hi:[0,1,1] neg_lo:[1,0,0]
    ds_write_addtid_b32 v69 offset:4608
    v_pk_mul_f16 v70, v41, v31 op_sel:[0,0] op_sel_hi:[1,0]
    v_pk_fma_f16 v70, v41, v31, v70 op_sel:[1,1,0] op_sel_hi:[0,1,1] neg_lo:[1,0,0]
    ds_write_addtid_b32 v70 offset:4896
    v_pk_mul_f16 v71, v41, v32 op_sel:[0,0] op_sel_hi:[1,0]
    v_pk_fma_f16 v71, v41, v32, v71 op_sel:[1,1,0] op_sel_hi:[0,1,1] neg_lo:[1,0,0]
    ds_write_addtid_b32 v71 offset:5184
    ds_write_addtid_b32 v42 offset:5472
    v_pk_mul_f16 v72, v42, v30 op_sel:[0,0] op_sel_hi:[1,0]
    v_pk_fma_f16 v72, v42, v30, v72 op_sel:[1,1,0] op_sel_hi:[0,1,1] neg_lo:[1,0,0]
    ds_write_addtid_b32 v72 offset:5760
    v_pk_mul_f16 v73, v42, v32 op_sel:[0,0] op_sel_hi:[1,0]
    v_pk_fma_f16 v73, v42, v32, v73 op_sel:[1,1,0] op_sel_hi:[0,1,1] neg_lo:[1,0,0]
    ds_write_addtid_b32 v73 offset:6048
    ds_write_addtid_b32 v43 offset:6336
    v_pk_mul_f16 v74, v43, v30 op_sel:[0,0] op_sel_hi:[1,0]
    v_pk_fma_f16 v74, v43, v30, v74 op_sel:[1,1,0] op_sel_hi:[0,1,1] neg_lo:[1,0,0]
    ds_write_addtid_b32 v74 offset:6624
    v_pk_mul_f16 v75, v43, v32 op_sel:[0,0] op_sel_hi:[1,0]
    v_pk_fma_f16 v75, v43, v32, v75 op_sel:[1,1,0] op_sel_hi:[0,1,1] neg_lo:[1,0,0]
    ds_write_addtid_b32 v75 offset:6912
    ds_write_addtid_b32 v44 offset:7200
    v_pk_mul_f16 v76, v44, v30 op_sel:[0,0] op_sel_hi:[1,0]
    v_pk_fma_f16 v76, v44, v30, v76 op_sel:[1,1,0] op_sel_hi:[0,1,1] neg_lo:[1,0,0]
    ds_write_addtid_b32 v76 offset:7488
    v_pk_mul_f16 v69, v44, v32 op_sel:[0,0] op_sel_hi:[1,0]
    v_pk_fma_f16 v69, v44, v32, v69 op_sel:[1,1,0] op_sel_hi:[0,1,1] neg_lo:[1,0,0]
    ds_write_addtid_b32 v69 offset:7776
    ds_write_addtid_b32 v45 offset:8064
    v_pk_mul_f16 v70, v45, v30 op_sel:[0,0] op_sel_hi:[1,0]
    v_pk_fma_f16 v70, v45, v30, v70 op_sel:[1,1,0] op_sel_hi:[0,1,1] neg_lo:[1,0,0]
    ds_write_addtid_b32 v70 offset:8352
    v_pk_mul_f16 v71, v45, v32 op_sel:[0,0] op_sel_hi:[1,0]
    v_pk_fma_f16 v71, v45, v32, v71 op_sel:[1,1,0] op_sel_hi:[0,1,1] neg_lo:[1,0,0]
    ds_write_addtid_b32 v71 offset:8640
    s_waitcnt lgkmcnt(14)
    ds_read_b128 v[128:131], v18 offset:0
    ds_read_b128 v[132:135], v19 offset:0
    ds_read_b128 v[136:139], v20 offset:0
    ds_read_b128 v[140:143], v18 offset:64
    ds_read_b128 v[144:147], v19 offset:64
    ds_read_b128 v[148:151], v20 offset:64
    v_mfma_f32_16x16x32_f16 v[80:83], v[96:99], v[100:103], 0
    v_mfma_f32_16x16x32_f16 v[80:83], v[104:107], v[108:111], v[80:83]
    v_mfma_f32_16x16x32_f16 v[80:83], v[112:115], v[116:119], v[80:83]
    v_mfma_f32_16x16x32_f16 v[80:83], v[120:123], v[124:127], v[80:83]
    s_waitcnt lgkmcnt(3)
    v_mfma_f32_16x16x32_f16 v[84:87], v[128:131], v[100:103], 0
    v_mfma_f32_16x16x32_f16 v[88:91], v[132:135], v[100:103], 0
    v_mfma_f32_16x16x32_f16 v[92:95], v[136:139], v[100:103], 0
    ds_read_b128 v[128:131], v18 offset:128
    ds_read_b128 v[132:135], v19 offset:128
    ds_read_b128 v[136:139], v20 offset:128
    s_waitcnt lgkmcnt(3)
    v_mfma_f32_16x16x32_f16 v[84:87], v[140:143], v[108:111], v[84:87]
    v_mfma_f32_16x16x32_f16 v[88:91], v[144:147], v[108:111], v[88:91]
    v_mfma_f32_16x16x32_f16 v[92:95], v[148:151], v[108:111], v[92:95]
    ds_read_b128 v[140:143], v18 offset:192
    ds_read_b128 v[144:147], v19 offset:192
    ds_read_b128 v[148:151], v20 offset:192
    s_waitcnt lgkmcnt(3)
    v_mfma_f32_16x16x32_f16 v[84:87], v[128:131], v[116:119], v[84:87]
    v_mfma_f32_16x16x32_f16 v[88:91], v[132:135], v[116:119], v[88:91]
    v_mfma_f32_16x16x32_f16 v[92:95], v[136:139], v[116:119], v[92:95]
    s_waitcnt lgkmcnt(0)
    v_mfma_f32_16x16x32_f16 v[84:87], v[140:143], v[124:127], v[84:87]
    v_mfma_f32_16x16x32_f16 v[88:91], v[144:147], v[124:127], v[88:91]
    v_mfma_f32_16x16x32_f16 v[92:95], v[148:151], v[124:127], v[92:95]
    v_mov_b32 v24, 0x3c00
.p2align 3
    ds_write_addtid_b32 v24 offset:0
    ds_write_addtid_b32 v46 offset:288
    ds_write_addtid_b32 v47 offset:576
    ds_write_addtid_b32 v48 offset:864
    ds_write_addtid_b32 v49 offset:1152
    v_pk_mul_f16 v72, v49, v46 op_sel:[0,0] op_sel_hi:[1,0]
    v_pk_fma_f16 v72, v49, v46, v72 op_sel:[1,1,0] op_sel_hi:[0,1,1] neg_lo:[1,0,0]
    ds_write_addtid_b32 v72 offset:1440
    v_pk_mul_f16 v66, v49, v47 op_sel:[0,0] op_sel_hi:[1,0]
    v_pk_fma_f16 v66, v49, v47, v66 op_sel:[1,1,0] op_sel_hi:[0,1,1] neg_lo:[1,0,0]
    ds_write_addtid_b32 v66 offset:1728
    v_pk_mul_f16 v73, v49, v48 op_sel:[0,0] op_sel_hi:[1,0]
    v_pk_fma_f16 v73, v49, v48, v73 op_sel:[1,1,0] op_sel_hi:[0,1,1] neg_lo:[1,0,0]
    ds_write_addtid_b32 v73 offset:2016
    ds_write_addtid_b32 v50 offset:2304
    v_pk_mul_f16 v74, v50, v46 op_sel:[0,0] op_sel_hi:[1,0]
    v_pk_fma_f16 v74, v50, v46, v74 op_sel:[1,1,0] op_sel_hi:[0,1,1] neg_lo:[1,0,0]
    ds_write_addtid_b32 v74 offset:2592
    v_pk_mul_f16 v67, v50, v47 op_sel:[0,0] op_sel_hi:[1,0]
    v_pk_fma_f16 v67, v50, v47, v67 op_sel:[1,1,0] op_sel_hi:[0,1,1] neg_lo:[1,0,0]
    ds_write_addtid_b32 v67 offset:2880
    v_pk_mul_f16 v75, v50, v48 op_sel:[0,0] op_sel_hi:[1,0]
    v_pk_fma_f16 v75, v50, v48, v75 op_sel:[1,1,0] op_sel_hi:[0,1,1] neg_lo:[1,0,0]
    ds_write_addtid_b32 v75 offset:3168
    ds_write_addtid_b32 v51 offset:3456
    v_pk_mul_f16 v76, v51, v46 op_sel:[0,0] op_sel_hi:[1,0]
    v_pk_fma_f16 v76, v51, v46, v76 op_sel:[1,1,0] op_sel_hi:[0,1,1] neg_lo:[1,0,0]
    ds_write_addtid_b32 v76 offset:3744
    v_pk_mul_f16 v68, v51, v47 op_sel:[0,0] op_sel_hi:[1,0]
    v_pk_fma_f16 v68, v51, v47, v68 op_sel:[1,1,0] op_sel_hi:[0,1,1] neg_lo:[1,0,0]
    ds_write_addtid_b32 v68 offset:4032
    v_pk_mul_f16 v69, v51, v48 op_sel:[0,0] op_sel_hi:[1,0]
    v_pk_fma_f16 v69, v51, v48, v69 op_sel:[1,1,0] op_sel_hi:[0,1,1] neg_lo:[1,0,0]
    ds_write_addtid_b32 v69 offset:4320
    ds_write_addtid_b32 v55 offset:4608
    v_pk_mul_f16 v70, v55, v52 op_sel:[0,0] op_sel_hi:[1,0]
    v_pk_fma_f16 v70, v55, v52, v70 op_sel:[1,1,0] op_sel_hi:[0,1,1] neg_hi:[1,0,0]
    ds_write_addtid_b32 v70 offset:4896
    v_pk_mul_f16 v71, v55, v53 op_sel:[0,0] op_sel_hi:[1,0]
    v_pk_fma_f16 v71, v55, v53, v71 op_sel:[1,1,0] op_sel_hi:[0,1,1] neg_hi:[1,0,0]
    ds_write_addtid_b32 v71 offset:5184
    v_pk_mul_f16 v72, v55, v54 op_sel:[0,0] op_sel_hi:[1,0]
    v_pk_fma_f16 v72, v55, v54, v72 op_sel:[1,1,0] op_sel_hi:[0,1,1] neg_hi:[1,0,0]
    ds_write_addtid_b32 v72 offset:5472
    ds_write_addtid_b32 v56 offset:5760
    v_pk_mul_f16 v73, v56, v52 op_sel:[0,0] op_sel_hi:[1,0]
    v_pk_fma_f16 v73, v56, v52, v73 op_sel:[1,1,0] op_sel_hi:[0,1,1] neg_hi:[1,0,0]
    ds_write_addtid_b32 v73 offset:6048
    v_pk_mul_f16 v74, v56, v53 op_sel:[0,0] op_sel_hi:[1,0]
    v_pk_fma_f16 v74, v56, v53, v74 op_sel:[1,1,0] op_sel_hi:[0,1,1] neg_hi:[1,0,0]
    ds_write_addtid_b32 v74 offset:6336
    v_pk_mul_f16 v75, v56, v54 op_sel:[0,0] op_sel_hi:[1,0]
    v_pk_fma_f16 v75, v56, v54, v75 op_sel:[1,1,0] op_sel_hi:[0,1,1] neg_hi:[1,0,0]
    ds_write_addtid_b32 v75 offset:6624
    ds_write_addtid_b32 v57 offset:6912
    v_pk_mul_f16 v76, v57, v52 op_sel:[0,0] op_sel_hi:[1,0]
    v_pk_fma_f16 v76, v57, v52, v76 op_sel:[1,1,0] op_sel_hi:[0,1,1] neg_hi:[1,0,0]
    ds_write_addtid_b32 v76 offset:7200
    v_pk_mul_f16 v69, v57, v53 op_sel:[0,0] op_sel_hi:[1,0]
    v_pk_fma_f16 v69, v57, v53, v69 op_sel:[1,1,0] op_sel_hi:[0,1,1] neg_hi:[1,0,0]
    ds_write_addtid_b32 v69 offset:7488
    v_pk_mul_f16 v70, v57, v54 op_sel:[0,0] op_sel_hi:[1,0]
    v_pk_fma_f16 v70, v57, v54, v70 op_sel:[1,1,0] op_sel_hi:[0,1,1] neg_hi:[1,0,0]
    ds_write_addtid_b32 v70 offset:7776
    ds_write_addtid_b32 v58 offset:8064
    v_pk_mul_f16 v71, v58, v52 op_sel:[0,0] op_sel_hi:[1,0]
    v_pk_fma_f16 v71, v58, v52, v71 op_sel:[1,1,0] op_sel_hi:[0,1,1] neg_hi:[1,0,0]
    ds_write_addtid_b32 v71 offset:8352
    v_pk_mul_f16 v72, v58, v53 op_sel:[0,0] op_sel_hi:[1,0]
    v_pk_fma_f16 v72, v58, v53, v72 op_sel:[1,1,0] op_sel_hi:[0,1,1] neg_hi:[1,0,0]
    ds_write_addtid_b32 v72 offset:8640
    v_pk_mul_f16 v73, v58, v54 op_sel:[0,0] op_sel_hi:[1,0]
    v_pk_fma_f16 v73, v58, v54, v73 op_sel:[1,1,0] op_sel_hi:[0,1,1] neg_hi:[1,0,0]
    ds_write_addtid_b32 v73 offset:8928
    ds_read_b128 v[96:99], v17 offset:0
    ds_read_b128 v[100:103], v17 offset:4608
    ds_read_b128 v[104:107], v17 offset:64
    ds_read_b128 v[108:111], v17 offset:4672
    ds_read_b128 v[112:115], v17 offset:128
    ds_read_b128 v[116:119], v17 offset:4736
    ds_read_b128 v[120:123], v17 offset:192
    ds_read_b128 v[124:127], v17 offset:4800
.p2align 3
    ds_write_addtid_b32 v59 offset:0
    v_pk_mul_f16 v74, v59, v47 op_sel:[0,0] op_sel_hi:[1,0]
    v_pk_fma_f16 v74, v59, v47, v74 op_sel:[1,1,0] op_sel_hi:[0,1,1] neg_lo:[1,0,0]
    ds_write_addtid_b32 v74 offset:288
    v_pk_mul_f16 v75, v59, v49 op_sel:[0,0] op_sel_hi:[1,0]
    v_pk_fma_f16 v75, v59, v49, v75 op_sel:[1,1,0] op_sel_hi:[0,1,1] neg_lo:[1,0,0]
    ds_write_addtid_b32 v75 offset:576
    v_pk_mul_f16 v76, v59, v66 op_sel:[0,0] op_sel_hi:[1,0]
    v_pk_fma_f16 v76, v59, v66, v76 op_sel:[1,1,0] op_sel_hi:[0,1,1] neg_lo:[1,0,0]
    ds_write_addtid_b32 v76 offset:864
    v_pk_mul_f16 v69, v59, v50 op_sel:[0,0] op_sel_hi:[1,0]
    v_pk_fma_f16 v69, v59, v50, v69 op_sel:[1,1,0] op_sel_hi:[0,1,1] neg_lo:[1,0,0]
    ds_write_addtid_b32 v69 offset:1152
    v_pk_mul_f16 v70, v59, v67 op_sel:[0,0] op_sel_hi:[1,0]
    v_pk_fma_f16 v70, v59, v67, v70 op_sel:[1,1,0] op_sel_hi:[0,1,1] neg_lo:[1,0,0]
    ds_write_addtid_b32 v70 offset:1440
    v_pk_mul_f16 v71, v59, v51 op_sel:[0,0] op_sel_hi:[1,0]
    v_pk_fma_f16 v71, v59, v51, v71 op_sel:[1,1,0] op_sel_hi:[0,1,1] neg_lo:[1,0,0]
    ds_write_addtid_b32 v71 offset:1728
    v_pk_mul_f16 v72, v59, v68 op_sel:[0,0] op_sel_hi:[1,0]
    v_pk_fma_f16 v72, v59, v68, v72 op_sel:[1,1,0] op_sel_hi:[0,1,1] neg_lo:[1,0,0]
    ds_write_addtid_b32 v72 offset:2016
    v_pk_mul_f16 v73, v59, v52 op_sel:[0,0] op_sel_hi:[1,0]
    v_pk_fma_f16 v73, v59, v52, v73 op_sel:[1,1,0] op_sel_hi:[0,1,1] neg_lo:[1,0,0]
    ds_write_addtid_b32 v73 offset:2304
    ds_write_addtid_b32 v60 offset:2592
    v_pk_mul_f16 v74, v60, v49 op_sel:[0,0] op_sel_hi:[1,0]
    v_pk_fma_f16 v74, v60, v49, v74 op_sel:[1,1,0] op_sel_hi:[0,1,1] neg_lo:[1,0,0]
    ds_write_addtid_b32 v74 offset:2880
    v_pk_mul_f16 v75, v60, v50 op_sel:[0,0] op_sel_hi:[1,0]
    v_pk_fma_f16 v75, v60, v50, v75 op_sel:[1,1,0] op_sel_hi:[0,1,1] neg_lo:[1,0,0]
    ds_write_addtid_b32 v75 offset:3168
    v_pk_mul_f16 v76, v60, v51 op_sel:[0,0] op_sel_hi:[1,0]
    v_pk_fma_f16 v76, v60, v51, v76 op_sel:[1,1,0] op_sel_hi:[0,1,1] neg_lo:[1,0,0]
    ds_write_addtid_b32 v76 offset:3456
    v_pk_mul_f16 v69, v60, v52 op_sel:[0,0] op_sel_hi:[1,0]
    v_pk_fma_f16 v69, v60, v52, v69 op_sel:[1,1,0] op_sel_hi:[0,1,1] neg_lo:[1,0,0]
    ds_write_addtid_b32 v69 offset:3744
    ds_write_addtid_b32 v61 offset:4032
    v_pk_mul_f16 v70, v61, v49 op_sel:[0,0] op_sel_hi:[1,0]
    v_pk_fma_f16 v70, v61, v49, v70 op_sel:[1,1,0] op_sel_hi:[0,1,1] neg_lo:[1,0,0]
    ds_write_addtid_b32 v70 offset:4320
    v_pk_mul_f16 v71, v61, v50 op_sel:[0,0] op_sel_hi:[1,0]
    v_pk_fma_f16 v71, v61, v50, v71 op_sel:[1,1,0] op_sel_hi:[0,1,1] neg_lo:[1,0,0]
    ds_write_addtid_b32 v71 offset:4608
    v_pk_mul_f16 v72, v61, v51 op_sel:[0,0] op_sel_hi:[1,0]
    v_pk_fma_f16 v72, v61, v51, v72 op_sel:[1,1,0] op_sel_hi:[0,1,1] neg_lo:[1,0,0]
    ds_write_addtid_b32 v72 offset:4896
    v_pk_mul_f16 v73, v61, v52 op_sel:[0,0] op_sel_hi:[1,0]
    v_pk_fma_f16 v73, v61, v52, v73 op_sel:[1,1,0] op_sel_hi:[0,1,1] neg_lo:[1,0,0]
    ds_write_addtid_b32 v73 offset:5184
    ds_write_addtid_b32 v62 offset:5472
    v_pk_mul_f16 v74, v62, v50 op_sel:[0,0] op_sel_hi:[1,0]
    v_pk_fma_f16 v74, v62, v50, v74 op_sel:[1,1,0] op_sel_hi:[0,1,1] neg_lo:[1,0,0]
    ds_write_addtid_b32 v74 offset:5760
    v_pk_mul_f16 v75, v62, v52 op_sel:[0,0] op_sel_hi:[1,0]
    v_pk_fma_f16 v75, v62, v52, v75 op_sel:[1,1,0] op_sel_hi:[0,1,1] neg_lo:[1,0,0]
    ds_write_addtid_b32 v75 offset:6048
    ds_write_addtid_b32 v63 offset:6336
    v_pk_mul_f16 v76, v63, v50 op_sel:[0,0] op_sel_hi:[1,0]
    v_pk_fma_f16 v76, v63, v50, v76 op_sel:[1,1,0] op_sel_hi:[0,1,1] neg_lo:[1,0,0]
    ds_write_addtid_b32 v76 offset:6624
    v_pk_mul_f16 v69, v63, v52 op_sel:[0,0] op_sel_hi:[1,0]
    v_pk_fma_f16 v69, v63, v52, v69 op_sel:[1,1,0] op_sel_hi:[0,1,1] neg_lo:[1,0,0]
    ds_write_addtid_b32 v69 offset:6912
    ds_write_addtid_b32 v64 offset:7200
    v_pk_mul_f16 v70, v64, v50 op_sel:[0,0] op_sel_hi:[1,0]
    v_pk_fma_f16 v70, v64, v50, v70 op_sel:[1,1,0] op_sel_hi:[0,1,1] neg_lo:[1,0,0]
    ds_write_addtid_b32 v70 offset:7488
    v_pk_mul_f16 v71, v64, v52 op_sel:[0,0] op_sel_hi:[1,0]
    v_pk_fma_f16 v71, v64, v52, v71 op_sel:[1,1,0] op_sel_hi:[0,1,1] neg_lo:[1,0,0]
    ds_write_addtid_b32 v71 offset:7776
    ds_write_addtid_b32 v65 offset:8064
    v_pk_mul_f16 v72, v65, v50 op_sel:[0,0] op_sel_hi:[1,0]
    v_pk_fma_f16 v72, v65, v50, v72 op_sel:[1,1,0] op_sel_hi:[0,1,1] neg_lo:[1,0,0]
    ds_write_addtid_b32 v72 offset:8352
    v_pk_mul_f16 v73, v65, v52 op_sel:[0,0] op_sel_hi:[1,0]
    v_pk_fma_f16 v73, v65, v52, v73 op_sel:[1,1,0] op_sel_hi:[0,1,1] neg_lo:[1,0,0]
    ds_write_addtid_b32 v73 offset:8640
    s_waitcnt lgkmcnt(14)
    ds_read_b128 v[128:131], v18 offset:0
    ds_read_b128 v[132:135], v19 offset:0
    ds_read_b128 v[136:139], v20 offset:0
    ds_read_b128 v[140:143], v18 offset:64
    ds_read_b128 v[144:147], v19 offset:64
    ds_read_b128 v[148:151], v20 offset:64
    v_mfma_f32_16x16x32_f16 v[80:83], v[96:99], v[100:103], v[80:83]
    v_mfma_f32_16x16x32_f16 v[80:83], v[104:107], v[108:111], v[80:83]
    v_mfma_f32_16x16x32_f16 v[80:83], v[112:115], v[116:119], v[80:83]
    v_mfma_f32_16x16x32_f16 v[80:83], v[120:123], v[124:127], v[80:83]
    s_waitcnt lgkmcnt(3)
    v_mfma_f32_16x16x32_f16 v[84:87], v[128:131], v[100:103], v[84:87]
    v_mfma_f32_16x16x32_f16 v[88:91], v[132:135], v[100:103], v[88:91]
    v_mfma_f32_16x16x32_f16 v[92:95], v[136:139], v[100:103], v[92:95]
    ds_read_b128 v[128:131], v18 offset:128
    ds_read_b128 v[132:135], v19 offset:128
    ds_read_b128 v[136:139], v20 offset:128
    s_waitcnt lgkmcnt(3)
    v_mfma_f32_16x16x32_f16 v[84:87], v[140:143], v[108:111], v[84:87]
    v_mfma_f32_16x16x32_f16 v[88:91], v[144:147], v[108:111], v[88:91]
    v_mfma_f32_16x16x32_f16 v[92:95], v[148:151], v[108:111], v[92:95]
    ds_read_b128 v[140:143], v18 offset:192
    ds_read_b128 v[144:147], v19 offset:192
    ds_read_b128 v[148:151], v20 offset:192
    s_waitcnt lgkmcnt(3)
    v_mfma_f32_16x16x32_f16 v[84:87], v[128:131], v[116:119], v[84:87]
    v_mfma_f32_16x16x32_f16 v[88:91], v[132:135], v[116:119], v[88:91]
    v_mfma_f32_16x16x32_f16 v[92:95], v[136:139], v[116:119], v[92:95]
    s_waitcnt lgkmcnt(0)
    v_mfma_f32_16x16x32_f16 v[84:87], v[140:143], v[124:127], v[84:87]
    v_mfma_f32_16x16x32_f16 v[88:91], v[144:147], v[124:127], v[88:91]
    v_mfma_f32_16x16x32_f16 v[92:95], v[148:151], v[124:127], v[92:95]
    v_mul_f32 v24, s57, v23
    v_mul_f32 v80, v80, v24
    v_mul_f32 v81, v81, v24
    v_mul_f32 v82, v82, v24
    v_mul_f32 v83, v83, v24
    s_nop 0
    v_mul_f32 v84, v84, v24
    v_mul_f32 v85, v85, v24
    v_mul_f32 v86, v86, v24
    v_mul_f32 v87, v87, v24
    v_mul_f32 v88, v88, v24
    v_mul_f32 v89, v89, v24
    v_mul_f32 v90, v90, v24
    v_mul_f32 v92, v92, v24
    v_mul_f32 v93, v93, v24
    v_mul_f32 v94, v94, v24
    v_cvt_pk_bf16_f32 v96, v83, v82
    v_cvt_pk_bf16_f32 v97, v81, v80
    v_cvt_pk_bf16_f32 v98, v87, v86
    v_cvt_pk_bf16_f32 v99, v85, v84
    v_cvt_pk_bf16_f32 v100, v90, v90
    v_cvt_pk_bf16_f32 v101, v89, v89
    v_cvt_pk_bf16_f32 v102, v89, v88
    v_cvt_pk_bf16_f32 v103, v88, v88
    v_cvt_pk_bf16_f32 v104, v94, v94
    v_cvt_pk_bf16_f32 v105, v94, v94
    v_cvt_pk_bf16_f32 v106, v93, v93
    v_cvt_pk_bf16_f32 v107, v93, v93
    v_cvt_pk_bf16_f32 v108, v93, v93
    v_cvt_pk_bf16_f32 v109, v93, v92
    v_cvt_pk_bf16_f32 v110, v92, v92
    v_cvt_pk_bf16_f32 v111, v92, v92
    ds_write_b64 v9, v[96:97] offset:3608
    ds_write_b64 v9, v[98:99] offset:3096
    ds_write_b128 v10, v[100:103] offset:2576
    ds_write_b128 v11, v[104:107] offset:1536
    ds_write_b128 v11, v[108:111] offset:1552
    buffer_load_dword v202, v200, s[36:39], 0 offen offset:240 sc1
    s_waitcnt lgkmcnt(0)
    s_barrier
    s_mov_b32 m0, s52
    ds_read_b64 v[48:49], v6 offset:0
    ds_read_b64 v[50:51], v6 offset:8
    ds_read_b128 v[80:83], v7 offset:3584
    ds_read_b128 v[84:87], v7 offset:3072
    ds_read_b128 v[88:91], v7 offset:2560
    ds_read_b128 v[92:95], v7 offset:2048
    ds_read_b64 v[52:53], v6 offset:512
    ds_read_b64 v[54:55], v6 offset:520
    ds_read_b64 v[56:57], v6 offset:1024
    ds_read_b64 v[58:59], v6 offset:1032
    ds_read_b64 v[60:61], v6 offset:1536
    ds_read_b64 v[62:63], v6 offset:1544
    s_waitcnt lgkmcnt(10)
    s_waitcnt lgkmcnt(9)
    v_mfma_f32_16x16x32_bf16 v[12:15], v[48:51], v[80:83], 0
    ds_read_b64 v[112:113], v6 offset:64
    s_waitcnt lgkmcnt(9)
    v_mfma_f32_16x16x32_bf16 v[16:19], v[48:51], v[84:87], 0
    ds_read_b64 v[114:115], v6 offset:72
    s_waitcnt lgkmcnt(9)
    v_mfma_f32_16x16x32_bf16 v[20:23], v[48:51], v[88:91], 0
    ds_read_b128 v[144:147], v7 offset:3648
    s_waitcnt lgkmcnt(9)
    v_mfma_f32_16x16x32_bf16 v[24:27], v[48:51], v[92:95], 0
    ds_read_b128 v[148:151], v7 offset:3136
    s_waitcnt lgkmcnt(8)
    v_mfma_f32_16x16x32_bf16 v[16:19], v[52:55], v[80:83], v[16:19]
    ds_read_b128 v[152:155], v7 offset:2624
    ds_read_b128 v[156:159], v7 offset:2112
    v_mfma_f32_16x16x32_bf16 v[20:23], v[52:55], v[84:87], v[20:23]
    ds_read_b64 v[116:117], v6 offset:576
    v_mfma_f32_16x16x32_bf16 v[24:27], v[52:55], v[88:91], v[24:27]
    ds_read_b64 v[118:119], v6 offset:584
    s_waitcnt lgkmcnt(10)
    v_mfma_f32_16x16x32_bf16 v[20:23], v[56:59], v[80:83], v[20:23]
    ds_read_b64 v[120:121], v6 offset:1088
    v_mfma_f32_16x16x32_bf16 v[24:27], v[56:59], v[84:87], v[24:27]
    ds_read_b64 v[122:123], v6 offset:1096
    s_waitcnt lgkmcnt(10)
    v_mfma_f32_16x16x32_bf16 v[24:27], v[60:63], v[80:83], v[24:27]
    ds_read_b64 v[124:125], v6 offset:1600
    ds_read_b64 v[126:127], v6 offset:1608
    s_waitcnt lgkmcnt(10)
    s_waitcnt lgkmcnt(9)
    v_mfma_f32_16x16x32_bf16 v[12:15], v[112:115], v[144:147], v[12:15]
    ds_read_b64 v[48:49], v6 offset:128
    s_waitcnt lgkmcnt(9)
    v_mfma_f32_16x16x32_bf16 v[16:19], v[112:115], v[148:151], v[16:19]
    ds_read_b64 v[50:51], v6 offset:136
    s_waitcnt lgkmcnt(9)
    v_mfma_f32_16x16x32_bf16 v[20:23], v[112:115], v[152:155], v[20:23]
    ds_read_b128 v[80:83], v7 offset:3712
    s_waitcnt lgkmcnt(9)
    v_mfma_f32_16x16x32_bf16 v[24:27], v[112:115], v[156:159], v[24:27]
    ds_read_b128 v[84:87], v7 offset:3200
    s_waitcnt lgkmcnt(8)
    v_mfma_f32_16x16x32_bf16 v[16:19], v[116:119], v[144:147], v[16:19]
    ds_read_b128 v[88:91], v7 offset:2688
    ds_read_b128 v[92:95], v7 offset:2176
    v_mfma_f32_16x16x32_bf16 v[20:23], v[116:119], v[148:151], v[20:23]
    ds_read_b64 v[52:53], v6 offset:640
    v_mfma_f32_16x16x32_bf16 v[24:27], v[116:119], v[152:155], v[24:27]
    ds_read_b64 v[54:55], v6 offset:648
    s_waitcnt lgkmcnt(10)
    v_mfma_f32_16x16x32_bf16 v[20:23], v[120:123], v[144:147], v[20:23]
    ds_read_b64 v[56:57], v6 offset:1152
    v_mfma_f32_16x16x32_bf16 v[24:27], v[120:123], v[148:151], v[24:27]
    ds_read_b64 v[58:59], v6 offset:1160
    s_waitcnt lgkmcnt(10)
    v_mfma_f32_16x16x32_bf16 v[24:27], v[124:127], v[144:147], v[24:27]
    ds_read_b64 v[60:61], v6 offset:1664
    ds_read_b64 v[62:63], v6 offset:1672
    s_waitcnt lgkmcnt(10)
    s_waitcnt lgkmcnt(9)
    v_mfma_f32_16x16x32_bf16 v[12:15], v[48:51], v[80:83], v[12:15]
    ds_read_b64 v[112:113], v6 offset:192
    s_waitcnt lgkmcnt(9)
    v_mfma_f32_16x16x32_bf16 v[16:19], v[48:51], v[84:87], v[16:19]
    ds_read_b64 v[114:115], v6 offset:200
    s_waitcnt lgkmcnt(9)
    v_mfma_f32_16x16x32_bf16 v[20:23], v[48:51], v[88:91], v[20:23]
    ds_read_b128 v[144:147], v7 offset:3776
    s_waitcnt lgkmcnt(9)
    v_mfma_f32_16x16x32_bf16 v[24:27], v[48:51], v[92:95], v[24:27]
    ds_read_b128 v[148:151], v7 offset:3264
    s_waitcnt lgkmcnt(8)
    v_mfma_f32_16x16x32_bf16 v[16:19], v[52:55], v[80:83], v[16:19]
    ds_read_b128 v[152:155], v7 offset:2752
    ds_read_b128 v[156:159], v7 offset:2240
    v_mfma_f32_16x16x32_bf16 v[20:23], v[52:55], v[84:87], v[20:23]
    ds_read_b64 v[116:117], v6 offset:704
    v_mfma_f32_16x16x32_bf16 v[24:27], v[52:55], v[88:91], v[24:27]
    ds_read_b64 v[118:119], v6 offset:712
    s_waitcnt lgkmcnt(10)
    v_mfma_f32_16x16x32_bf16 v[20:23], v[56:59], v[80:83], v[20:23]
    ds_read_b64 v[120:121], v6 offset:1216
    v_mfma_f32_16x16x32_bf16 v[24:27], v[56:59], v[84:87], v[24:27]
    ds_read_b64 v[122:123], v6 offset:1224
    s_waitcnt lgkmcnt(10)
    v_mfma_f32_16x16x32_bf16 v[24:27], v[60:63], v[80:83], v[24:27]
    ds_read_b64 v[124:125], v6 offset:1728
    ds_read_b64 v[126:127], v6 offset:1736
    s_waitcnt lgkmcnt(10)
    s_waitcnt lgkmcnt(9)
    v_mfma_f32_16x16x32_bf16 v[12:15], v[112:115], v[144:147], v[12:15]
    ds_read_b64 v[48:49], v6 offset:256
    s_waitcnt lgkmcnt(9)
    v_mfma_f32_16x16x32_bf16 v[16:19], v[112:115], v[148:151], v[16:19]
    ds_read_b64 v[50:51], v6 offset:264
    s_waitcnt lgkmcnt(9)
    v_mfma_f32_16x16x32_bf16 v[20:23], v[112:115], v[152:155], v[20:23]
    ds_read_b128 v[80:83], v7 offset:3840
    s_waitcnt lgkmcnt(9)
    v_mfma_f32_16x16x32_bf16 v[24:27], v[112:115], v[156:159], v[24:27]
    ds_read_b128 v[84:87], v7 offset:3328
    ds_read_b128 v[88:91], v7 offset:2816
    s_waitcnt lgkmcnt(9)
    v_mfma_f32_16x16x32_bf16 v[16:19], v[116:119], v[144:147], v[16:19]
    ds_read_b128 v[92:95], v7 offset:2304
    v_mfma_f32_16x16x32_bf16 v[20:23], v[116:119], v[148:151], v[20:23]
    ds_read_b64 v[52:53], v6 offset:768
    v_mfma_f32_16x16x32_bf16 v[24:27], v[116:119], v[152:155], v[24:27]
    ds_read_b64 v[54:55], v6 offset:776
    ds_read_b64 v[56:57], v6 offset:1280
    s_waitcnt lgkmcnt(11)
    v_mfma_f32_16x16x32_bf16 v[20:23], v[120:123], v[144:147], v[20:23]
    ds_read_b64 v[58:59], v6 offset:1288
    v_mfma_f32_16x16x32_bf16 v[24:27], v[120:123], v[148:151], v[24:27]
    ds_read_b64 v[60:61], v6 offset:1792
    s_waitcnt lgkmcnt(11)
    v_mfma_f32_16x16x32_bf16 v[24:27], v[124:127], v[144:147], v[24:27]
    ds_read_b64 v[62:63], v6 offset:1800
    ds_read_b128 v[96:99], v7 offset:1536
    s_waitcnt lgkmcnt(11)
    s_waitcnt lgkmcnt(10)
    v_mfma_f32_16x16x32_bf16 v[12:15], v[48:51], v[80:83], v[12:15]
    ds_read_b64 v[112:113], v6 offset:320
    s_waitcnt lgkmcnt(10)
    v_mfma_f32_16x16x32_bf16 v[16:19], v[48:51], v[84:87], v[16:19]
    ds_read_b64 v[114:115], v6 offset:328
    s_waitcnt lgkmcnt(10)
    v_mfma_f32_16x16x32_bf16 v[20:23], v[48:51], v[88:91], v[20:23]
    ds_read_b128 v[144:147], v7 offset:3904
    s_waitcnt lgkmcnt(10)
    v_mfma_f32_16x16x32_bf16 v[24:27], v[48:51], v[92:95], v[24:27]
    ds_read_b128 v[148:151], v7 offset:3392
    ds_read_b128 v[152:155], v7 offset:2880
    s_waitcnt lgkmcnt(10)
    v_mfma_f32_16x16x32_bf16 v[16:19], v[52:55], v[80:83], v[16:19]
    ds_read_b128 v[156:159], v7 offset:2368
    v_mfma_f32_16x16x32_bf16 v[20:23], v[52:55], v[84:87], v[20:23]
    ds_read_b64 v[116:117], v6 offset:832
    v_mfma_f32_16x16x32_bf16 v[24:27], v[52:55], v[88:91], v[24:27]
    ds_read_b64 v[118:119], v6 offset:840
    ds_read_b64 v[120:121], v6 offset:1344
    s_waitcnt lgkmcnt(12)
    v_mfma_f32_16x16x32_bf16 v[20:23], v[56:59], v[80:83], v[20:23]
    ds_read_b64 v[122:123], v6 offset:1352
    v_mfma_f32_16x16x32_bf16 v[24:27], v[56:59], v[84:87], v[24:27]
    ds_read_b64 v[124:125], v6 offset:1856
    s_waitcnt lgkmcnt(12)
    v_mfma_f32_16x16x32_bf16 v[24:27], v[60:63], v[80:83], v[24:27]
    ds_read_b64 v[126:127], v6 offset:1864
    ds_read_b128 v[100:103], v7 offset:1024
    s_waitcnt lgkmcnt(11)
    s_waitcnt lgkmcnt(10)
    v_mfma_f32_16x16x32_bf16 v[12:15], v[112:115], v[144:147], v[12:15]
    ds_read_b64 v[48:49], v6 offset:384
    s_waitcnt lgkmcnt(10)
    v_mfma_f32_16x16x32_bf16 v[16:19], v[112:115], v[148:151], v[16:19]
    ds_read_b64 v[50:51], v6 offset:392
    s_waitcnt lgkmcnt(10)
    v_mfma_f32_16x16x32_bf16 v[20:23], v[112:115], v[152:155], v[20:23]
    ds_read_b128 v[80:83], v7 offset:3968
    s_waitcnt lgkmcnt(10)
    v_mfma_f32_16x16x32_bf16 v[24:27], v[112:115], v[156:159], v[24:27]
    ds_read_b128 v[84:87], v7 offset:3456
    ds_read_b128 v[88:91], v7 offset:2944
    s_waitcnt lgkmcnt(10)
    v_mfma_f32_16x16x32_bf16 v[16:19], v[116:119], v[144:147], v[16:19]
    ds_read_b128 v[92:95], v7 offset:2432
    v_mfma_f32_16x16x32_bf16 v[20:23], v[116:119], v[148:151], v[20:23]
    ds_read_b64 v[52:53], v6 offset:896
    v_mfma_f32_16x16x32_bf16 v[24:27], v[116:119], v[152:155], v[24:27]
    ds_read_b64 v[54:55], v6 offset:904
    ds_read_b64 v[56:57], v6 offset:1408
    s_waitcnt lgkmcnt(12)
    v_mfma_f32_16x16x32_bf16 v[20:23], v[120:123], v[144:147], v[20:23]
    ds_read_b64 v[58:59], v6 offset:1416
    v_mfma_f32_16x16x32_bf16 v[24:27], v[120:123], v[148:151], v[24:27]
    ds_read_b64 v[60:61], v6 offset:1920
    s_waitcnt lgkmcnt(12)
    v_mfma_f32_16x16x32_bf16 v[24:27], v[124:127], v[144:147], v[24:27]
    ds_read_b64 v[62:63], v6 offset:1928
    ds_read_b128 v[104:107], v7 offset:512
    s_waitcnt lgkmcnt(11)
    s_waitcnt lgkmcnt(10)
    v_mfma_f32_16x16x32_bf16 v[12:15], v[48:51], v[80:83], v[12:15]
    ds_read_b64 v[112:113], v6 offset:448
    s_waitcnt lgkmcnt(10)
    v_mfma_f32_16x16x32_bf16 v[16:19], v[48:51], v[84:87], v[16:19]
    ds_read_b64 v[114:115], v6 offset:456
    s_waitcnt lgkmcnt(10)
    v_mfma_f32_16x16x32_bf16 v[20:23], v[48:51], v[88:91], v[20:23]
    ds_read_b128 v[144:147], v7 offset:4032
    s_waitcnt lgkmcnt(10)
    v_mfma_f32_16x16x32_bf16 v[24:27], v[48:51], v[92:95], v[24:27]
    ds_read_b128 v[148:151], v7 offset:3520
    ds_read_b128 v[152:155], v7 offset:3008
    s_waitcnt lgkmcnt(10)
    v_mfma_f32_16x16x32_bf16 v[16:19], v[52:55], v[80:83], v[16:19]
    ds_read_b128 v[156:159], v7 offset:2496
    v_mfma_f32_16x16x32_bf16 v[20:23], v[52:55], v[84:87], v[20:23]
    ds_read_b64 v[116:117], v6 offset:960
    v_mfma_f32_16x16x32_bf16 v[24:27], v[52:55], v[88:91], v[24:27]
    ds_read_b64 v[118:119], v6 offset:968
    ds_read_b64 v[120:121], v6 offset:1472
    s_waitcnt lgkmcnt(12)
    v_mfma_f32_16x16x32_bf16 v[20:23], v[56:59], v[80:83], v[20:23]
    ds_read_b64 v[122:123], v6 offset:1480
    v_mfma_f32_16x16x32_bf16 v[24:27], v[56:59], v[84:87], v[24:27]
    ds_read_b64 v[124:125], v6 offset:1984
    s_waitcnt lgkmcnt(12)
    v_mfma_f32_16x16x32_bf16 v[24:27], v[60:63], v[80:83], v[24:27]
    ds_read_b64 v[126:127], v6 offset:1992
    ds_read_b128 v[108:111], v7 offset:0
    s_waitcnt lgkmcnt(11)
    s_waitcnt lgkmcnt(10)
    v_mfma_f32_16x16x32_bf16 v[12:15], v[112:115], v[144:147], v[12:15]
    ds_read_b64 v[48:49], v6 offset:0
    s_waitcnt lgkmcnt(10)
    v_mfma_f32_16x16x32_bf16 v[16:19], v[112:115], v[148:151], v[16:19]
    ds_read_b64 v[50:51], v6 offset:8
    s_waitcnt lgkmcnt(10)
    v_mfma_f32_16x16x32_bf16 v[20:23], v[112:115], v[152:155], v[20:23]
    ds_read_b64 v[52:53], v6 offset:512
    s_waitcnt lgkmcnt(10)
    v_mfma_f32_16x16x32_bf16 v[24:27], v[112:115], v[156:159], v[24:27]
    ds_read_b64 v[54:55], v6 offset:520
    s_waitcnt lgkmcnt(9)
    v_mfma_f32_16x16x32_bf16 v[16:19], v[116:119], v[144:147], v[16:19]
    ds_read_b128 v[92:95], v7 offset:2048
    ds_read_b64 v[56:57], v6 offset:1024
    v_mfma_f32_16x16x32_bf16 v[20:23], v[116:119], v[148:151], v[20:23]
    ds_read_b64 v[58:59], v6 offset:1032
    v_mfma_f32_16x16x32_bf16 v[24:27], v[116:119], v[152:155], v[24:27]
    ds_read_b128 v[88:91], v7 offset:2560
    s_waitcnt lgkmcnt(11)
    v_mfma_f32_16x16x32_bf16 v[20:23], v[120:123], v[144:147], v[20:23]
    ds_read_b64 v[60:61], v6 offset:1536
    v_mfma_f32_16x16x32_bf16 v[24:27], v[120:123], v[148:151], v[24:27]
    ds_read_b64 v[62:63], v6 offset:1544
    s_waitcnt lgkmcnt(11)
    v_mfma_f32_16x16x32_bf16 v[24:27], v[124:127], v[144:147], v[24:27]
    ds_read_b128 v[84:87], v7 offset:3072
    ds_read_b128 v[80:83], v7 offset:3584
    s_barrier
    s_waitcnt lgkmcnt(10)
    v_mfma_f32_16x16x32_bf16 v[28:31], v[48:51], v[96:99], 0
    ds_read_b64 v[64:65], v6 offset:2048
    v_mfma_f32_16x16x32_bf16 v[32:35], v[48:51], v[100:103], 0
    ds_read_b64 v[66:67], v6 offset:2056
    v_mfma_f32_16x16x32_bf16 v[36:39], v[48:51], v[104:107], 0
    ds_read_b64 v[68:69], v6 offset:2560
    v_mfma_f32_16x16x32_bf16 v[40:43], v[48:51], v[108:111], 0
    ds_read_b64 v[70:71], v6 offset:2568
    s_waitcnt lgkmcnt(12)
    s_waitcnt lgkmcnt(11)
    v_mfma_f32_16x16x32_bf16 v[28:31], v[52:55], v[92:95], v[28:31]
    ds_read_b64 v[72:73], v6 offset:3072
    ds_read_b64 v[74:75], v6 offset:3080
    v_mfma_f32_16x16x32_bf16 v[32:35], v[52:55], v[96:99], v[32:35]
    ds_read_b64 v[76:77], v6 offset:3584
    v_mfma_f32_16x16x32_bf16 v[36:39], v[52:55], v[100:103], v[36:39]
    ds_read_b64 v[78:79], v6 offset:3592
    v_mfma_f32_16x16x32_bf16 v[40:43], v[52:55], v[104:107], v[40:43]
    ds_read_b64 v[112:113], v6 offset:64
    s_waitcnt lgkmcnt(14)
    s_waitcnt lgkmcnt(13)
    v_mfma_f32_16x16x32_bf16 v[28:31], v[56:59], v[88:91], v[28:31]
    ds_read_b64 v[114:115], v6 offset:72
    ds_read_b128 v[160:163], v7 offset:1600
    v_mfma_f32_16x16x32_bf16 v[32:35], v[56:59], v[92:95], v[32:35]
    ds_read_b128 v[164:167], v7 offset:1088
    v_mfma_f32_16x16x32_bf16 v[36:39], v[56:59], v[96:99], v[36:39]
    ds_read_b128 v[168:171], v7 offset:576
    v_mfma_f32_16x16x32_bf16 v[40:43], v[56:59], v[100:103], v[40:43]
    ds_read_b128 v[172:175], v7 offset:64
    s_waitcnt lgkmcnt(14)
    v_mfma_f32_16x16x32_bf16 v[28:31], v[60:63], v[84:87], v[28:31]
    ds_read_b64 v[116:117], v6 offset:576
    ds_read_b64 v[118:119], v6 offset:584
    v_mfma_f32_16x16x32_bf16 v[32:35], v[60:63], v[88:91], v[32:35]
    ds_read_b128 v[156:159], v7 offset:2112
    v_mfma_f32_16x16x32_bf16 v[36:39], v[60:63], v[92:95], v[36:39]
    ds_read_b64 v[120:121], v6 offset:1088
    v_mfma_f32_16x16x32_bf16 v[40:43], v[60:63], v[96:99], v[40:43]
    ds_read_b64 v[122:123], v6 offset:1096
    s_waitcnt lgkmcnt(14)
    v_mfma_f32_16x16x32_bf16 v[28:31], v[64:67], v[80:83], v[28:31]
    ds_read_b128 v[152:155], v7 offset:2624
    v_mfma_f32_16x16x32_bf16 v[32:35], v[64:67], v[84:87], v[32:35]
    ds_read_b64 v[124:125], v6 offset:1600
    ds_read_b64 v[126:127], v6 offset:1608
    v_mfma_f32_16x16x32_bf16 v[36:39], v[64:67], v[88:91], v[36:39]
    ds_read_b128 v[148:151], v7 offset:3136
    v_mfma_f32_16x16x32_bf16 v[40:43], v[64:67], v[92:95], v[40:43]
    ds_read_b64 v[128:129], v6 offset:2112
    v_mfma_f32_16x16x32_bf16 v[32:35], v[68:71], v[80:83], v[32:35]
    ds_read_b64 v[130:131], v6 offset:2120
    v_mfma_f32_16x16x32_bf16 v[36:39], v[68:71], v[84:87], v[36:39]
    ds_read_b128 v[144:147], v7 offset:3648
    ds_read_b64 v[132:133], v6 offset:2624
    v_mfma_f32_16x16x32_bf16 v[40:43], v[68:71], v[88:91], v[40:43]
    ds_read_b64 v[134:135], v6 offset:2632
    s_waitcnt lgkmcnt(14)
    v_mfma_f32_16x16x32_bf16 v[36:39], v[72:75], v[80:83], v[36:39]
    ds_read_b64 v[136:137], v6 offset:3136
    v_mfma_f32_16x16x32_bf16 v[40:43], v[72:75], v[84:87], v[40:43]
    ds_read_b64 v[138:139], v6 offset:3144
    v_mfma_f32_16x16x32_bf16 v[40:43], v[76:79], v[80:83], v[40:43]
    ds_read_b64 v[140:141], v6 offset:3648
    ds_read_b64 v[142:143], v6 offset:3656
    v_mfma_f32_16x16x32_bf16 v[28:31], v[112:115], v[160:163], v[28:31]
    ds_read_b64 v[48:49], v6 offset:128
    v_cvt_pk_bf16_f32 v176, v12, v13
    v_mfma_f32_16x16x32_bf16 v[32:35], v[112:115], v[164:167], v[32:35]
    ds_read_b64 v[50:51], v6 offset:136
    v_cvt_pk_bf16_f32 v177, v14, v15
    v_mfma_f32_16x16x32_bf16 v[36:39], v[112:115], v[168:171], v[36:39]
    ds_read_b128 v[96:99], v7 offset:1664
    v_cvt_pk_bf16_f32 v178, v16, v17
    v_mfma_f32_16x16x32_bf16 v[40:43], v[112:115], v[172:175], v[40:43]
    ds_read_b128 v[100:103], v7 offset:1152
    v_cvt_pk_bf16_f32 v179, v18, v19
    s_waitcnt lgkmcnt(14)
    v_mfma_f32_16x16x32_bf16 v[28:31], v[116:119], v[156:159], v[28:31]
    ds_read_b128 v[104:107], v7 offset:640
    v_cvt_pk_bf16_f32 v180, v20, v21
    v_mfma_f32_16x16x32_bf16 v[32:35], v[116:119], v[160:163], v[32:35]
    ds_read_b128 v[108:111], v7 offset:128
    v_cvt_pk_bf16_f32 v181, v22, v23
    v_mfma_f32_16x16x32_bf16 v[36:39], v[116:119], v[164:167], v[36:39]
    ds_read_b64 v[52:53], v6 offset:640
    v_cvt_pk_bf16_f32 v182, v24, v25
    v_mfma_f32_16x16x32_bf16 v[40:43], v[116:119], v[168:171], v[40:43]
    ds_read_b64 v[54:55], v6 offset:648
    v_cvt_pk_bf16_f32 v183, v26, v27
    v_mfma_f32_16x16x32_bf16 v[28:31], v[120:123], v[152:155], v[28:31]
    ds_read_b128 v[92:95], v7 offset:2176
    v_mfma_f32_16x16x32_bf16 v[32:35], v[120:123], v[156:159], v[32:35]
    ds_read_b64 v[56:57], v6 offset:1152
    v_mfma_f32_16x16x32_bf16 v[36:39], v[120:123], v[160:163], v[36:39]
    ds_read_b64 v[58:59], v6 offset:1160
    v_mfma_f32_16x16x32_bf16 v[40:43], v[120:123], v[164:167], v[40:43]
    ds_read_b128 v[88:91], v7 offset:2688
    s_waitcnt lgkmcnt(14)
    v_mfma_f32_16x16x32_bf16 v[28:31], v[124:127], v[148:151], v[28:31]
    ds_read_b64 v[60:61], v6 offset:1664
    v_mfma_f32_16x16x32_bf16 v[32:35], v[124:127], v[152:155], v[32:35]
    ds_read_b64 v[62:63], v6 offset:1672
    v_mfma_f32_16x16x32_bf16 v[36:39], v[124:127], v[156:159], v[36:39]
    ds_read_b128 v[84:87], v7 offset:3200
    v_mfma_f32_16x16x32_bf16 v[40:43], v[124:127], v[160:163], v[40:43]
    ds_read_b64 v[64:65], v6 offset:2176
    v_mfma_f32_16x16x32_bf16 v[28:31], v[128:131], v[144:147], v[28:31]
    ds_read_b64 v[66:67], v6 offset:2184
    v_mfma_f32_16x16x32_bf16 v[32:35], v[128:131], v[148:151], v[32:35]
    ds_read_b128 v[80:83], v7 offset:3712
    v_mfma_f32_16x16x32_bf16 v[36:39], v[128:131], v[152:155], v[36:39]
    ds_read_b64 v[68:69], v6 offset:2688
    v_mfma_f32_16x16x32_bf16 v[40:43], v[128:131], v[156:159], v[40:43]
    ds_read_b64 v[70:71], v6 offset:2696
    v_mfma_f32_16x16x32_bf16 v[32:35], v[132:135], v[144:147], v[32:35]
    ds_read_b64 v[72:73], v6 offset:3200
    v_mfma_f32_16x16x32_bf16 v[36:39], v[132:135], v[148:151], v[36:39]
    ds_read_b64 v[74:75], v6 offset:3208
    v_mfma_f32_16x16x32_bf16 v[40:43], v[132:135], v[152:155], v[40:43]
    ds_read_b64 v[76:77], v6 offset:3712
    v_mfma_f32_16x16x32_bf16 v[36:39], v[136:139], v[144:147], v[36:39]
    ds_read_b64 v[78:79], v6 offset:3720
    v_mfma_f32_16x16x32_bf16 v[40:43], v[136:139], v[148:151], v[40:43]
    s_waitcnt lgkmcnt(14)
    v_mfma_f32_16x16x32_bf16 v[40:43], v[140:143], v[144:147], v[40:43]
    v_mfma_f32_16x16x32_bf16 v[28:31], v[48:51], v[96:99], v[28:31]
    ds_read_b64 v[112:113], v6 offset:192
    v_mfma_f32_16x16x32_bf16 v[32:35], v[48:51], v[100:103], v[32:35]
    ds_read_b64 v[114:115], v6 offset:200
    v_mfma_f32_16x16x32_bf16 v[36:39], v[48:51], v[104:107], v[36:39]
    ds_read_b128 v[160:163], v7 offset:1728
    v_mfma_f32_16x16x32_bf16 v[40:43], v[48:51], v[108:111], v[40:43]
    ds_read_b128 v[164:167], v7 offset:1216
    v_mfma_f32_16x16x32_bf16 v[28:31], v[52:55], v[92:95], v[28:31]
    ds_read_b128 v[168:171], v7 offset:704
    v_mfma_f32_16x16x32_bf16 v[32:35], v[52:55], v[96:99], v[32:35]
    ds_read_b128 v[172:175], v7 offset:192
    v_mfma_f32_16x16x32_bf16 v[36:39], v[52:55], v[100:103], v[36:39]
    ds_read_b64 v[116:117], v6 offset:704
    v_mfma_f32_16x16x32_bf16 v[40:43], v[52:55], v[104:107], v[40:43]
    ds_read_b64 v[118:119], v6 offset:712
    s_waitcnt lgkmcnt(14)
    v_mfma_f32_16x16x32_bf16 v[28:31], v[56:59], v[88:91], v[28:31]
    ds_read_b128 v[156:159], v7 offset:2240
    v_mfma_f32_16x16x32_bf16 v[32:35], v[56:59], v[92:95], v[32:35]
    ds_read_b64 v[120:121], v6 offset:1216
    v_mfma_f32_16x16x32_bf16 v[36:39], v[56:59], v[96:99], v[36:39]
    ds_read_b64 v[122:123], v6 offset:1224
    v_mfma_f32_16x16x32_bf16 v[40:43], v[56:59], v[100:103], v[40:43]
    ds_read_b128 v[152:155], v7 offset:2752
    v_mfma_f32_16x16x32_bf16 v[28:31], v[60:63], v[84:87], v[28:31]
    ds_read_b64 v[124:125], v6 offset:1728
    v_mfma_f32_16x16x32_bf16 v[32:35], v[60:63], v[88:91], v[32:35]
    ds_read_b64 v[126:127], v6 offset:1736
    v_mfma_f32_16x16x32_bf16 v[36:39], v[60:63], v[92:95], v[36:39]
    ds_read_b128 v[148:151], v7 offset:3264
    v_mfma_f32_16x16x32_bf16 v[40:43], v[60:63], v[96:99], v[40:43]
    ds_read_b64 v[128:129], v6 offset:2240
    v_mfma_f32_16x16x32_bf16 v[28:31], v[64:67], v[80:83], v[28:31]
    ds_read_b64 v[130:131], v6 offset:2248
    v_mfma_f32_16x16x32_bf16 v[32:35], v[64:67], v[84:87], v[32:35]
    ds_read_b128 v[144:147], v7 offset:3776
    v_mfma_f32_16x16x32_bf16 v[36:39], v[64:67], v[88:91], v[36:39]
    ds_read_b64 v[132:133], v6 offset:2752
    v_mfma_f32_16x16x32_bf16 v[40:43], v[64:67], v[92:95], v[40:43]
    ds_read_b64 v[134:135], v6 offset:2760
    s_waitcnt lgkmcnt(14)
    v_mfma_f32_16x16x32_bf16 v[32:35], v[68:71], v[80:83], v[32:35]
    ds_read_b64 v[136:137], v6 offset:3264
    v_mfma_f32_16x16x32_bf16 v[36:39], v[68:71], v[84:87], v[36:39]
    ds_read_b64 v[138:139], v6 offset:3272
    v_mfma_f32_16x16x32_bf16 v[40:43], v[68:71], v[88:91], v[40:43]
    ds_read_b64 v[140:141], v6 offset:3776
    v_mfma_f32_16x16x32_bf16 v[36:39], v[72:75], v[80:83], v[36:39]
    ds_read_b64 v[142:143], v6 offset:3784
    v_mfma_f32_16x16x32_bf16 v[40:43], v[72:75], v[84:87], v[40:43]
    v_mfma_f32_16x16x32_bf16 v[40:43], v[76:79], v[80:83], v[40:43]
    s_waitcnt vmcnt(0)
bc_clr:
    v_cmp_eq_u32 vcc, 0, v202
    s_nop 0
    s_cmp_eq_u64 vcc, 0
    s_cbranch_scc1 bc_clr_ok
    s_sleep 2
    buffer_load_dword v202, v200, s[36:39], 0 offen offset:240 sc1
    s_waitcnt vmcnt(0)
    s_branch bc_clr
bc_clr_ok:
    buffer_load_dword v202, v201, s[40:43], 0 offen sc1
    v_mfma_f32_16x16x32_bf16 v[28:31], v[112:115], v[160:163], v[28:31]
    ds_read_b64 v[48:49], v6 offset:256
    v_mfma_f32_16x16x32_bf16 v[32:35], v[112:115], v[164:167], v[32:35]
    ds_read_b64 v[50:51], v6 offset:264
    v_mfma_f32_16x16x32_bf16 v[36:39], v[112:115], v[168:171], v[36:39]
    ds_read_b128 v[96:99], v7 offset:1792
    v_mfma_f32_16x16x32_bf16 v[40:43], v[112:115], v[172:175], v[40:43]
    ds_read_b128 v[100:103], v7 offset:1280
    s_waitcnt lgkmcnt(14)
    v_mfma_f32_16x16x32_bf16 v[28:31], v[116:119], v[156:159], v[28:31]
    ds_read_b128 v[104:107], v7 offset:768
    v_mfma_f32_16x16x32_bf16 v[32:35], v[116:119], v[160:163], v[32:35]
    ds_read_b128 v[108:111], v7 offset:256
    v_mfma_f32_16x16x32_bf16 v[36:39], v[116:119], v[164:167], v[36:39]
    ds_read_b64 v[52:53], v6 offset:768
    v_mfma_f32_16x16x32_bf16 v[40:43], v[116:119], v[168:171], v[40:43]
    ds_read_b64 v[54:55], v6 offset:776
    v_mfma_f32_16x16x32_bf16 v[28:31], v[120:123], v[152:155], v[28:31]
    ds_read_b128 v[92:95], v7 offset:2304
    v_mfma_f32_16x16x32_bf16 v[32:35], v[120:123], v[156:159], v[32:35]
    ds_read_b64 v[56:57], v6 offset:1280
    v_mfma_f32_16x16x32_bf16 v[36:39], v[120:123], v[160:163], v[36:39]
    ds_read_b64 v[58:59], v6 offset:1288
    v_mfma_f32_16x16x32_bf16 v[40:43], v[120:123], v[164:167], v[40:43]
    ds_read_b128 v[88:91], v7 offset:2816
    s_waitcnt lgkmcnt(14)
    v_mfma_f32_16x16x32_bf16 v[28:31], v[124:127], v[148:151], v[28:31]
    ds_read_b64 v[60:61], v6 offset:1792
    v_mfma_f32_16x16x32_bf16 v[32:35], v[124:127], v[152:155], v[32:35]
    ds_read_b64 v[62:63], v6 offset:1800
    v_mfma_f32_16x16x32_bf16 v[36:39], v[124:127], v[156:159], v[36:39]
    ds_read_b128 v[84:87], v7 offset:3328
    v_mfma_f32_16x16x32_bf16 v[40:43], v[124:127], v[160:163], v[40:43]
    ds_read_b64 v[64:65], v6 offset:2304
    v_mfma_f32_16x16x32_bf16 v[28:31], v[128:131], v[144:147], v[28:31]
    ds_read_b64 v[66:67], v6 offset:2312
    v_mfma_f32_16x16x32_bf16 v[32:35], v[128:131], v[148:151], v[32:35]
    ds_read_b128 v[80:83], v7 offset:3840
    v_mfma_f32_16x16x32_bf16 v[36:39], v[128:131], v[152:155], v[36:39]
    ds_read_b64 v[68:69], v6 offset:2816
    v_mfma_f32_16x16x32_bf16 v[40:43], v[128:131], v[156:159], v[40:43]
    ds_read_b64 v[70:71], v6 offset:2824
    v_mfma_f32_16x16x32_bf16 v[32:35], v[132:135], v[144:147], v[32:35]
    ds_read_b64 v[72:73], v6 offset:3328
    v_mfma_f32_16x16x32_bf16 v[36:39], v[132:135], v[148:151], v[36:39]
    ds_read_b64 v[74:75], v6 offset:3336
    v_mfma_f32_16x16x32_bf16 v[40:43], v[132:135], v[152:155], v[40:43]
    ds_read_b64 v[76:77], v6 offset:3840
    v_mfma_f32_16x16x32_bf16 v[36:39], v[136:139], v[144:147], v[36:39]
    ds_read_b64 v[78:79], v6 offset:3848
    v_mfma_f32_16x16x32_bf16 v[40:43], v[136:139], v[148:151], v[40:43]
    s_waitcnt lgkmcnt(14)
    v_mfma_f32_16x16x32_bf16 v[40:43], v[140:143], v[144:147], v[40:43]
    v_mfma_f32_16x16x32_bf16 v[28:31], v[48:51], v[96:99], v[28:31]
    ds_read_b64 v[112:113], v6 offset:320
    v_mfma_f32_16x16x32_bf16 v[32:35], v[48:51], v[100:103], v[32:35]
    ds_read_b64 v[114:115], v6 offset:328
    v_mfma_f32_16x16x32_bf16 v[36:39], v[48:51], v[104:107], v[36:39]
    ds_read_b128 v[160:163], v7 offset:1856
    v_mfma_f32_16x16x32_bf16 v[40:43], v[48:51], v[108:111], v[40:43]
    ds_read_b128 v[164:167], v7 offset:1344
    v_mfma_f32_16x16x32_bf16 v[28:31], v[52:55], v[92:95], v[28:31]
    ds_read_b128 v[168:171], v7 offset:832
    v_mfma_f32_16x16x32_bf16 v[32:35], v[52:55], v[96:99], v[32:35]
    ds_read_b128 v[172:175], v7 offset:320
    v_mfma_f32_16x16x32_bf16 v[36:39], v[52:55], v[100:103], v[36:39]
    ds_read_b64 v[116:117], v6 offset:832
    v_mfma_f32_16x16x32_bf16 v[40:43], v[52:55], v[104:107], v[40:43]
    ds_read_b64 v[118:119], v6 offset:840
    s_waitcnt lgkmcnt(14)
    v_mfma_f32_16x16x32_bf16 v[28:31], v[56:59], v[88:91], v[28:31]
    ds_read_b128 v[156:159], v7 offset:2368
    v_mfma_f32_16x16x32_bf16 v[32:35], v[56:59], v[92:95], v[32:35]
    ds_read_b64 v[120:121], v6 offset:1344
    v_mfma_f32_16x16x32_bf16 v[36:39], v[56:59], v[96:99], v[36:39]
    ds_read_b64 v[122:123], v6 offset:1352
    v_mfma_f32_16x16x32_bf16 v[40:43], v[56:59], v[100:103], v[40:43]
    ds_read_b128 v[152:155], v7 offset:2880
    v_mfma_f32_16x16x32_bf16 v[28:31], v[60:63], v[84:87], v[28:31]
    ds_read_b64 v[124:125], v6 offset:1856
    v_mfma_f32_16x16x32_bf16 v[32:35], v[60:63], v[88:91], v[32:35]
    ds_read_b64 v[126:127], v6 offset:1864
    v_mfma_f32_16x16x32_bf16 v[36:39], v[60:63], v[92:95], v[36:39]
    ds_read_b128 v[148:151], v7 offset:3392
    v_mfma_f32_16x16x32_bf16 v[40:43], v[60:63], v[96:99], v[40:43]
    ds_read_b64 v[128:129], v6 offset:2368
    v_mfma_f32_16x16x32_bf16 v[28:31], v[64:67], v[80:83], v[28:31]
    ds_read_b64 v[130:131], v6 offset:2376
    v_mfma_f32_16x16x32_bf16 v[32:35], v[64:67], v[84:87], v[32:35]
    ds_read_b128 v[144:147], v7 offset:3904
    v_mfma_f32_16x16x32_bf16 v[36:39], v[64:67], v[88:91], v[36:39]
    ds_read_b64 v[132:133], v6 offset:2880
    v_mfma_f32_16x16x32_bf16 v[40:43], v[64:67], v[92:95], v[40:43]
    ds_read_b64 v[134:135], v6 offset:2888
    s_waitcnt lgkmcnt(14)
    v_mfma_f32_16x16x32_bf16 v[32:35], v[68:71], v[80:83], v[32:35]
    ds_read_b64 v[136:137], v6 offset:3392
    v_mfma_f32_16x16x32_bf16 v[36:39], v[68:71], v[84:87], v[36:39]
    ds_read_b64 v[138:139], v6 offset:3400
    v_mfma_f32_16x16x32_bf16 v[40:43], v[68:71], v[88:91], v[40:43]
    ds_read_b64 v[140:141], v6 offset:3904
    v_mfma_f32_16x16x32_bf16 v[36:39], v[72:75], v[80:83], v[36:39]
    ds_read_b64 v[142:143], v6 offset:3912
    v_mfma_f32_16x16x32_bf16 v[40:43], v[72:75], v[84:87], v[40:43]
    v_mfma_f32_16x16x32_bf16 v[40:43], v[76:79], v[80:83], v[40:43]
bc_kp:
    s_waitcnt vmcnt(0)
    v_cmp_eq_u32 vcc, 1, v202
    s_nop 0
    s_cmp_lg_u64 vcc, 0
    s_cbranch_scc1 bc_kp_ok
    s_sleep 4
    buffer_load_dword v202, v201, s[40:43], 0 offen sc1
    s_branch bc_kp
bc_kp_ok:
    buffer_load_dwordx4 v[204:207], v203, s[44:47], s54 offen offset:0 sc1
    buffer_load_dwordx4 v[208:211], v203, s[44:47], s54 offen offset:1024 sc1
    buffer_load_dwordx4 v[212:215], v203, s[44:47], s54 offen offset:2048 sc1
    buffer_load_dwordx4 v[216:219], v203, s[44:47], s54 offen offset:3072 sc1
    s_barrier
    v_mfma_f32_16x16x32_bf16 v[28:31], v[112:115], v[160:163], v[28:31]
    ds_read_b64 v[48:49], v6 offset:384
    v_mfma_f32_16x16x32_bf16 v[32:35], v[112:115], v[164:167], v[32:35]
    ds_read_b64 v[50:51], v6 offset:392
    v_mfma_f32_16x16x32_bf16 v[36:39], v[112:115], v[168:171], v[36:39]
    ds_read_b128 v[96:99], v7 offset:1920
    v_mfma_f32_16x16x32_bf16 v[40:43], v[112:115], v[172:175], v[40:43]
    ds_read_b128 v[100:103], v7 offset:1408
    s_waitcnt lgkmcnt(14)
    v_mfma_f32_16x16x32_bf16 v[28:31], v[116:119], v[156:159], v[28:31]
    ds_read_b128 v[104:107], v7 offset:896
    v_mfma_f32_16x16x32_bf16 v[32:35], v[116:119], v[160:163], v[32:35]
    ds_read_b128 v[108:111], v7 offset:384
    v_mfma_f32_16x16x32_bf16 v[36:39], v[116:119], v[164:167], v[36:39]
    ds_read_b64 v[52:53], v6 offset:896
    v_mfma_f32_16x16x32_bf16 v[40:43], v[116:119], v[168:171], v[40:43]
    ds_read_b64 v[54:55], v6 offset:904
    v_mfma_f32_16x16x32_bf16 v[28:31], v[120:123], v[152:155], v[28:31]
    ds_read_b128 v[92:95], v7 offset:2432
    v_mfma_f32_16x16x32_bf16 v[32:35], v[120:123], v[156:159], v[32:35]
    ds_read_b64 v[56:57], v6 offset:1408
    v_mfma_f32_16x16x32_bf16 v[36:39], v[120:123], v[160:163], v[36:39]
    ds_read_b64 v[58:59], v6 offset:1416
    v_mfma_f32_16x16x32_bf16 v[40:43], v[120:123], v[164:167], v[40:43]
    ds_read_b128 v[88:91], v7 offset:2944
    s_waitcnt lgkmcnt(14)
    v_mfma_f32_16x16x32_bf16 v[28:31], v[124:127], v[148:151], v[28:31]
    ds_read_b64 v[60:61], v6 offset:1920
    v_mfma_f32_16x16x32_bf16 v[32:35], v[124:127], v[152:155], v[32:35]
    ds_read_b64 v[62:63], v6 offset:1928
    v_mfma_f32_16x16x32_bf16 v[36:39], v[124:127], v[156:159], v[36:39]
    ds_read_b128 v[84:87], v7 offset:3456
    v_mfma_f32_16x16x32_bf16 v[40:43], v[124:127], v[160:163], v[40:43]
    ds_read_b64 v[64:65], v6 offset:2432
    v_mfma_f32_16x16x32_bf16 v[28:31], v[128:131], v[144:147], v[28:31]
    ds_read_b64 v[66:67], v6 offset:2440
    v_mfma_f32_16x16x32_bf16 v[32:35], v[128:131], v[148:151], v[32:35]
    ds_read_b128 v[80:83], v7 offset:3968
    v_mfma_f32_16x16x32_bf16 v[36:39], v[128:131], v[152:155], v[36:39]
    ds_read_b64 v[68:69], v6 offset:2944
    v_mfma_f32_16x16x32_bf16 v[40:43], v[128:131], v[156:159], v[40:43]
    ds_read_b64 v[70:71], v6 offset:2952
    v_mfma_f32_16x16x32_bf16 v[32:35], v[132:135], v[144:147], v[32:35]
    ds_read_b64 v[72:73], v6 offset:3456
    v_mfma_f32_16x16x32_bf16 v[36:39], v[132:135], v[148:151], v[36:39]
    ds_read_b64 v[74:75], v6 offset:3464
    v_mfma_f32_16x16x32_bf16 v[40:43], v[132:135], v[152:155], v[40:43]
    ds_read_b64 v[76:77], v6 offset:3968
    v_mfma_f32_16x16x32_bf16 v[36:39], v[136:139], v[144:147], v[36:39]
    ds_read_b64 v[78:79], v6 offset:3976
    v_mfma_f32_16x16x32_bf16 v[40:43], v[136:139], v[148:151], v[40:43]
    s_waitcnt lgkmcnt(14)
    v_mfma_f32_16x16x32_bf16 v[40:43], v[140:143], v[144:147], v[40:43]
    v_mfma_f32_16x16x32_bf16 v[28:31], v[48:51], v[96:99], v[28:31]
    ds_read_b64 v[112:113], v6 offset:448
    v_mfma_f32_16x16x32_bf16 v[32:35], v[48:51], v[100:103], v[32:35]
    ds_read_b64 v[114:115], v6 offset:456
    v_mfma_f32_16x16x32_bf16 v[36:39], v[48:51], v[104:107], v[36:39]
    ds_read_b128 v[160:163], v7 offset:1984
    v_mfma_f32_16x16x32_bf16 v[40:43], v[48:51], v[108:111], v[40:43]
    ds_read_b128 v[164:167], v7 offset:1472
    v_mfma_f32_16x16x32_bf16 v[28:31], v[52:55], v[92:95], v[28:31]
    ds_read_b128 v[168:171], v7 offset:960
    v_mfma_f32_16x16x32_bf16 v[32:35], v[52:55], v[96:99], v[32:35]
    ds_read_b128 v[172:175], v7 offset:448
    v_mfma_f32_16x16x32_bf16 v[36:39], v[52:55], v[100:103], v[36:39]
    ds_read_b64 v[116:117], v6 offset:960
    v_mfma_f32_16x16x32_bf16 v[40:43], v[52:55], v[104:107], v[40:43]
    ds_read_b64 v[118:119], v6 offset:968
    s_waitcnt lgkmcnt(14)
    v_mfma_f32_16x16x32_bf16 v[28:31], v[56:59], v[88:91], v[28:31]
    ds_read_b128 v[156:159], v7 offset:2496
    v_mfma_f32_16x16x32_bf16 v[32:35], v[56:59], v[92:95], v[32:35]
    ds_read_b64 v[120:121], v6 offset:1472
    v_mfma_f32_16x16x32_bf16 v[36:39], v[56:59], v[96:99], v[36:39]
    ds_read_b64 v[122:123], v6 offset:1480
    v_mfma_f32_16x16x32_bf16 v[40:43], v[56:59], v[100:103], v[40:43]
    ds_read_b128 v[152:155], v7 offset:3008
    v_mfma_f32_16x16x32_bf16 v[28:31], v[60:63], v[84:87], v[28:31]
    ds_read_b64 v[124:125], v6 offset:1984
    v_mfma_f32_16x16x32_bf16 v[32:35], v[60:63], v[88:91], v[32:35]
    ds_read_b64 v[126:127], v6 offset:1992
    v_mfma_f32_16x16x32_bf16 v[36:39], v[60:63], v[92:95], v[36:39]
    ds_read_b128 v[148:151], v7 offset:3520
    v_mfma_f32_16x16x32_bf16 v[40:43], v[60:63], v[96:99], v[40:43]
    ds_read_b64 v[128:129], v6 offset:2496
    v_mfma_f32_16x16x32_bf16 v[28:31], v[64:67], v[80:83], v[28:31]
    ds_read_b64 v[130:131], v6 offset:2504
    v_mfma_f32_16x16x32_bf16 v[32:35], v[64:67], v[84:87], v[32:35]
    ds_read_b128 v[144:147], v7 offset:4032
    v_mfma_f32_16x16x32_bf16 v[36:39], v[64:67], v[88:91], v[36:39]
    ds_read_b64 v[132:133], v6 offset:3008
    v_mfma_f32_16x16x32_bf16 v[40:43], v[64:67], v[92:95], v[40:43]
    ds_read_b64 v[134:135], v6 offset:3016
    s_waitcnt lgkmcnt(14)
    v_mfma_f32_16x16x32_bf16 v[32:35], v[68:71], v[80:83], v[32:35]
    ds_read_b64 v[136:137], v6 offset:3520
    v_mfma_f32_16x16x32_bf16 v[36:39], v[68:71], v[84:87], v[36:39]
    ds_read_b64 v[138:139], v6 offset:3528
    v_mfma_f32_16x16x32_bf16 v[40:43], v[68:71], v[88:91], v[40:43]
    ds_read_b64 v[140:141], v6 offset:4032
    v_mfma_f32_16x16x32_bf16 v[36:39], v[72:75], v[80:83], v[36:39]
    ds_read_b64 v[142:143], v6 offset:4040
    v_mfma_f32_16x16x32_bf16 v[40:43], v[72:75], v[84:87], v[40:43]
    v_mfma_f32_16x16x32_bf16 v[40:43], v[76:79], v[80:83], v[40:43]
    s_waitcnt vmcnt(0)
    v_subrev_u32 v6, 73728, v6
    v_mfma_f32_16x16x32_bf16 v[28:31], v[112:115], v[160:163], v[28:31]
    ds_write_b64 v9, v[204:205] offset:3608
    v_mfma_f32_16x16x32_bf16 v[32:35], v[112:115], v[164:167], v[32:35]
    v_mfma_f32_16x16x32_bf16 v[36:39], v[112:115], v[168:171], v[36:39]
    ds_write_b64 v9, v[206:207] offset:3096
    v_mfma_f32_16x16x32_bf16 v[40:43], v[112:115], v[172:175], v[40:43]
    s_waitcnt lgkmcnt(14)
    v_mfma_f32_16x16x32_bf16 v[28:31], v[116:119], v[156:159], v[28:31]
    ds_write_b128 v10, v[208:211] offset:2576
    v_mfma_f32_16x16x32_bf16 v[32:35], v[116:119], v[160:163], v[32:35]
    v_mfma_f32_16x16x32_bf16 v[36:39], v[116:119], v[164:167], v[36:39]
    ds_write_b128 v11, v[212:215] offset:1536
    v_mfma_f32_16x16x32_bf16 v[40:43], v[116:119], v[168:171], v[40:43]
    v_mfma_f32_16x16x32_bf16 v[28:31], v[120:123], v[152:155], v[28:31]
    ds_write_b128 v11, v[216:219] offset:1552
    v_mfma_f32_16x16x32_bf16 v[32:35], v[120:123], v[156:159], v[32:35]
    v_mfma_f32_16x16x32_bf16 v[36:39], v[120:123], v[160:163], v[36:39]
    ds_read_b64 v[48:49], v6 offset:0
    v_mfma_f32_16x16x32_bf16 v[40:43], v[120:123], v[164:167], v[40:43]
    ds_read_b64 v[50:51], v6 offset:8
    s_waitcnt lgkmcnt(14)
    v_mfma_f32_16x16x32_bf16 v[28:31], v[124:127], v[148:151], v[28:31]
    ds_read_b128 v[80:83], v7 offset:3584
    v_mfma_f32_16x16x32_bf16 v[32:35], v[124:127], v[152:155], v[32:35]
    ds_read_b128 v[84:87], v7 offset:3072
    v_mfma_f32_16x16x32_bf16 v[36:39], v[124:127], v[156:159], v[36:39]
    ds_read_b128 v[88:91], v7 offset:2560
    v_mfma_f32_16x16x32_bf16 v[40:43], v[124:127], v[160:163], v[40:43]
    ds_read_b128 v[92:95], v7 offset:2048
    s_waitcnt lgkmcnt(14)
    v_mfma_f32_16x16x32_bf16 v[28:31], v[128:131], v[144:147], v[28:31]
    ds_read_b64 v[52:53], v6 offset:512
    v_mfma_f32_16x16x32_bf16 v[32:35], v[128:131], v[148:151], v[32:35]
    ds_read_b64 v[54:55], v6 offset:520
    v_mfma_f32_16x16x32_bf16 v[36:39], v[128:131], v[152:155], v[36:39]
    ds_read_b64 v[56:57], v6 offset:1024
    ds_write_addtid_b32 v176 offset:4160
    v_mfma_f32_16x16x32_bf16 v[40:43], v[128:131], v[156:159], v[40:43]
    ds_read_b64 v[58:59], v6 offset:1032
    ds_write_addtid_b32 v177 offset:4416
    v_mfma_f32_16x16x32_bf16 v[32:35], v[132:135], v[144:147], v[32:35]
    ds_read_b64 v[60:61], v6 offset:1536
    ds_write_addtid_b32 v178 offset:4672
    v_mfma_f32_16x16x32_bf16 v[36:39], v[132:135], v[148:151], v[36:39]
    ds_read_b64 v[62:63], v6 offset:1544
    ds_write_addtid_b32 v179 offset:4928
    v_mfma_f32_16x16x32_bf16 v[40:43], v[132:135], v[152:155], v[40:43]
    ds_write_addtid_b32 v180 offset:5184
    s_waitcnt lgkmcnt(14)
    v_mfma_f32_16x16x32_bf16 v[36:39], v[136:139], v[144:147], v[36:39]
    ds_write_addtid_b32 v181 offset:5440
    v_mfma_f32_16x16x32_bf16 v[40:43], v[136:139], v[148:151], v[40:43]
    ds_write_addtid_b32 v182 offset:5696
    v_mfma_f32_16x16x32_bf16 v[40:43], v[140:143], v[144:147], v[40:43]
    ds_write_addtid_b32 v183 offset:5952
    v_mfma_f32_16x16x32_bf16 v[12:15], v[48:51], v[80:83], 0
    ds_read_b64 v[112:113], v6 offset:64
    s_waitcnt lgkmcnt(14)
    v_mfma_f32_16x16x32_bf16 v[16:19], v[48:51], v[84:87], 0
    ds_read_b64 v[114:115], v6 offset:72
    v_mfma_f32_16x16x32_bf16 v[20:23], v[48:51], v[88:91], 0
    ds_read_b128 v[144:147], v7 offset:3648
    v_cvt_pk_bf16_f32 v184, v28, v29
    v_mfma_f32_16x16x32_bf16 v[24:27], v[48:51], v[92:95], 0
    ds_read_b128 v[148:151], v7 offset:3136
    v_cvt_pk_bf16_f32 v185, v30, v31
    s_waitcnt lgkmcnt(14)
    v_mfma_f32_16x16x32_bf16 v[16:19], v[52:55], v[80:83], v[16:19]
    ds_read_b128 v[152:155], v7 offset:2624
    ds_read_b128 v[156:159], v7 offset:2112
    v_cvt_pk_bf16_f32 v186, v32, v33
    v_mfma_f32_16x16x32_bf16 v[20:23], v[52:55], v[84:87], v[20:23]
    ds_read_b64 v[116:117], v6 offset:576
    v_cvt_pk_bf16_f32 v187, v34, v35
    v_mfma_f32_16x16x32_bf16 v[24:27], v[52:55], v[88:91], v[24:27]
    ds_read_b64 v[118:119], v6 offset:584
    v_cvt_pk_bf16_f32 v188, v36, v37
    s_waitcnt lgkmcnt(14)
    v_mfma_f32_16x16x32_bf16 v[20:23], v[56:59], v[80:83], v[20:23]
    ds_read_b64 v[120:121], v6 offset:1088
    v_cvt_pk_bf16_f32 v189, v38, v39
    v_mfma_f32_16x16x32_bf16 v[24:27], v[56:59], v[84:87], v[24:27]
    ds_read_b64 v[122:123], v6 offset:1096
    v_cvt_pk_bf16_f32 v190, v40, v41
    s_waitcnt lgkmcnt(14)
    v_mfma_f32_16x16x32_bf16 v[24:27], v[60:63], v[80:83], v[24:27]
    ds_read_b64 v[124:125], v6 offset:1600
    ds_read_b64 v[126:127], v6 offset:1608
    v_cvt_pk_bf16_f32 v191, v42, v43
    s_waitcnt lgkmcnt(10)
    s_waitcnt lgkmcnt(9)
    v_mfma_f32_16x16x32_bf16 v[12:15], v[112:115], v[144:147], v[12:15]
    ds_read_b64 v[48:49], v6 offset:128
    ds_write_addtid_b32 v184 offset:6208
    s_waitcnt lgkmcnt(10)
    v_mfma_f32_16x16x32_bf16 v[16:19], v[112:115], v[148:151], v[16:19]
    ds_read_b64 v[50:51], v6 offset:136
    ds_write_addtid_b32 v185 offset:6464
    s_waitcnt lgkmcnt(11)
    v_mfma_f32_16x16x32_bf16 v[20:23], v[112:115], v[152:155], v[20:23]
    ds_read_b128 v[80:83], v7 offset:3712
    ds_write_addtid_b32 v186 offset:6720
    s_waitcnt lgkmcnt(12)
    v_mfma_f32_16x16x32_bf16 v[24:27], v[112:115], v[156:159], v[24:27]
    ds_read_b128 v[84:87], v7 offset:3200
    ds_write_addtid_b32 v187 offset:6976
    s_waitcnt lgkmcnt(12)
    v_mfma_f32_16x16x32_bf16 v[16:19], v[116:119], v[144:147], v[16:19]
    ds_read_b128 v[88:91], v7 offset:2688
    ds_read_b128 v[92:95], v7 offset:2176
    ds_write_addtid_b32 v188 offset:7232
    v_mfma_f32_16x16x32_bf16 v[20:23], v[116:119], v[148:151], v[20:23]
    ds_read_b64 v[52:53], v6 offset:640
    ds_write_addtid_b32 v189 offset:7488
    v_mfma_f32_16x16x32_bf16 v[24:27], v[116:119], v[152:155], v[24:27]
    ds_read_b64 v[54:55], v6 offset:648
    ds_write_addtid_b32 v190 offset:7744
    s_waitcnt lgkmcnt(14)
    v_mfma_f32_16x16x32_bf16 v[20:23], v[120:123], v[144:147], v[20:23]
    ds_read_b64 v[56:57], v6 offset:1152
    ds_write_addtid_b32 v191 offset:8000
    v_mfma_f32_16x16x32_bf16 v[24:27], v[120:123], v[148:151], v[24:27]
    ds_read_b64 v[58:59], v6 offset:1160
    v_mfma_f32_16x16x32_bf16 v[24:27], v[124:127], v[144:147], v[24:27]
    ds_read_b64 v[60:61], v6 offset:1664
    ds_read_b64 v[62:63], v6 offset:1672
    s_waitcnt lgkmcnt(14)
    v_mfma_f32_16x16x32_bf16 v[12:15], v[48:51], v[80:83], v[12:15]
    ds_read_b64 v[112:113], v6 offset:192
    s_waitcnt lgkmcnt(14)
    v_mfma_f32_16x16x32_bf16 v[16:19], v[48:51], v[84:87], v[16:19]
    ds_read_b64 v[114:115], v6 offset:200
    s_waitcnt lgkmcnt(13)
    v_mfma_f32_16x16x32_bf16 v[20:23], v[48:51], v[88:91], v[20:23]
    ds_read_b128 v[144:147], v7 offset:3776
    s_waitcnt lgkmcnt(13)
    v_mfma_f32_16x16x32_bf16 v[24:27], v[48:51], v[92:95], v[24:27]
    ds_read_b128 v[148:151], v7 offset:3264
    s_waitcnt lgkmcnt(10)
    v_mfma_f32_16x16x32_bf16 v[16:19], v[52:55], v[80:83], v[16:19]
    ds_read_b128 v[152:155], v7 offset:2752
    ds_read_b128 v[156:159], v7 offset:2240
    v_mfma_f32_16x16x32_bf16 v[20:23], v[52:55], v[84:87], v[20:23]
    ds_read_b64 v[116:117], v6 offset:704
    v_mfma_f32_16x16x32_bf16 v[24:27], v[52:55], v[88:91], v[24:27]
    ds_read_b64 v[118:119], v6 offset:712
    s_waitcnt lgkmcnt(10)
    v_mfma_f32_16x16x32_bf16 v[20:23], v[56:59], v[80:83], v[20:23]
    ds_read_b64 v[120:121], v6 offset:1216
    v_mfma_f32_16x16x32_bf16 v[24:27], v[56:59], v[84:87], v[24:27]
    ds_read_b64 v[122:123], v6 offset:1224
    s_waitcnt lgkmcnt(10)
    v_mfma_f32_16x16x32_bf16 v[24:27], v[60:63], v[80:83], v[24:27]
    ds_read_b64 v[124:125], v6 offset:1728
    ds_read_b64 v[126:127], v6 offset:1736
    s_barrier
    s_waitcnt lgkmcnt(10)
    s_waitcnt lgkmcnt(9)
    v_mfma_f32_16x16x32_bf16 v[12:15], v[112:115], v[144:147], v[12:15]
    ds_read_b64 v[48:49], v6 offset:256
    s_waitcnt lgkmcnt(9)
    v_mfma_f32_16x16x32_bf16 v[16:19], v[112:115], v[148:151], v[16:19]
    ds_read_b64 v[50:51], v6 offset:264
    s_waitcnt lgkmcnt(9)
    v_mfma_f32_16x16x32_bf16 v[20:23], v[112:115], v[152:155], v[20:23]
    ds_read_b128 v[80:83], v7 offset:3840
    s_waitcnt lgkmcnt(9)
    v_mfma_f32_16x16x32_bf16 v[24:27], v[112:115], v[156:159], v[24:27]
    ds_read_b128 v[84:87], v7 offset:3328
    ds_read_b128 v[88:91], v7 offset:2816
    s_waitcnt lgkmcnt(9)
    v_mfma_f32_16x16x32_bf16 v[16:19], v[116:119], v[144:147], v[16:19]
    ds_read_b128 v[92:95], v7 offset:2304
    v_mfma_f32_16x16x32_bf16 v[20:23], v[116:119], v[148:151], v[20:23]
    ds_read_b64 v[52:53], v6 offset:768
    v_mfma_f32_16x16x32_bf16 v[24:27], v[116:119], v[152:155], v[24:27]
    ds_read_b64 v[54:55], v6 offset:776
    ds_read_b64 v[56:57], v6 offset:1280
    s_waitcnt lgkmcnt(11)
    v_mfma_f32_16x16x32_bf16 v[20:23], v[120:123], v[144:147], v[20:23]
    ds_read_b64 v[58:59], v6 offset:1288
    v_mfma_f32_16x16x32_bf16 v[24:27], v[120:123], v[148:151], v[24:27]
    ds_read_b64 v[60:61], v6 offset:1792
    s_waitcnt lgkmcnt(11)
    v_mfma_f32_16x16x32_bf16 v[24:27], v[124:127], v[144:147], v[24:27]
    ds_read_b64 v[62:63], v6 offset:1800
    ds_read_b128 v[96:99], v7 offset:1536
    s_waitcnt lgkmcnt(11)
    s_waitcnt lgkmcnt(10)
    v_mfma_f32_16x16x32_bf16 v[12:15], v[48:51], v[80:83], v[12:15]
    ds_read_b64 v[112:113], v6 offset:320
    s_waitcnt lgkmcnt(10)
    v_mfma_f32_16x16x32_bf16 v[16:19], v[48:51], v[84:87], v[16:19]
    ds_read_b64 v[114:115], v6 offset:328
    s_waitcnt lgkmcnt(10)
    v_mfma_f32_16x16x32_bf16 v[20:23], v[48:51], v[88:91], v[20:23]
    ds_read_b128 v[144:147], v7 offset:3904
    s_waitcnt lgkmcnt(10)
    v_mfma_f32_16x16x32_bf16 v[24:27], v[48:51], v[92:95], v[24:27]
    ds_read_b128 v[148:151], v7 offset:3392
    ds_read_b128 v[152:155], v7 offset:2880
    s_waitcnt lgkmcnt(10)
    v_mfma_f32_16x16x32_bf16 v[16:19], v[52:55], v[80:83], v[16:19]
    ds_read_b128 v[156:159], v7 offset:2368
    v_mfma_f32_16x16x32_bf16 v[20:23], v[52:55], v[84:87], v[20:23]
    ds_read_b64 v[116:117], v6 offset:832
    v_mfma_f32_16x16x32_bf16 v[24:27], v[52:55], v[88:91], v[24:27]
    ds_read_b64 v[118:119], v6 offset:840
    ds_read_b64 v[120:121], v6 offset:1344
    s_waitcnt lgkmcnt(12)
    v_mfma_f32_16x16x32_bf16 v[20:23], v[56:59], v[80:83], v[20:23]
    ds_read_b64 v[122:123], v6 offset:1352
    v_mfma_f32_16x16x32_bf16 v[24:27], v[56:59], v[84:87], v[24:27]
    ds_read_b64 v[124:125], v6 offset:1856
    s_waitcnt lgkmcnt(12)
    v_mfma_f32_16x16x32_bf16 v[24:27], v[60:63], v[80:83], v[24:27]
    ds_read_b64 v[126:127], v6 offset:1864
    ds_read_b128 v[100:103], v7 offset:1024
    s_waitcnt lgkmcnt(11)
    s_waitcnt lgkmcnt(10)
    v_mfma_f32_16x16x32_bf16 v[12:15], v[112:115], v[144:147], v[12:15]
    ds_read_b64 v[48:49], v6 offset:384
    s_waitcnt lgkmcnt(10)
    v_mfma_f32_16x16x32_bf16 v[16:19], v[112:115], v[148:151], v[16:19]
    ds_read_b64 v[50:51], v6 offset:392
    s_waitcnt lgkmcnt(10)
    v_mfma_f32_16x16x32_bf16 v[20:23], v[112:115], v[152:155], v[20:23]
    ds_read_b128 v[80:83], v7 offset:3968
    s_waitcnt lgkmcnt(10)
    v_mfma_f32_16x16x32_bf16 v[24:27], v[112:115], v[156:159], v[24:27]
    ds_read_b128 v[84:87], v7 offset:3456
    ds_read_b128 v[88:91], v7 offset:2944
    s_waitcnt lgkmcnt(10)
    v_mfma_f32_16x16x32_bf16 v[16:19], v[116:119], v[144:147], v[16:19]
    ds_read_b128 v[92:95], v7 offset:2432
    v_mfma_f32_16x16x32_bf16 v[20:23], v[116:119], v[148:151], v[20:23]
    ds_read_b64 v[52:53], v6 offset:896
    v_mfma_f32_16x16x32_bf16 v[24:27], v[116:119], v[152:155], v[24:27]
    ds_read_b64 v[54:55], v6 offset:904
    ds_read_b64 v[56:57], v6 offset:1408
    s_waitcnt lgkmcnt(12)
    v_mfma_f32_16x16x32_bf16 v[20:23], v[120:123], v[144:147], v[20:23]
    ds_read_b64 v[58:59], v6 offset:1416
    v_mfma_f32_16x16x32_bf16 v[24:27], v[120:123], v[148:151], v[24:27]
    ds_read_b64 v[60:61], v6 offset:1920
    s_waitcnt lgkmcnt(12)
    v_mfma_f32_16x16x32_bf16 v[24:27], v[124:127], v[144:147], v[24:27]
    ds_read_b64 v[62:63], v6 offset:1928
    ds_read_b128 v[104:107], v7 offset:512
    s_waitcnt lgkmcnt(11)
    s_waitcnt lgkmcnt(10)
    v_mfma_f32_16x16x32_bf16 v[12:15], v[48:51], v[80:83], v[12:15]
    ds_read_b64 v[112:113], v6 offset:448
    s_waitcnt lgkmcnt(10)
    v_mfma_f32_16x16x32_bf16 v[16:19], v[48:51], v[84:87], v[16:19]
    ds_read_b64 v[114:115], v6 offset:456
    s_waitcnt lgkmcnt(10)
    v_mfma_f32_16x16x32_bf16 v[20:23], v[48:51], v[88:91], v[20:23]
    ds_read_b128 v[144:147], v7 offset:4032
    s_waitcnt lgkmcnt(10)
    v_mfma_f32_16x16x32_bf16 v[24:27], v[48:51], v[92:95], v[24:27]
    ds_read_b128 v[148:151], v7 offset:3520
    ds_read_b128 v[152:155], v7 offset:3008
    s_waitcnt lgkmcnt(10)
    v_mfma_f32_16x16x32_bf16 v[16:19], v[52:55], v[80:83], v[16:19]
    ds_read_b128 v[156:159], v7 offset:2496
    v_mfma_f32_16x16x32_bf16 v[20:23], v[52:55], v[84:87], v[20:23]
    ds_read_b64 v[116:117], v6 offset:960
    v_mfma_f32_16x16x32_bf16 v[24:27], v[52:55], v[88:91], v[24:27]
    ds_read_b64 v[118:119], v6 offset:968
    ds_read_b64 v[120:121], v6 offset:1472
    s_waitcnt lgkmcnt(12)
    v_mfma_f32_16x16x32_bf16 v[20:23], v[56:59], v[80:83], v[20:23]
    ds_read_b64 v[122:123], v6 offset:1480
    v_mfma_f32_16x16x32_bf16 v[24:27], v[56:59], v[84:87], v[24:27]
    ds_read_b64 v[124:125], v6 offset:1984
    s_waitcnt lgkmcnt(12)
    v_mfma_f32_16x16x32_bf16 v[24:27], v[60:63], v[80:83], v[24:27]
    ds_read_b64 v[126:127], v6 offset:1992
    ds_read_b128 v[108:111], v7 offset:0
    s_waitcnt lgkmcnt(11)
    s_waitcnt lgkmcnt(10)
    v_mfma_f32_16x16x32_bf16 v[12:15], v[112:115], v[144:147], v[12:15]
    ds_read_b64 v[48:49], v6 offset:0
    s_waitcnt lgkmcnt(10)
    v_mfma_f32_16x16x32_bf16 v[16:19], v[112:115], v[148:151], v[16:19]
    ds_read_b64 v[50:51], v6 offset:8
    s_waitcnt lgkmcnt(10)
    v_mfma_f32_16x16x32_bf16 v[20:23], v[112:115], v[152:155], v[20:23]
    ds_read_b64 v[52:53], v6 offset:512
    s_waitcnt lgkmcnt(10)
    v_mfma_f32_16x16x32_bf16 v[24:27], v[112:115], v[156:159], v[24:27]
    ds_read_b64 v[54:55], v6 offset:520
    s_waitcnt lgkmcnt(9)
    v_mfma_f32_16x16x32_bf16 v[16:19], v[116:119], v[144:147], v[16:19]
    ds_read_b128 v[92:95], v7 offset:2048
    ds_read_b64 v[56:57], v6 offset:1024
    v_mfma_f32_16x16x32_bf16 v[20:23], v[116:119], v[148:151], v[20:23]
    ds_read_b64 v[58:59], v6 offset:1032
    v_mfma_f32_16x16x32_bf16 v[24:27], v[116:119], v[152:155], v[24:27]
    ds_read_b128 v[88:91], v7 offset:2560
    s_waitcnt lgkmcnt(11)
    v_mfma_f32_16x16x32_bf16 v[20:23], v[120:123], v[144:147], v[20:23]
    ds_read_b64 v[60:61], v6 offset:1536
    v_mfma_f32_16x16x32_bf16 v[24:27], v[120:123], v[148:151], v[24:27]
    ds_read_b64 v[62:63], v6 offset:1544
    s_waitcnt lgkmcnt(11)
    v_mfma_f32_16x16x32_bf16 v[24:27], v[124:127], v[144:147], v[24:27]
    ds_read_b128 v[84:87], v7 offset:3072
    ds_read_b128 v[80:83], v7 offset:3584
    s_waitcnt lgkmcnt(10)
    v_mfma_f32_16x16x32_bf16 v[28:31], v[48:51], v[96:99], 0
    ds_read_b64 v[64:65], v6 offset:2048
    v_mfma_f32_16x16x32_bf16 v[32:35], v[48:51], v[100:103], 0
    ds_read_b64 v[66:67], v6 offset:2056
    v_mfma_f32_16x16x32_bf16 v[36:39], v[48:51], v[104:107], 0
    ds_read_b64 v[68:69], v6 offset:2560
    v_mfma_f32_16x16x32_bf16 v[40:43], v[48:51], v[108:111], 0
    ds_read_b64 v[70:71], v6 offset:2568
    s_waitcnt lgkmcnt(12)
    s_waitcnt lgkmcnt(11)
    v_mfma_f32_16x16x32_bf16 v[28:31], v[52:55], v[92:95], v[28:31]
    ds_read_b64 v[72:73], v6 offset:3072
    ds_read_b64 v[74:75], v6 offset:3080
    v_cvt_pk_bf16_f32 v176, v12, v13
    v_mfma_f32_16x16x32_bf16 v[32:35], v[52:55], v[96:99], v[32:35]
    ds_read_b64 v[76:77], v6 offset:3584
    v_cvt_pk_bf16_f32 v177, v14, v15
    v_mfma_f32_16x16x32_bf16 v[36:39], v[52:55], v[100:103], v[36:39]
    ds_read_b64 v[78:79], v6 offset:3592
    v_cvt_pk_bf16_f32 v178, v16, v17
    v_mfma_f32_16x16x32_bf16 v[40:43], v[52:55], v[104:107], v[40:43]
    ds_read_b64 v[112:113], v6 offset:64
    v_cvt_pk_bf16_f32 v179, v18, v19
    s_waitcnt lgkmcnt(14)
    s_waitcnt lgkmcnt(13)
    v_mfma_f32_16x16x32_bf16 v[28:31], v[56:59], v[88:91], v[28:31]
    ds_read_b64 v[114:115], v6 offset:72
    ds_read_b128 v[160:163], v7 offset:1600
    v_cvt_pk_bf16_f32 v180, v20, v21
    v_mfma_f32_16x16x32_bf16 v[32:35], v[56:59], v[92:95], v[32:35]
    ds_read_b128 v[164:167], v7 offset:1088
    v_cvt_pk_bf16_f32 v181, v22, v23
    v_mfma_f32_16x16x32_bf16 v[36:39], v[56:59], v[96:99], v[36:39]
    ds_read_b128 v[168:171], v7 offset:576
    v_cvt_pk_bf16_f32 v182, v24, v25
    v_mfma_f32_16x16x32_bf16 v[40:43], v[56:59], v[100:103], v[40:43]
    ds_read_b128 v[172:175], v7 offset:64
    v_cvt_pk_bf16_f32 v183, v26, v27
    s_waitcnt lgkmcnt(14)
    v_mfma_f32_16x16x32_bf16 v[28:31], v[60:63], v[84:87], v[28:31]
    ds_read_b64 v[116:117], v6 offset:576
    ds_read_b64 v[118:119], v6 offset:584
    v_mfma_f32_16x16x32_bf16 v[32:35], v[60:63], v[88:91], v[32:35]
    ds_read_b128 v[156:159], v7 offset:2112
    v_mfma_f32_16x16x32_bf16 v[36:39], v[60:63], v[92:95], v[36:39]
    ds_read_b64 v[120:121], v6 offset:1088
    v_mfma_f32_16x16x32_bf16 v[40:43], v[60:63], v[96:99], v[40:43]
    ds_read_b64 v[122:123], v6 offset:1096
    s_waitcnt lgkmcnt(14)
    v_mfma_f32_16x16x32_bf16 v[28:31], v[64:67], v[80:83], v[28:31]
    ds_read_b128 v[152:155], v7 offset:2624
    v_mfma_f32_16x16x32_bf16 v[32:35], v[64:67], v[84:87], v[32:35]
    ds_read_b64 v[124:125], v6 offset:1600
    ds_read_b64 v[126:127], v6 offset:1608
    v_mfma_f32_16x16x32_bf16 v[36:39], v[64:67], v[88:91], v[36:39]
    ds_read_b128 v[148:151], v7 offset:3136
    v_mfma_f32_16x16x32_bf16 v[40:43], v[64:67], v[92:95], v[40:43]
    ds_read_b64 v[128:129], v6 offset:2112
    v_mfma_f32_16x16x32_bf16 v[32:35], v[68:71], v[80:83], v[32:35]
    ds_read_b64 v[130:131], v6 offset:2120
    v_mfma_f32_16x16x32_bf16 v[36:39], v[68:71], v[84:87], v[36:39]
    ds_read_b128 v[144:147], v7 offset:3648
    ds_read_b64 v[132:133], v6 offset:2624
    v_mfma_f32_16x16x32_bf16 v[40:43], v[68:71], v[88:91], v[40:43]
    ds_read_b64 v[134:135], v6 offset:2632
    s_waitcnt lgkmcnt(14)
    v_mfma_f32_16x16x32_bf16 v[36:39], v[72:75], v[80:83], v[36:39]
    ds_read_b64 v[136:137], v6 offset:3136
    v_mfma_f32_16x16x32_bf16 v[40:43], v[72:75], v[84:87], v[40:43]
    ds_read_b64 v[138:139], v6 offset:3144
    v_mfma_f32_16x16x32_bf16 v[40:43], v[76:79], v[80:83], v[40:43]
    ds_read_b64 v[140:141], v6 offset:3648
    ds_read_b64 v[142:143], v6 offset:3656
    v_mfma_f32_16x16x32_bf16 v[28:31], v[112:115], v[160:163], v[28:31]
    ds_read_b64 v[48:49], v6 offset:128
    ds_write_addtid_b32 v176 offset:8320
    v_mfma_f32_16x16x32_bf16 v[32:35], v[112:115], v[164:167], v[32:35]
    ds_read_b64 v[50:51], v6 offset:136
    ds_write_addtid_b32 v177 offset:8576
    v_mfma_f32_16x16x32_bf16 v[36:39], v[112:115], v[168:171], v[36:39]
    ds_read_b128 v[96:99], v7 offset:1664
    ds_write_addtid_b32 v178 offset:8832
    v_mfma_f32_16x16x32_bf16 v[40:43], v[112:115], v[172:175], v[40:43]
    ds_read_b128 v[100:103], v7 offset:1152
    ds_write_addtid_b32 v179 offset:9088
    s_waitcnt lgkmcnt(14)
    v_mfma_f32_16x16x32_bf16 v[28:31], v[116:119], v[156:159], v[28:31]
    ds_read_b128 v[104:107], v7 offset:640
    ds_write_addtid_b32 v180 offset:9344
    v_mfma_f32_16x16x32_bf16 v[32:35], v[116:119], v[160:163], v[32:35]
    ds_read_b128 v[108:111], v7 offset:128
    ds_write_addtid_b32 v181 offset:9600
    v_mfma_f32_16x16x32_bf16 v[36:39], v[116:119], v[164:167], v[36:39]
    ds_read_b64 v[52:53], v6 offset:640
    ds_write_addtid_b32 v182 offset:9856
    v_mfma_f32_16x16x32_bf16 v[40:43], v[116:119], v[168:171], v[40:43]
    ds_read_b64 v[54:55], v6 offset:648
    ds_write_addtid_b32 v183 offset:10112
    v_mfma_f32_16x16x32_bf16 v[28:31], v[120:123], v[152:155], v[28:31]
    ds_read_b128 v[92:95], v7 offset:2176
    v_mfma_f32_16x16x32_bf16 v[32:35], v[120:123], v[156:159], v[32:35]
    ds_read_b64 v[56:57], v6 offset:1152
    v_mfma_f32_16x16x32_bf16 v[36:39], v[120:123], v[160:163], v[36:39]
    ds_read_b64 v[58:59], v6 offset:1160
    v_mfma_f32_16x16x32_bf16 v[40:43], v[120:123], v[164:167], v[40:43]
    ds_read_b128 v[88:91], v7 offset:2688
    v_mfma_f32_16x16x32_bf16 v[28:31], v[124:127], v[148:151], v[28:31]
    ds_read_b64 v[60:61], v6 offset:1664
    v_mfma_f32_16x16x32_bf16 v[32:35], v[124:127], v[152:155], v[32:35]
    ds_read_b64 v[62:63], v6 offset:1672
    v_mfma_f32_16x16x32_bf16 v[36:39], v[124:127], v[156:159], v[36:39]
    ds_read_b128 v[84:87], v7 offset:3200
    v_mfma_f32_16x16x32_bf16 v[40:43], v[124:127], v[160:163], v[40:43]
    ds_read_b64 v[64:65], v6 offset:2176
    v_mfma_f32_16x16x32_bf16 v[28:31], v[128:131], v[144:147], v[28:31]
    ds_read_b64 v[66:67], v6 offset:2184
    v_mfma_f32_16x16x32_bf16 v[32:35], v[128:131], v[148:151], v[32:35]
    ds_read_b128 v[80:83], v7 offset:3712
    v_mfma_f32_16x16x32_bf16 v[36:39], v[128:131], v[152:155], v[36:39]
    ds_read_b64 v[68:69], v6 offset:2688
    v_mfma_f32_16x16x32_bf16 v[40:43], v[128:131], v[156:159], v[40:43]
    ds_read_b64 v[70:71], v6 offset:2696
    s_waitcnt lgkmcnt(14)
    v_mfma_f32_16x16x32_bf16 v[32:35], v[132:135], v[144:147], v[32:35]
    ds_read_b64 v[72:73], v6 offset:3200
    v_mfma_f32_16x16x32_bf16 v[36:39], v[132:135], v[148:151], v[36:39]
    ds_read_b64 v[74:75], v6 offset:3208
    v_mfma_f32_16x16x32_bf16 v[40:43], v[132:135], v[152:155], v[40:43]
    ds_read_b64 v[76:77], v6 offset:3712
    v_mfma_f32_16x16x32_bf16 v[36:39], v[136:139], v[144:147], v[36:39]
    ds_read_b64 v[78:79], v6 offset:3720
    v_mfma_f32_16x16x32_bf16 v[40:43], v[136:139], v[148:151], v[40:43]
    v_mfma_f32_16x16x32_bf16 v[40:43], v[140:143], v[144:147], v[40:43]
    s_waitcnt lgkmcnt(14)
    s_barrier
    v_mfma_f32_16x16x32_bf16 v[28:31], v[48:51], v[96:99], v[28:31]
    ds_read_b64 v[112:113], v6 offset:192
    v_mfma_f32_16x16x32_bf16 v[32:35], v[48:51], v[100:103], v[32:35]
    ds_read_b64 v[114:115], v6 offset:200
    v_mfma_f32_16x16x32_bf16 v[36:39], v[48:51], v[104:107], v[36:39]
    ds_read_b128 v[160:163], v7 offset:1728
    v_mfma_f32_16x16x32_bf16 v[40:43], v[48:51], v[108:111], v[40:43]
    ds_read_b128 v[164:167], v7 offset:1216
    v_mfma_f32_16x16x32_bf16 v[28:31], v[52:55], v[92:95], v[28:31]
    ds_read_b128 v[168:171], v7 offset:704
    v_mfma_f32_16x16x32_bf16 v[32:35], v[52:55], v[96:99], v[32:35]
    ds_read_b128 v[172:175], v7 offset:192
    v_mfma_f32_16x16x32_bf16 v[36:39], v[52:55], v[100:103], v[36:39]
    ds_read_b64 v[116:117], v6 offset:704
    v_mfma_f32_16x16x32_bf16 v[40:43], v[52:55], v[104:107], v[40:43]
    ds_read_b64 v[118:119], v6 offset:712
    s_waitcnt lgkmcnt(14)
    v_mfma_f32_16x16x32_bf16 v[28:31], v[56:59], v[88:91], v[28:31]
    ds_read_b128 v[156:159], v7 offset:2240
    v_mfma_f32_16x16x32_bf16 v[32:35], v[56:59], v[92:95], v[32:35]
    ds_read_b64 v[120:121], v6 offset:1216
    v_mfma_f32_16x16x32_bf16 v[36:39], v[56:59], v[96:99], v[36:39]
    ds_read_b64 v[122:123], v6 offset:1224
    v_mfma_f32_16x16x32_bf16 v[40:43], v[56:59], v[100:103], v[40:43]
    ds_read_b128 v[152:155], v7 offset:2752
    v_mfma_f32_16x16x32_bf16 v[28:31], v[60:63], v[84:87], v[28:31]
    ds_read_b64 v[124:125], v6 offset:1728
    v_mfma_f32_16x16x32_bf16 v[32:35], v[60:63], v[88:91], v[32:35]
    ds_read_b64 v[126:127], v6 offset:1736
    v_mfma_f32_16x16x32_bf16 v[36:39], v[60:63], v[92:95], v[36:39]
    ds_read_b128 v[148:151], v7 offset:3264
    v_mfma_f32_16x16x32_bf16 v[40:43], v[60:63], v[96:99], v[40:43]
    ds_read_b64 v[128:129], v6 offset:2240
    v_mfma_f32_16x16x32_bf16 v[28:31], v[64:67], v[80:83], v[28:31]
    ds_read_b64 v[130:131], v6 offset:2248
    v_mfma_f32_16x16x32_bf16 v[32:35], v[64:67], v[84:87], v[32:35]
    ds_read_b128 v[144:147], v7 offset:3776
    v_mfma_f32_16x16x32_bf16 v[36:39], v[64:67], v[88:91], v[36:39]
    ds_read_b64 v[132:133], v6 offset:2752
    v_mfma_f32_16x16x32_bf16 v[40:43], v[64:67], v[92:95], v[40:43]
    ds_read_b64 v[134:135], v6 offset:2760
    s_waitcnt lgkmcnt(14)
    v_mfma_f32_16x16x32_bf16 v[32:35], v[68:71], v[80:83], v[32:35]
    ds_read_b64 v[136:137], v6 offset:3264
    v_mfma_f32_16x16x32_bf16 v[36:39], v[68:71], v[84:87], v[36:39]
    ds_read_b64 v[138:139], v6 offset:3272
    v_mfma_f32_16x16x32_bf16 v[40:43], v[68:71], v[88:91], v[40:43]
    ds_read_b64 v[140:141], v6 offset:3776
    v_mfma_f32_16x16x32_bf16 v[36:39], v[72:75], v[80:83], v[36:39]
    ds_read_b64 v[142:143], v6 offset:3784
    v_mfma_f32_16x16x32_bf16 v[40:43], v[72:75], v[84:87], v[40:43]
    v_mfma_f32_16x16x32_bf16 v[40:43], v[76:79], v[80:83], v[40:43]
    v_mfma_f32_16x16x32_bf16 v[28:31], v[112:115], v[160:163], v[28:31]
    ds_read_b64 v[48:49], v6 offset:256
    v_mfma_f32_16x16x32_bf16 v[32:35], v[112:115], v[164:167], v[32:35]
    ds_read_b64 v[50:51], v6 offset:264
    v_mfma_f32_16x16x32_bf16 v[36:39], v[112:115], v[168:171], v[36:39]
    ds_read_b128 v[96:99], v7 offset:1792
    v_mfma_f32_16x16x32_bf16 v[40:43], v[112:115], v[172:175], v[40:43]
    ds_read_b128 v[100:103], v7 offset:1280
    s_waitcnt lgkmcnt(14)
    v_mfma_f32_16x16x32_bf16 v[28:31], v[116:119], v[156:159], v[28:31]
    ds_read_b128 v[104:107], v7 offset:768
    v_mfma_f32_16x16x32_bf16 v[32:35], v[116:119], v[160:163], v[32:35]
    ds_read_b128 v[108:111], v7 offset:256
    v_mfma_f32_16x16x32_bf16 v[36:39], v[116:119], v[164:167], v[36:39]
    ds_read_b64 v[52:53], v6 offset:768
    v_mfma_f32_16x16x32_bf16 v[40:43], v[116:119], v[168:171], v[40:43]
    ds_read_b64 v[54:55], v6 offset:776
    v_mfma_f32_16x16x32_bf16 v[28:31], v[120:123], v[152:155], v[28:31]
    ds_read_b128 v[92:95], v7 offset:2304
    v_mfma_f32_16x16x32_bf16 v[32:35], v[120:123], v[156:159], v[32:35]
    ds_read_b64 v[56:57], v6 offset:1280
    v_mfma_f32_16x16x32_bf16 v[36:39], v[120:123], v[160:163], v[36:39]
    ds_read_b64 v[58:59], v6 offset:1288
    v_mfma_f32_16x16x32_bf16 v[40:43], v[120:123], v[164:167], v[40:43]
    ds_read_b128 v[88:91], v7 offset:2816
    s_waitcnt lgkmcnt(14)
    v_mfma_f32_16x16x32_bf16 v[28:31], v[124:127], v[148:151], v[28:31]
    ds_read_b64 v[60:61], v6 offset:1792
    v_mfma_f32_16x16x32_bf16 v[32:35], v[124:127], v[152:155], v[32:35]
    ds_read_b64 v[62:63], v6 offset:1800
    v_mfma_f32_16x16x32_bf16 v[36:39], v[124:127], v[156:159], v[36:39]
    ds_read_b128 v[84:87], v7 offset:3328
    v_mfma_f32_16x16x32_bf16 v[40:43], v[124:127], v[160:163], v[40:43]
    ds_read_b64 v[64:65], v6 offset:2304
    v_mfma_f32_16x16x32_bf16 v[28:31], v[128:131], v[144:147], v[28:31]
    ds_read_b64 v[66:67], v6 offset:2312
    v_mfma_f32_16x16x32_bf16 v[32:35], v[128:131], v[148:151], v[32:35]
    ds_read_b128 v[80:83], v7 offset:3840
    v_mfma_f32_16x16x32_bf16 v[36:39], v[128:131], v[152:155], v[36:39]
    ds_read_b64 v[68:69], v6 offset:2816
    v_mfma_f32_16x16x32_bf16 v[40:43], v[128:131], v[156:159], v[40:43]
    ds_read_b64 v[70:71], v6 offset:2824
    v_mfma_f32_16x16x32_bf16 v[32:35], v[132:135], v[144:147], v[32:35]
    ds_read_b64 v[72:73], v6 offset:3328
    v_mfma_f32_16x16x32_bf16 v[36:39], v[132:135], v[148:151], v[36:39]
    ds_read_b64 v[74:75], v6 offset:3336
    v_mfma_f32_16x16x32_bf16 v[40:43], v[132:135], v[152:155], v[40:43]
    ds_read_b64 v[76:77], v6 offset:3840
    v_mfma_f32_16x16x32_bf16 v[36:39], v[136:139], v[144:147], v[36:39]
    ds_read_b64 v[78:79], v6 offset:3848
    v_mfma_f32_16x16x32_bf16 v[40:43], v[136:139], v[148:151], v[40:43]
    s_waitcnt lgkmcnt(14)
    v_mfma_f32_16x16x32_bf16 v[40:43], v[140:143], v[144:147], v[40:43]
    v_mfma_f32_16x16x32_bf16 v[28:31], v[48:51], v[96:99], v[28:31]
    ds_read_b64 v[112:113], v6 offset:320
    v_mfma_f32_16x16x32_bf16 v[32:35], v[48:51], v[100:103], v[32:35]
    ds_read_b64 v[114:115], v6 offset:328
    v_mfma_f32_16x16x32_bf16 v[36:39], v[48:51], v[104:107], v[36:39]
    ds_read_b128 v[160:163], v7 offset:1856
    v_mfma_f32_16x16x32_bf16 v[40:43], v[48:51], v[108:111], v[40:43]
    ds_read_b128 v[164:167], v7 offset:1344
    v_mfma_f32_16x16x32_bf16 v[28:31], v[52:55], v[92:95], v[28:31]
    ds_read_b128 v[168:171], v7 offset:832
    v_mfma_f32_16x16x32_bf16 v[32:35], v[52:55], v[96:99], v[32:35]
    ds_read_b128 v[172:175], v7 offset:320
    v_mfma_f32_16x16x32_bf16 v[36:39], v[52:55], v[100:103], v[36:39]
    ds_read_b64 v[116:117], v6 offset:832
    v_mfma_f32_16x16x32_bf16 v[40:43], v[52:55], v[104:107], v[40:43]
    ds_read_b64 v[118:119], v6 offset:840
    s_waitcnt lgkmcnt(14)
    v_mfma_f32_16x16x32_bf16 v[28:31], v[56:59], v[88:91], v[28:31]
    ds_read_b128 v[156:159], v7 offset:2368
    v_mfma_f32_16x16x32_bf16 v[32:35], v[56:59], v[92:95], v[32:35]
    ds_read_b64 v[120:121], v6 offset:1344
    v_mfma_f32_16x16x32_bf16 v[36:39], v[56:59], v[96:99], v[36:39]
    ds_read_b64 v[122:123], v6 offset:1352
    v_mfma_f32_16x16x32_bf16 v[40:43], v[56:59], v[100:103], v[40:43]
    ds_read_b128 v[152:155], v7 offset:2880
    v_mfma_f32_16x16x32_bf16 v[28:31], v[60:63], v[84:87], v[28:31]
    ds_read_b64 v[124:125], v6 offset:1856
    v_mfma_f32_16x16x32_bf16 v[32:35], v[60:63], v[88:91], v[32:35]
    ds_read_b64 v[126:127], v6 offset:1864
    v_mfma_f32_16x16x32_bf16 v[36:39], v[60:63], v[92:95], v[36:39]
    ds_read_b128 v[148:151], v7 offset:3392
    v_mfma_f32_16x16x32_bf16 v[40:43], v[60:63], v[96:99], v[40:43]
    ds_read_b64 v[128:129], v6 offset:2368
    v_mfma_f32_16x16x32_bf16 v[28:31], v[64:67], v[80:83], v[28:31]
    ds_read_b64 v[130:131], v6 offset:2376
    v_mfma_f32_16x16x32_bf16 v[32:35], v[64:67], v[84:87], v[32:35]
    ds_read_b128 v[144:147], v7 offset:3904
    v_mfma_f32_16x16x32_bf16 v[36:39], v[64:67], v[88:91], v[36:39]
    ds_read_b64 v[132:133], v6 offset:2880
    v_mfma_f32_16x16x32_bf16 v[40:43], v[64:67], v[92:95], v[40:43]
    ds_read_b64 v[134:135], v6 offset:2888
    s_waitcnt lgkmcnt(14)
    v_mfma_f32_16x16x32_bf16 v[32:35], v[68:71], v[80:83], v[32:35]
    ds_read_b64 v[136:137], v6 offset:3392
    v_mfma_f32_16x16x32_bf16 v[36:39], v[68:71], v[84:87], v[36:39]
    ds_read_b64 v[138:139], v6 offset:3400
    v_mfma_f32_16x16x32_bf16 v[40:43], v[68:71], v[88:91], v[40:43]
    ds_read_b64 v[140:141], v6 offset:3904
    v_mfma_f32_16x16x32_bf16 v[36:39], v[72:75], v[80:83], v[36:39]
    ds_read_b64 v[142:143], v6 offset:3912
    v_mfma_f32_16x16x32_bf16 v[40:43], v[72:75], v[84:87], v[40:43]
    v_mfma_f32_16x16x32_bf16 v[40:43], v[76:79], v[80:83], v[40:43]
    v_mfma_f32_16x16x32_bf16 v[28:31], v[112:115], v[160:163], v[28:31]
    ds_read_b64 v[48:49], v6 offset:384
    v_mfma_f32_16x16x32_bf16 v[32:35], v[112:115], v[164:167], v[32:35]
    ds_read_b64 v[50:51], v6 offset:392
    v_mfma_f32_16x16x32_bf16 v[36:39], v[112:115], v[168:171], v[36:39]
    ds_read_b128 v[96:99], v7 offset:1920
    v_mfma_f32_16x16x32_bf16 v[40:43], v[112:115], v[172:175], v[40:43]
    ds_read_b128 v[100:103], v7 offset:1408
    s_waitcnt lgkmcnt(14)
    v_mfma_f32_16x16x32_bf16 v[28:31], v[116:119], v[156:159], v[28:31]
    ds_read_b128 v[104:107], v7 offset:896
    v_mfma_f32_16x16x32_bf16 v[32:35], v[116:119], v[160:163], v[32:35]
    ds_read_b128 v[108:111], v7 offset:384
    v_mfma_f32_16x16x32_bf16 v[36:39], v[116:119], v[164:167], v[36:39]
    ds_read_b64 v[52:53], v6 offset:896
    v_mfma_f32_16x16x32_bf16 v[40:43], v[116:119], v[168:171], v[40:43]
    ds_read_b64 v[54:55], v6 offset:904
    v_mfma_f32_16x16x32_bf16 v[28:31], v[120:123], v[152:155], v[28:31]
    ds_read_b128 v[92:95], v7 offset:2432
    v_mfma_f32_16x16x32_bf16 v[32:35], v[120:123], v[156:159], v[32:35]
    ds_read_b64 v[56:57], v6 offset:1408
    v_mfma_f32_16x16x32_bf16 v[36:39], v[120:123], v[160:163], v[36:39]
    ds_read_b64 v[58:59], v6 offset:1416
    v_mfma_f32_16x16x32_bf16 v[40:43], v[120:123], v[164:167], v[40:43]
    ds_read_b128 v[88:91], v7 offset:2944
    s_waitcnt lgkmcnt(14)
    v_mfma_f32_16x16x32_bf16 v[28:31], v[124:127], v[148:151], v[28:31]
    ds_read_b64 v[60:61], v6 offset:1920
    v_mfma_f32_16x16x32_bf16 v[32:35], v[124:127], v[152:155], v[32:35]
    ds_read_b64 v[62:63], v6 offset:1928
    v_mfma_f32_16x16x32_bf16 v[36:39], v[124:127], v[156:159], v[36:39]
    ds_read_b128 v[84:87], v7 offset:3456
    v_mfma_f32_16x16x32_bf16 v[40:43], v[124:127], v[160:163], v[40:43]
    ds_read_b64 v[64:65], v6 offset:2432
    v_mfma_f32_16x16x32_bf16 v[28:31], v[128:131], v[144:147], v[28:31]
    ds_read_b64 v[66:67], v6 offset:2440
    v_mfma_f32_16x16x32_bf16 v[32:35], v[128:131], v[148:151], v[32:35]
    ds_read_b128 v[80:83], v7 offset:3968
    v_mfma_f32_16x16x32_bf16 v[36:39], v[128:131], v[152:155], v[36:39]
    ds_read_b64 v[68:69], v6 offset:2944
    v_mfma_f32_16x16x32_bf16 v[40:43], v[128:131], v[156:159], v[40:43]
    ds_read_b64 v[70:71], v6 offset:2952
    v_mfma_f32_16x16x32_bf16 v[32:35], v[132:135], v[144:147], v[32:35]
    ds_read_b64 v[72:73], v6 offset:3456
    v_mfma_f32_16x16x32_bf16 v[36:39], v[132:135], v[148:151], v[36:39]
    ds_read_b64 v[74:75], v6 offset:3464
    v_mfma_f32_16x16x32_bf16 v[40:43], v[132:135], v[152:155], v[40:43]
    ds_read_b64 v[76:77], v6 offset:3968
    v_mfma_f32_16x16x32_bf16 v[36:39], v[136:139], v[144:147], v[36:39]
    ds_read_b64 v[78:79], v6 offset:3976
    v_mfma_f32_16x16x32_bf16 v[40:43], v[136:139], v[148:151], v[40:43]
    s_waitcnt lgkmcnt(14)
    v_mfma_f32_16x16x32_bf16 v[40:43], v[140:143], v[144:147], v[40:43]
    v_mfma_f32_16x16x32_bf16 v[28:31], v[48:51], v[96:99], v[28:31]
    ds_read_b64 v[112:113], v6 offset:448
    v_mfma_f32_16x16x32_bf16 v[32:35], v[48:51], v[100:103], v[32:35]
    ds_read_b64 v[114:115], v6 offset:456
    v_mfma_f32_16x16x32_bf16 v[36:39], v[48:51], v[104:107], v[36:39]
    ds_read_b128 v[160:163], v7 offset:1984
    v_mfma_f32_16x16x32_bf16 v[40:43], v[48:51], v[108:111], v[40:43]
    ds_read_b128 v[164:167], v7 offset:1472
    v_mfma_f32_16x16x32_bf16 v[28:31], v[52:55], v[92:95], v[28:31]
    ds_read_b128 v[168:171], v7 offset:960
    v_mfma_f32_16x16x32_bf16 v[32:35], v[52:55], v[96:99], v[32:35]
    ds_read_b128 v[172:175], v7 offset:448
    v_mfma_f32_16x16x32_bf16 v[36:39], v[52:55], v[100:103], v[36:39]
    ds_read_b64 v[116:117], v6 offset:960
    v_mfma_f32_16x16x32_bf16 v[40:43], v[52:55], v[104:107], v[40:43]
    ds_read_b64 v[118:119], v6 offset:968
    s_waitcnt lgkmcnt(14)
    v_mfma_f32_16x16x32_bf16 v[28:31], v[56:59], v[88:91], v[28:31]
    ds_read_b128 v[156:159], v7 offset:2496
    v_mfma_f32_16x16x32_bf16 v[32:35], v[56:59], v[92:95], v[32:35]
    ds_read_b64 v[120:121], v6 offset:1472
    v_mfma_f32_16x16x32_bf16 v[36:39], v[56:59], v[96:99], v[36:39]
    ds_read_b64 v[122:123], v6 offset:1480
    v_mfma_f32_16x16x32_bf16 v[40:43], v[56:59], v[100:103], v[40:43]
    ds_read_b128 v[152:155], v7 offset:3008
    v_mfma_f32_16x16x32_bf16 v[28:31], v[60:63], v[84:87], v[28:31]
    ds_read_b64 v[124:125], v6 offset:1984
    v_mfma_f32_16x16x32_bf16 v[32:35], v[60:63], v[88:91], v[32:35]
    ds_read_b64 v[126:127], v6 offset:1992
    v_mfma_f32_16x16x32_bf16 v[36:39], v[60:63], v[92:95], v[36:39]
    ds_read_b128 v[148:151], v7 offset:3520
    v_mfma_f32_16x16x32_bf16 v[40:43], v[60:63], v[96:99], v[40:43]
    ds_read_b64 v[128:129], v6 offset:2496
    v_mfma_f32_16x16x32_bf16 v[28:31], v[64:67], v[80:83], v[28:31]
    ds_read_b64 v[130:131], v6 offset:2504
    v_mfma_f32_16x16x32_bf16 v[32:35], v[64:67], v[84:87], v[32:35]
    ds_read_b128 v[144:147], v7 offset:4032
    v_mfma_f32_16x16x32_bf16 v[36:39], v[64:67], v[88:91], v[36:39]
    ds_read_b64 v[132:133], v6 offset:3008
    v_mfma_f32_16x16x32_bf16 v[40:43], v[64:67], v[92:95], v[40:43]
    ds_read_b64 v[134:135], v6 offset:3016
    s_waitcnt lgkmcnt(14)
    v_mfma_f32_16x16x32_bf16 v[32:35], v[68:71], v[80:83], v[32:35]
    ds_read_b64 v[136:137], v6 offset:3520
    v_mfma_f32_16x16x32_bf16 v[36:39], v[68:71], v[84:87], v[36:39]
    ds_read_b64 v[138:139], v6 offset:3528
    v_mfma_f32_16x16x32_bf16 v[40:43], v[68:71], v[88:91], v[40:43]
    ds_read_b64 v[140:141], v6 offset:4032
    v_mfma_f32_16x16x32_bf16 v[36:39], v[72:75], v[80:83], v[36:39]
    ds_read_b64 v[142:143], v6 offset:4040
    v_mfma_f32_16x16x32_bf16 v[40:43], v[72:75], v[84:87], v[40:43]
    v_mfma_f32_16x16x32_bf16 v[40:43], v[76:79], v[80:83], v[40:43]
    v_mfma_f32_16x16x32_bf16 v[28:31], v[112:115], v[160:163], v[28:31]
    v_mfma_f32_16x16x32_bf16 v[32:35], v[112:115], v[164:167], v[32:35]
    v_mfma_f32_16x16x32_bf16 v[36:39], v[112:115], v[168:171], v[36:39]
    v_mfma_f32_16x16x32_bf16 v[40:43], v[112:115], v[172:175], v[40:43]
    s_waitcnt lgkmcnt(14)
    v_mfma_f32_16x16x32_bf16 v[28:31], v[116:119], v[156:159], v[28:31]
    v_mfma_f32_16x16x32_bf16 v[32:35], v[116:119], v[160:163], v[32:35]
    v_mfma_f32_16x16x32_bf16 v[36:39], v[116:119], v[164:167], v[36:39]
    v_mfma_f32_16x16x32_bf16 v[40:43], v[116:119], v[168:171], v[40:43]
    s_waitcnt lgkmcnt(13)
    s_waitcnt lgkmcnt(12)
    v_mfma_f32_16x16x32_bf16 v[28:31], v[120:123], v[152:155], v[28:31]
    v_mfma_f32_16x16x32_bf16 v[32:35], v[120:123], v[156:159], v[32:35]
    v_mfma_f32_16x16x32_bf16 v[36:39], v[120:123], v[160:163], v[36:39]
    v_mfma_f32_16x16x32_bf16 v[40:43], v[120:123], v[164:167], v[40:43]
    s_waitcnt lgkmcnt(10)
    s_waitcnt lgkmcnt(9)
    v_mfma_f32_16x16x32_bf16 v[28:31], v[124:127], v[148:151], v[28:31]
    v_mfma_f32_16x16x32_bf16 v[32:35], v[124:127], v[152:155], v[32:35]
    v_mfma_f32_16x16x32_bf16 v[36:39], v[124:127], v[156:159], v[36:39]
    v_mfma_f32_16x16x32_bf16 v[40:43], v[124:127], v[160:163], v[40:43]
    s_waitcnt lgkmcnt(7)
    s_waitcnt lgkmcnt(6)
    v_mfma_f32_16x16x32_bf16 v[28:31], v[128:131], v[144:147], v[28:31]
    v_mfma_f32_16x16x32_bf16 v[32:35], v[128:131], v[148:151], v[32:35]
    v_mfma_f32_16x16x32_bf16 v[36:39], v[128:131], v[152:155], v[36:39]
    v_mfma_f32_16x16x32_bf16 v[40:43], v[128:131], v[156:159], v[40:43]
    s_waitcnt lgkmcnt(4)
    v_mfma_f32_16x16x32_bf16 v[32:35], v[132:135], v[144:147], v[32:35]
    v_mfma_f32_16x16x32_bf16 v[36:39], v[132:135], v[148:151], v[36:39]
    v_mfma_f32_16x16x32_bf16 v[40:43], v[132:135], v[152:155], v[40:43]
    s_waitcnt lgkmcnt(2)
    v_mfma_f32_16x16x32_bf16 v[36:39], v[136:139], v[144:147], v[36:39]
    v_mfma_f32_16x16x32_bf16 v[40:43], v[136:139], v[148:151], v[40:43]
    s_waitcnt lgkmcnt(0)
    v_mfma_f32_16x16x32_bf16 v[40:43], v[140:143], v[144:147], v[40:43]
    v_cvt_pk_bf16_f32 v184, v28, v29
    v_cvt_pk_bf16_f32 v185, v30, v31
    v_cvt_pk_bf16_f32 v186, v32, v33
    v_cvt_pk_bf16_f32 v187, v34, v35
    s_nop 0
    v_cvt_pk_bf16_f32 v188, v36, v37
    v_cvt_pk_bf16_f32 v189, v38, v39
    s_nop 0
    v_cvt_pk_bf16_f32 v190, v40, v41
    v_cvt_pk_bf16_f32 v191, v42, v43
    ds_write_addtid_b32 v184 offset:10368
    ds_write_addtid_b32 v185 offset:10624
    ds_write_addtid_b32 v186 offset:10880
    ds_write_addtid_b32 v187 offset:11136
    ds_write_addtid_b32 v188 offset:11392
    ds_write_addtid_b32 v189 offset:11648
    ds_write_addtid_b32 v190 offset:11904
    ds_write_addtid_b32 v191 offset:12160
    s_waitcnt lgkmcnt(0)
    s_barrier
    s_endpgm
role_p:
    s_sub_u32 s48, s2, 144
    v_and_b32 v1, 63, v0
    v_and_b32 v2, 15, v0
    v_lshrrev_b32 v3, 4, v1
    v_mul_u32_u24 v6, 1152, v1
    v_and_b32 v7, 3, v0
    v_lshlrev_b32 v7, 2, v7
    s_lshr_b32 s55, s48, 3
    s_lshl_b32 s55, s55, 3
    s_add_u32 s55, s55, s3
    s_lshl_b32 s52, s48, 1
    s_lshr_b32 s49, s3, 2
    s_add_u32 s52, s52, s49
    s_min_u32 s52, s52, 71
    s_and_b32 s53, s3, 3
    s_lshr_b32 s49, s53, 1
    s_lshl_b32 s49, s49, 1
    s_add_u32 s49, s49, s53
    s_lshl_b32 s51, s52, 3
    s_add_u32 s51, s51, s49
    s_add_u32 s51, s51, 2
    s_mul_i32 s54, s3, 9216
    s_waitcnt lgkmcnt(0)
    s_mov_b64 s[4:5], s[82:83]
    s_mov_b64 s[6:7], s[84:85]
    s_mov_b64 s[8:9], s[86:87]
    s_mov_b64 s[10:11], s[88:89]
    s_mov_b64 s[12:13], s[90:91]
    s_mov_b64 s[14:15], s[92:93]
    s_mov_b64 s[16:17], s[98:99]
    s_mov_b64 s[18:19], s[100:101]
    s_mov_b64 s[24:25], s[70:71]
    s_mov_b64 s[26:27], s[72:73]
    s_mov_b64 s[28:29], s[74:75]
    s_mov_b64 s[30:31], s[76:77]
    s_mov_b32 s36, s16
    s_mov_b32 s37, s17
    s_mov_b32 s38, 256
    s_mov_b32 s39, 0x00020000
    s_cmp_lt_u32 s48, 36
    s_cbranch_scc1 p_noclear
    s_add_u32 s40, s18, 8388608
    s_addc_u32 s41, s19, 0
    s_mov_b32 s42, 101376
    s_mov_b32 s43, 0x00020000
    v_mov_b32 v200, -1
    v_mov_b32 v201, -1
    v_mov_b32 v202, -1
    v_mov_b32 v203, -1
    v_lshlrev_b32 v4, 4, v0
    s_sub_u32 s50, s48, 36
    s_mul_i32 s49, s50, 32768
    buffer_store_dwordx4 v[200:203], v4, s[40:43], s49 offen sc1
    s_add_u32 s49, s49, 8192
    buffer_store_dwordx4 v[200:203], v4, s[40:43], s49 offen sc1
    s_add_u32 s49, s49, 8192
    buffer_store_dwordx4 v[200:203], v4, s[40:43], s49 offen sc1
    s_add_u32 s49, s49, 8192
    buffer_store_dwordx4 v[200:203], v4, s[40:43], s49 offen sc1
    s_add_u32 s49, s49, 8192
    s_lshl_b32 s50, s50, 2
    v_mov_b32 v4, s50
    v_mov_b32 v5, 0x7fffffff
    v_cmp_eq_u32 vcc, 0, v0
    s_nop 1
    v_cndmask_b32 v4, v5, v4, vcc
    v_mov_b32 v5, 1
    s_waitcnt vmcnt(0)
    s_barrier
    buffer_store_dword v5, v4, s[36:39], 0 offen offset:240 sc1
p_noclear:
    s_lshl_b32 s49, s51, 8
    v_lshl_add_u32 v24, v1, 2, s49
    s_lshl_b32 s49, s51, 1
    v_mov_b32 v25, s49
    global_load_dword v12, v24, s[6:7]
    global_load_dword v13, v24, s[8:9]
    global_load_dword v14, v24, s[10:11]
    global_load_dword v15, v24, s[12:13]
    global_load_ushort v16, v25, s[14:15]
    s_and_b32 s59, s2, 7
    s_add_u32 s56, s55, 0
    s_mul_i32 s57, s56, 57
    s_lshr_b32 s57, s57, 9
    s_mul_i32 s49, s57, 9
    s_sub_u32 s56, s56, s49
    s_lshr_b32 s58, s57, 1
    s_add_u32 s58, s58, s59
    s_cmp_ge_u32 s58, 9
    s_cselect_b32 s62, 9, 0
    s_sub_u32 s58, s58, s62
    s_and_b32 s57, s57, 1
    s_cmp_eq_u32 s57, 0
    s_cselect_b32 s44, s28, s30
    s_cselect_b32 s45, s29, s31
    s_mov_b32 s46, 663552
    s_mov_b32 s47, 0x00020000
    s_mul_i32 s49, s56, 73728
    s_lshl_b32 s50, s58, 7
    s_add_u32 s49, s49, s50
    buffer_load_dword v250, v6, s[44:47], s49 offen
p_t1:
    s_cmp_ge_u32 s48, 36
    s_cbranch_scc1 p_nok
    v_lshl_add_u32 v24, v3, 4, s54
    v_mul_u32_u24 v25, 288, v2
    v_add_u32 v17, v24, v25
    v_cmp_gt_u32 vcc, 8, v2
    v_lshlrev_b32 v21, 2, v2
    v_and_b32 v21, 31, v21
    v_mov_b32 v18, 0x43222100
    v_mov_b32 v25, 0x87666544
    v_cndmask_b32 v18, v25, v18, vcc
    v_bfe_u32 v18, v18, v21, 4
    v_mul_u32_u24 v18, 288, v18
    v_add_u32 v18, v18, v24
    v_mov_b32 v19, 0x44322210
    v_mov_b32 v25, 0x99877765
    v_cndmask_b32 v19, v25, v19, vcc
    v_bfe_u32 v19, v19, v21, 4
    v_mul_u32_u24 v19, 288, v19
    v_add_u32 v19, 2592, v19
    v_add_u32 v19, v19, v24
    v_mov_b32 v20, 0x55432210
    v_mov_b32 v25, 0xbba98876
    v_cndmask_b32 v20, v25, v20, vcc
    v_bfe_u32 v20, v20, v21, 4
    v_mul_u32_u24 v20, 288, v20
    v_add_u32 v20, 5472, v20
    v_add_u32 v20, v20, v24
    s_waitcnt vmcnt(1)
    v_and_b32 v24, 0x7fff7fff, v14
    v_and_b32 v25, 0x7fff7fff, v15
    v_pk_max_u16 v24, v24, v25
    v_lshlrev_b32 v25, 16, v24
    v_max_u32 v24, v24, v25
    v_lshlrev_b32 v23, 16, v16
    v_mul_f32 v23, 0x3fb8aa3b, v23
    v_max_u32_dpp v24, v24, v24 row_shr:1 row_mask:0xf bank_mask:0xf
    v_exp_f32 v23, v23
    s_nop 0
    v_max_u32_dpp v24, v24, v24 row_shr:2 row_mask:0xf bank_mask:0xf
    s_nop 1
    v_max_u32_dpp v24, v24, v24 row_shr:4 row_mask:0xf bank_mask:0xf
    s_nop 1
    v_max_u32_dpp v24, v24, v24 row_shr:8 row_mask:0xf bank_mask:0xf
    v_cvt_pk_bf16_f32 v23, 0, v23
    s_nop 0
    v_max_u32_dpp v24, v24, v24 row_bcast:15 row_mask:0xa bank_mask:0xf
    s_nop 1
    v_max_u32_dpp v24, v24, v24 row_bcast:31 row_mask:0xc bank_mask:0xf
    s_nop 0
    v_readlane_b32 s60, v24, 63
    s_nop 0
    s_lshr_b32 s60, s60, 23
    s_sub_u32 s60, 262, s60
    s_min_u32 s60, s60, 253
    s_sub_u32 s61, 255, s60
    s_lshl_b32 s60, s60, 23
    s_lshl_b32 s61, s61, 23
    v_lshlrev_b32 v21, 16, v12
    v_lshlrev_b32 v22, 16, v13
    v_lshlrev_b32 v110, 16, v14
    v_lshlrev_b32 v111, 16, v15
    v_mul_f32 v21, 0x3fb8aa3b, v21
    v_exp_f32 v21, v21
    v_mul_f32 v22, v22, v23
    v_cvt_pk_bf16_f32 v21, 0, v21
    v_mul_f32 v22, 0.15915494, v22
    v_mul_f32 v21, v21, v23
    v_mul_f32 v21, 0xbfb8aa3b, v21
    v_mul_f32 v110, s60, v110
    v_mul_f32 v111, s60, v111
    v_exp_f32 v24, v21
    v_rndne_f32 v96, v22
    v_sub_f32 v25, v22, v96
    v_cos_f32 v96, v25
    v_sin_f32 v97, v25
    v_mul_f32 v96, v96, v24
    v_mul_f32 v97, v97, v24
    v_mul_f32 v24, 0x41800000, v21
    v_mul_f32 v25, 0x41800000, v22
    v_exp_f32 v24, v24
    v_rndne_f32 v104, v25
    v_sub_f32 v25, v25, v104
    v_cos_f32 v104, v25
    v_sin_f32 v105, v25
    v_mul_f32 v104, v104, v24
    v_mul_f32 v105, v105, v24
    v_mul_f32 v24, 0x43800000, v21
    v_mul_f32 v25, 0x43800000, v22
    v_exp_f32 v24, v24
    v_rndne_f32 v112, v25
    v_sub_f32 v25, v25, v112
    v_cos_f32 v112, v25
    v_sin_f32 v113, v25
    v_mul_f32 v112, v112, v24
    v_mul_f32 v113, v113, v24
.p2align 3
    v_cvt_pk_f16_f32 v26, v96, v97
    v_pk_mul_f32 v[98:99], v[96:97], v[96:97] op_sel:[0,0] op_sel_hi:[1,0]
    v_pk_fma_f32 v[98:99], v[96:97], v[96:97], v[98:99] op_sel:[1,1,0] op_sel_hi:[0,1,1] neg_lo:[1,0,0]
    v_cvt_pk_f16_f32 v27, v98, v99
    v_pk_mul_f32 v[114:115], v[98:99], v[96:97] op_sel:[0,0] op_sel_hi:[1,0]
    v_pk_fma_f32 v[114:115], v[98:99], v[96:97], v[114:115] op_sel:[1,1,0] op_sel_hi:[0,1,1] neg_lo:[1,0,0]
    v_cvt_pk_f16_f32 v28, v114, v115
    v_pk_mul_f32 v[100:101], v[98:99], v[98:99] op_sel:[0,0] op_sel_hi:[1,0]
    v_pk_fma_f32 v[100:101], v[98:99], v[98:99], v[100:101] op_sel:[1,1,0] op_sel_hi:[0,1,1] neg_lo:[1,0,0]
    v_cvt_pk_f16_f32 v29, v100, v101
    v_pk_mul_f32 v[102:103], v[100:101], v[100:101] op_sel:[0,0] op_sel_hi:[1,0]
    v_pk_fma_f32 v[102:103], v[100:101], v[100:101], v[102:103] op_sel:[1,1,0] op_sel_hi:[0,1,1] neg_lo:[1,0,0]
    v_cvt_pk_f16_f32 v30, v102, v103
    v_pk_mul_f32 v[114:115], v[102:103], v[100:101] op_sel:[0,0] op_sel_hi:[1,0]
    v_pk_fma_f32 v[114:115], v[102:103], v[100:101], v[114:115] op_sel:[1,1,0] op_sel_hi:[0,1,1] neg_lo:[1,0,0]
    v_cvt_pk_f16_f32 v31, v114, v115
    v_cvt_pk_f16_f32 v32, v104, v105
    v_pk_mul_f32 v[106:107], v[104:105], v[104:105] op_sel:[0,0] op_sel_hi:[1,0]
    v_pk_fma_f32 v[106:107], v[104:105], v[104:105], v[106:107] op_sel:[1,1,0] op_sel_hi:[0,1,1] neg_lo:[1,0,0]
    v_cvt_pk_f16_f32 v33, v106, v107
    v_pk_mul_f32 v[114:115], v[106:107], v[104:105] op_sel:[0,0] op_sel_hi:[1,0]
    v_pk_fma_f32 v[114:115], v[106:107], v[104:105], v[114:115] op_sel:[1,1,0] op_sel_hi:[0,1,1] neg_lo:[1,0,0]
    v_cvt_pk_f16_f32 v34, v114, v115
    v_pk_mul_f32 v[108:109], v[106:107], v[106:107] op_sel:[0,0] op_sel_hi:[1,0]
    v_pk_fma_f32 v[108:109], v[106:107], v[106:107], v[108:109] op_sel:[1,1,0] op_sel_hi:[0,1,1] neg_lo:[1,0,0]
    v_cvt_pk_f16_f32 v35, v110, -v111
    v_pk_mul_f32 v[114:115], v[110:111], v[108:109] op_sel:[0,0] op_sel_hi:[1,0]
    v_pk_fma_f32 v[114:115], v[110:111], v[108:109], v[114:115] op_sel:[1,1,0] op_sel_hi:[0,1,1] neg_lo:[1,0,0]
    v_cvt_pk_f16_f32 v36, v114, -v115
    v_pk_mul_f32 v[116:117], v[114:115], v[108:109] op_sel:[0,0] op_sel_hi:[1,0]
    v_pk_fma_f32 v[116:117], v[114:115], v[108:109], v[116:117] op_sel:[1,1,0] op_sel_hi:[0,1,1] neg_lo:[1,0,0]
    v_cvt_pk_f16_f32 v37, v116, -v117
    v_pk_mul_f32 v[114:115], v[116:117], v[108:109] op_sel:[0,0] op_sel_hi:[1,0]
    v_pk_fma_f32 v[114:115], v[116:117], v[108:109], v[114:115] op_sel:[1,1,0] op_sel_hi:[0,1,1] neg_lo:[1,0,0]
    v_cvt_pk_f16_f32 v38, v114, -v115
    v_cvt_pk_f16_f32 v39, v112, v113
    v_pk_mul_f32 v[114:115], v[112:113], v[112:113] op_sel:[0,0] op_sel_hi:[1,0]
    v_pk_fma_f32 v[114:115], v[112:113], v[112:113], v[114:115] op_sel:[1,1,0] op_sel_hi:[0,1,1] neg_lo:[1,0,0]
    v_cvt_pk_f16_f32 v40, v114, v115
    v_pk_mul_f32 v[116:117], v[114:115], v[112:113] op_sel:[0,0] op_sel_hi:[1,0]
    v_pk_fma_f32 v[116:117], v[114:115], v[112:113], v[116:117] op_sel:[1,1,0] op_sel_hi:[0,1,1] neg_lo:[1,0,0]
    v_cvt_pk_f16_f32 v41, v116, v117
    v_pk_mul_f32 v[114:115], v[116:117], v[112:113] op_sel:[0,0] op_sel_hi:[1,0]
    v_pk_fma_f32 v[114:115], v[116:117], v[112:113], v[114:115] op_sel:[1,1,0] op_sel_hi:[0,1,1] neg_lo:[1,0,0]
    v_cvt_pk_f16_f32 v42, v114, v115
    v_pk_mul_f32 v[116:117], v[114:115], v[112:113] op_sel:[0,0] op_sel_hi:[1,0]
    v_pk_fma_f32 v[116:117], v[114:115], v[112:113], v[116:117] op_sel:[1,1,0] op_sel_hi:[0,1,1] neg_lo:[1,0,0]
    v_cvt_pk_f16_f32 v43, v116, v117
    v_pk_mul_f32 v[114:115], v[116:117], v[112:113] op_sel:[0,0] op_sel_hi:[1,0]
    v_pk_fma_f32 v[114:115], v[116:117], v[112:113], v[114:115] op_sel:[1,1,0] op_sel_hi:[0,1,1] neg_lo:[1,0,0]
    v_cvt_pk_f16_f32 v44, v114, v115
    v_pk_mul_f32 v[116:117], v[114:115], v[112:113] op_sel:[0,0] op_sel_hi:[1,0]
    v_pk_fma_f32 v[116:117], v[114:115], v[112:113], v[116:117] op_sel:[1,1,0] op_sel_hi:[0,1,1] neg_lo:[1,0,0]
    v_cvt_pk_f16_f32 v45, v116, v117
    v_and_b32 v21, 0xffff0000, v12
    v_and_b32 v22, 0xffff0000, v13
    v_and_b32 v110, 0xffff0000, v14
    v_and_b32 v111, 0xffff0000, v15
    v_mul_f32 v21, 0x3fb8aa3b, v21
    v_exp_f32 v21, v21
    v_mul_f32 v22, v22, v23
    v_cvt_pk_bf16_f32 v21, 0, v21
    v_mul_f32 v22, 0.15915494, v22
    v_mul_f32 v21, v21, v23
    v_mul_f32 v21, 0xbfb8aa3b, v21
    v_mul_f32 v110, s60, v110
    v_mul_f32 v111, s60, v111
    v_exp_f32 v24, v21
    v_rndne_f32 v96, v22
    v_sub_f32 v25, v22, v96
    v_cos_f32 v96, v25
    v_sin_f32 v97, v25
    v_mul_f32 v96, v96, v24
    v_mul_f32 v97, v97, v24
    v_mul_f32 v24, 0x41800000, v21
    v_mul_f32 v25, 0x41800000, v22
    v_exp_f32 v24, v24
    v_rndne_f32 v104, v25
    v_sub_f32 v25, v25, v104
    v_cos_f32 v104, v25
    v_sin_f32 v105, v25
    v_mul_f32 v104, v104, v24
    v_mul_f32 v105, v105, v24
    v_mul_f32 v24, 0x43800000, v21
    v_mul_f32 v25, 0x43800000, v22
    v_exp_f32 v24, v24
    v_rndne_f32 v112, v25
    v_sub_f32 v25, v25, v112
    v_cos_f32 v112, v25
    v_sin_f32 v113, v25
    v_mul_f32 v112, v112, v24
    v_mul_f32 v113, v113, v24
.p2align 3
    v_cvt_pk_f16_f32 v46, v96, v97
    v_pk_mul_f32 v[98:99], v[96:97], v[96:97] op_sel:[0,0] op_sel_hi:[1,0]
    v_pk_fma_f32 v[98:99], v[96:97], v[96:97], v[98:99] op_sel:[1,1,0] op_sel_hi:[0,1,1] neg_lo:[1,0,0]
    v_cvt_pk_f16_f32 v47, v98, v99
    v_pk_mul_f32 v[114:115], v[98:99], v[96:97] op_sel:[0,0] op_sel_hi:[1,0]
    v_pk_fma_f32 v[114:115], v[98:99], v[96:97], v[114:115] op_sel:[1,1,0] op_sel_hi:[0,1,1] neg_lo:[1,0,0]
    v_cvt_pk_f16_f32 v48, v114, v115
    v_pk_mul_f32 v[100:101], v[98:99], v[98:99] op_sel:[0,0] op_sel_hi:[1,0]
    v_pk_fma_f32 v[100:101], v[98:99], v[98:99], v[100:101] op_sel:[1,1,0] op_sel_hi:[0,1,1] neg_lo:[1,0,0]
    v_cvt_pk_f16_f32 v49, v100, v101
    v_pk_mul_f32 v[102:103], v[100:101], v[100:101] op_sel:[0,0] op_sel_hi:[1,0]
    v_pk_fma_f32 v[102:103], v[100:101], v[100:101], v[102:103] op_sel:[1,1,0] op_sel_hi:[0,1,1] neg_lo:[1,0,0]
    v_cvt_pk_f16_f32 v50, v102, v103
    v_pk_mul_f32 v[114:115], v[102:103], v[100:101] op_sel:[0,0] op_sel_hi:[1,0]
    v_pk_fma_f32 v[114:115], v[102:103], v[100:101], v[114:115] op_sel:[1,1,0] op_sel_hi:[0,1,1] neg_lo:[1,0,0]
    v_cvt_pk_f16_f32 v51, v114, v115
    v_cvt_pk_f16_f32 v52, v104, v105
    v_pk_mul_f32 v[106:107], v[104:105], v[104:105] op_sel:[0,0] op_sel_hi:[1,0]
    v_pk_fma_f32 v[106:107], v[104:105], v[104:105], v[106:107] op_sel:[1,1,0] op_sel_hi:[0,1,1] neg_lo:[1,0,0]
    v_cvt_pk_f16_f32 v53, v106, v107
    v_pk_mul_f32 v[114:115], v[106:107], v[104:105] op_sel:[0,0] op_sel_hi:[1,0]
    v_pk_fma_f32 v[114:115], v[106:107], v[104:105], v[114:115] op_sel:[1,1,0] op_sel_hi:[0,1,1] neg_lo:[1,0,0]
    v_cvt_pk_f16_f32 v54, v114, v115
    v_pk_mul_f32 v[108:109], v[106:107], v[106:107] op_sel:[0,0] op_sel_hi:[1,0]
    v_pk_fma_f32 v[108:109], v[106:107], v[106:107], v[108:109] op_sel:[1,1,0] op_sel_hi:[0,1,1] neg_lo:[1,0,0]
    v_cvt_pk_f16_f32 v55, v110, -v111
    v_pk_mul_f32 v[114:115], v[110:111], v[108:109] op_sel:[0,0] op_sel_hi:[1,0]
    v_pk_fma_f32 v[114:115], v[110:111], v[108:109], v[114:115] op_sel:[1,1,0] op_sel_hi:[0,1,1] neg_lo:[1,0,0]
    v_cvt_pk_f16_f32 v56, v114, -v115
    v_pk_mul_f32 v[116:117], v[114:115], v[108:109] op_sel:[0,0] op_sel_hi:[1,0]
    v_pk_fma_f32 v[116:117], v[114:115], v[108:109], v[116:117] op_sel:[1,1,0] op_sel_hi:[0,1,1] neg_lo:[1,0,0]
    v_cvt_pk_f16_f32 v57, v116, -v117
    v_pk_mul_f32 v[114:115], v[116:117], v[108:109] op_sel:[0,0] op_sel_hi:[1,0]
    v_pk_fma_f32 v[114:115], v[116:117], v[108:109], v[114:115] op_sel:[1,1,0] op_sel_hi:[0,1,1] neg_lo:[1,0,0]
    v_cvt_pk_f16_f32 v58, v114, -v115
    v_cvt_pk_f16_f32 v59, v112, v113
    v_pk_mul_f32 v[114:115], v[112:113], v[112:113] op_sel:[0,0] op_sel_hi:[1,0]
    v_pk_fma_f32 v[114:115], v[112:113], v[112:113], v[114:115] op_sel:[1,1,0] op_sel_hi:[0,1,1] neg_lo:[1,0,0]
    v_cvt_pk_f16_f32 v60, v114, v115
    v_pk_mul_f32 v[116:117], v[114:115], v[112:113] op_sel:[0,0] op_sel_hi:[1,0]
    v_pk_fma_f32 v[116:117], v[114:115], v[112:113], v[116:117] op_sel:[1,1,0] op_sel_hi:[0,1,1] neg_lo:[1,0,0]
    v_cvt_pk_f16_f32 v61, v116, v117
    v_pk_mul_f32 v[114:115], v[116:117], v[112:113] op_sel:[0,0] op_sel_hi:[1,0]
    v_pk_fma_f32 v[114:115], v[116:117], v[112:113], v[114:115] op_sel:[1,1,0] op_sel_hi:[0,1,1] neg_lo:[1,0,0]
    v_cvt_pk_f16_f32 v62, v114, v115
    v_pk_mul_f32 v[116:117], v[114:115], v[112:113] op_sel:[0,0] op_sel_hi:[1,0]
    v_pk_fma_f32 v[116:117], v[114:115], v[112:113], v[116:117] op_sel:[1,1,0] op_sel_hi:[0,1,1] neg_lo:[1,0,0]
    v_cvt_pk_f16_f32 v63, v116, v117
    v_pk_mul_f32 v[114:115], v[116:117], v[112:113] op_sel:[0,0] op_sel_hi:[1,0]
    v_pk_fma_f32 v[114:115], v[116:117], v[112:113], v[114:115] op_sel:[1,1,0] op_sel_hi:[0,1,1] neg_lo:[1,0,0]
    v_cvt_pk_f16_f32 v64, v114, v115
    v_pk_mul_f32 v[116:117], v[114:115], v[112:113] op_sel:[0,0] op_sel_hi:[1,0]
    v_pk_fma_f32 v[116:117], v[114:115], v[112:113], v[116:117] op_sel:[1,1,0] op_sel_hi:[0,1,1] neg_lo:[1,0,0]
    v_cvt_pk_f16_f32 v65, v116, v117
    s_add_u32 s56, s55, 40
    s_mul_i32 s57, s56, 57
    s_lshr_b32 s57, s57, 9
    s_mul_i32 s49, s57, 9
    s_sub_u32 s56, s56, s49
    s_lshr_b32 s58, s57, 1
    s_add_u32 s58, s58, s59
    s_cmp_ge_u32 s58, 9
    s_cselect_b32 s62, 9, 0
    s_sub_u32 s58, s58, s62
    s_and_b32 s57, s57, 1
    s_cmp_eq_u32 s57, 0
    s_cselect_b32 s44, s28, s30
    s_cselect_b32 s45, s29, s31
    s_mov_b32 s46, 663552
    s_mov_b32 s47, 0x00020000
    s_mul_i32 s49, s56, 73728
    s_lshl_b32 s50, s58, 7
    s_add_u32 s49, s49, s50
    buffer_load_dword v250, v6, s[44:47], s49 offen
p_t2:
    v_mov_b32 v24, 0x3c00
    s_mov_b32 m0, s54
    s_nop 0
.p2align 3
    ds_write_addtid_b32 v24 offset:0
    ds_write_addtid_b32 v26 offset:288
    ds_write_addtid_b32 v27 offset:576
    ds_write_addtid_b32 v28 offset:864
    ds_write_addtid_b32 v29 offset:1152
    v_pk_mul_f16 v70, v29, v26 op_sel:[0,0] op_sel_hi:[1,0]
    v_pk_fma_f16 v70, v29, v26, v70 op_sel:[1,1,0] op_sel_hi:[0,1,1] neg_lo:[1,0,0]
    ds_write_addtid_b32 v70 offset:1440
    v_pk_mul_f16 v66, v29, v27 op_sel:[0,0] op_sel_hi:[1,0]
    v_pk_fma_f16 v66, v29, v27, v66 op_sel:[1,1,0] op_sel_hi:[0,1,1] neg_lo:[1,0,0]
    ds_write_addtid_b32 v66 offset:1728
    v_pk_mul_f16 v71, v29, v28 op_sel:[0,0] op_sel_hi:[1,0]
    v_pk_fma_f16 v71, v29, v28, v71 op_sel:[1,1,0] op_sel_hi:[0,1,1] neg_lo:[1,0,0]
    ds_write_addtid_b32 v71 offset:2016
    ds_write_addtid_b32 v30 offset:2304
    v_pk_mul_f16 v72, v30, v26 op_sel:[0,0] op_sel_hi:[1,0]
    v_pk_fma_f16 v72, v30, v26, v72 op_sel:[1,1,0] op_sel_hi:[0,1,1] neg_lo:[1,0,0]
    ds_write_addtid_b32 v72 offset:2592
    v_pk_mul_f16 v67, v30, v27 op_sel:[0,0] op_sel_hi:[1,0]
    v_pk_fma_f16 v67, v30, v27, v67 op_sel:[1,1,0] op_sel_hi:[0,1,1] neg_lo:[1,0,0]
    ds_write_addtid_b32 v67 offset:2880
    v_pk_mul_f16 v73, v30, v28 op_sel:[0,0] op_sel_hi:[1,0]
    v_pk_fma_f16 v73, v30, v28, v73 op_sel:[1,1,0] op_sel_hi:[0,1,1] neg_lo:[1,0,0]
    ds_write_addtid_b32 v73 offset:3168
    ds_write_addtid_b32 v31 offset:3456
    v_pk_mul_f16 v74, v31, v26 op_sel:[0,0] op_sel_hi:[1,0]
    v_pk_fma_f16 v74, v31, v26, v74 op_sel:[1,1,0] op_sel_hi:[0,1,1] neg_lo:[1,0,0]
    ds_write_addtid_b32 v74 offset:3744
    v_pk_mul_f16 v68, v31, v27 op_sel:[0,0] op_sel_hi:[1,0]
    v_pk_fma_f16 v68, v31, v27, v68 op_sel:[1,1,0] op_sel_hi:[0,1,1] neg_lo:[1,0,0]
    ds_write_addtid_b32 v68 offset:4032
    v_pk_mul_f16 v75, v31, v28 op_sel:[0,0] op_sel_hi:[1,0]
    v_pk_fma_f16 v75, v31, v28, v75 op_sel:[1,1,0] op_sel_hi:[0,1,1] neg_lo:[1,0,0]
    ds_write_addtid_b32 v75 offset:4320
    ds_write_addtid_b32 v35 offset:4608
    v_pk_mul_f16 v76, v35, v32 op_sel:[0,0] op_sel_hi:[1,0]
    v_pk_fma_f16 v76, v35, v32, v76 op_sel:[1,1,0] op_sel_hi:[0,1,1] neg_hi:[1,0,0]
    ds_write_addtid_b32 v76 offset:4896
    v_pk_mul_f16 v69, v35, v33 op_sel:[0,0] op_sel_hi:[1,0]
    v_pk_fma_f16 v69, v35, v33, v69 op_sel:[1,1,0] op_sel_hi:[0,1,1] neg_hi:[1,0,0]
    ds_write_addtid_b32 v69 offset:5184
    v_pk_mul_f16 v70, v35, v34 op_sel:[0,0] op_sel_hi:[1,0]
    v_pk_fma_f16 v70, v35, v34, v70 op_sel:[1,1,0] op_sel_hi:[0,1,1] neg_hi:[1,0,0]
    ds_write_addtid_b32 v70 offset:5472
    ds_write_addtid_b32 v36 offset:5760
    v_pk_mul_f16 v71, v36, v32 op_sel:[0,0] op_sel_hi:[1,0]
    v_pk_fma_f16 v71, v36, v32, v71 op_sel:[1,1,0] op_sel_hi:[0,1,1] neg_hi:[1,0,0]
    ds_write_addtid_b32 v71 offset:6048
    v_pk_mul_f16 v72, v36, v33 op_sel:[0,0] op_sel_hi:[1,0]
    v_pk_fma_f16 v72, v36, v33, v72 op_sel:[1,1,0] op_sel_hi:[0,1,1] neg_hi:[1,0,0]
    ds_write_addtid_b32 v72 offset:6336
    v_pk_mul_f16 v73, v36, v34 op_sel:[0,0] op_sel_hi:[1,0]
    v_pk_fma_f16 v73, v36, v34, v73 op_sel:[1,1,0] op_sel_hi:[0,1,1] neg_hi:[1,0,0]
    ds_write_addtid_b32 v73 offset:6624
    ds_write_addtid_b32 v37 offset:6912
    v_pk_mul_f16 v74, v37, v32 op_sel:[0,0] op_sel_hi:[1,0]
    v_pk_fma_f16 v74, v37, v32, v74 op_sel:[1,1,0] op_sel_hi:[0,1,1] neg_hi:[1,0,0]
    ds_write_addtid_b32 v74 offset:7200
    v_pk_mul_f16 v75, v37, v33 op_sel:[0,0] op_sel_hi:[1,0]
    v_pk_fma_f16 v75, v37, v33, v75 op_sel:[1,1,0] op_sel_hi:[0,1,1] neg_hi:[1,0,0]
    ds_write_addtid_b32 v75 offset:7488
    v_pk_mul_f16 v76, v37, v34 op_sel:[0,0] op_sel_hi:[1,0]
    v_pk_fma_f16 v76, v37, v34, v76 op_sel:[1,1,0] op_sel_hi:[0,1,1] neg_hi:[1,0,0]
    ds_write_addtid_b32 v76 offset:7776
    ds_write_addtid_b32 v38 offset:8064
    v_pk_mul_f16 v69, v38, v32 op_sel:[0,0] op_sel_hi:[1,0]
    v_pk_fma_f16 v69, v38, v32, v69 op_sel:[1,1,0] op_sel_hi:[0,1,1] neg_hi:[1,0,0]
    ds_write_addtid_b32 v69 offset:8352
    v_pk_mul_f16 v70, v38, v33 op_sel:[0,0] op_sel_hi:[1,0]
    v_pk_fma_f16 v70, v38, v33, v70 op_sel:[1,1,0] op_sel_hi:[0,1,1] neg_hi:[1,0,0]
    ds_write_addtid_b32 v70 offset:8640
    v_pk_mul_f16 v71, v38, v34 op_sel:[0,0] op_sel_hi:[1,0]
    v_pk_fma_f16 v71, v38, v34, v71 op_sel:[1,1,0] op_sel_hi:[0,1,1] neg_hi:[1,0,0]
    ds_write_addtid_b32 v71 offset:8928
    ds_read_b128 v[96:99], v17 offset:0
    ds_read_b128 v[100:103], v17 offset:4608
    ds_read_b128 v[104:107], v17 offset:64
    ds_read_b128 v[108:111], v17 offset:4672
    ds_read_b128 v[112:115], v17 offset:128
    ds_read_b128 v[116:119], v17 offset:4736
    ds_read_b128 v[120:123], v17 offset:192
    ds_read_b128 v[124:127], v17 offset:4800
.p2align 3
    ds_write_addtid_b32 v39 offset:0
    v_pk_mul_f16 v72, v39, v27 op_sel:[0,0] op_sel_hi:[1,0]
    v_pk_fma_f16 v72, v39, v27, v72 op_sel:[1,1,0] op_sel_hi:[0,1,1] neg_lo:[1,0,0]
    ds_write_addtid_b32 v72 offset:288
    v_pk_mul_f16 v73, v39, v29 op_sel:[0,0] op_sel_hi:[1,0]
    v_pk_fma_f16 v73, v39, v29, v73 op_sel:[1,1,0] op_sel_hi:[0,1,1] neg_lo:[1,0,0]
    ds_write_addtid_b32 v73 offset:576
    v_pk_mul_f16 v74, v39, v66 op_sel:[0,0] op_sel_hi:[1,0]
    v_pk_fma_f16 v74, v39, v66, v74 op_sel:[1,1,0] op_sel_hi:[0,1,1] neg_lo:[1,0,0]
    ds_write_addtid_b32 v74 offset:864
    v_pk_mul_f16 v75, v39, v30 op_sel:[0,0] op_sel_hi:[1,0]
    v_pk_fma_f16 v75, v39, v30, v75 op_sel:[1,1,0] op_sel_hi:[0,1,1] neg_lo:[1,0,0]
    ds_write_addtid_b32 v75 offset:1152
    v_pk_mul_f16 v76, v39, v67 op_sel:[0,0] op_sel_hi:[1,0]
    v_pk_fma_f16 v76, v39, v67, v76 op_sel:[1,1,0] op_sel_hi:[0,1,1] neg_lo:[1,0,0]
    ds_write_addtid_b32 v76 offset:1440
    v_pk_mul_f16 v69, v39, v31 op_sel:[0,0] op_sel_hi:[1,0]
    v_pk_fma_f16 v69, v39, v31, v69 op_sel:[1,1,0] op_sel_hi:[0,1,1] neg_lo:[1,0,0]
    ds_write_addtid_b32 v69 offset:1728
    v_pk_mul_f16 v70, v39, v68 op_sel:[0,0] op_sel_hi:[1,0]
    v_pk_fma_f16 v70, v39, v68, v70 op_sel:[1,1,0] op_sel_hi:[0,1,1] neg_lo:[1,0,0]
    ds_write_addtid_b32 v70 offset:2016
    v_pk_mul_f16 v71, v39, v32 op_sel:[0,0] op_sel_hi:[1,0]
    v_pk_fma_f16 v71, v39, v32, v71 op_sel:[1,1,0] op_sel_hi:[0,1,1] neg_lo:[1,0,0]
    ds_write_addtid_b32 v71 offset:2304
    ds_write_addtid_b32 v40 offset:2592
    v_pk_mul_f16 v72, v40, v29 op_sel:[0,0] op_sel_hi:[1,0]
    v_pk_fma_f16 v72, v40, v29, v72 op_sel:[1,1,0] op_sel_hi:[0,1,1] neg_lo:[1,0,0]
    ds_write_addtid_b32 v72 offset:2880
    v_pk_mul_f16 v73, v40, v30 op_sel:[0,0] op_sel_hi:[1,0]
    v_pk_fma_f16 v73, v40, v30, v73 op_sel:[1,1,0] op_sel_hi:[0,1,1] neg_lo:[1,0,0]
    ds_write_addtid_b32 v73 offset:3168
    v_pk_mul_f16 v74, v40, v31 op_sel:[0,0] op_sel_hi:[1,0]
    v_pk_fma_f16 v74, v40, v31, v74 op_sel:[1,1,0] op_sel_hi:[0,1,1] neg_lo:[1,0,0]
    ds_write_addtid_b32 v74 offset:3456
    v_pk_mul_f16 v75, v40, v32 op_sel:[0,0] op_sel_hi:[1,0]
    v_pk_fma_f16 v75, v40, v32, v75 op_sel:[1,1,0] op_sel_hi:[0,1,1] neg_lo:[1,0,0]
    ds_write_addtid_b32 v75 offset:3744
    ds_write_addtid_b32 v41 offset:4032
    v_pk_mul_f16 v76, v41, v29 op_sel:[0,0] op_sel_hi:[1,0]
    v_pk_fma_f16 v76, v41, v29, v76 op_sel:[1,1,0] op_sel_hi:[0,1,1] neg_lo:[1,0,0]
    ds_write_addtid_b32 v76 offset:4320
    v_pk_mul_f16 v69, v41, v30 op_sel:[0,0] op_sel_hi:[1,0]
    v_pk_fma_f16 v69, v41, v30, v69 op_sel:[1,1,0] op_sel_hi:[0,1,1] neg_lo:[1,0,0]
    ds_write_addtid_b32 v69 offset:4608
    v_pk_mul_f16 v70, v41, v31 op_sel:[0,0] op_sel_hi:[1,0]
    v_pk_fma_f16 v70, v41, v31, v70 op_sel:[1,1,0] op_sel_hi:[0,1,1] neg_lo:[1,0,0]
    ds_write_addtid_b32 v70 offset:4896
    v_pk_mul_f16 v71, v41, v32 op_sel:[0,0] op_sel_hi:[1,0]
    v_pk_fma_f16 v71, v41, v32, v71 op_sel:[1,1,0] op_sel_hi:[0,1,1] neg_lo:[1,0,0]
    ds_write_addtid_b32 v71 offset:5184
    ds_write_addtid_b32 v42 offset:5472
    v_pk_mul_f16 v72, v42, v30 op_sel:[0,0] op_sel_hi:[1,0]
    v_pk_fma_f16 v72, v42, v30, v72 op_sel:[1,1,0] op_sel_hi:[0,1,1] neg_lo:[1,0,0]
    ds_write_addtid_b32 v72 offset:5760
    v_pk_mul_f16 v73, v42, v32 op_sel:[0,0] op_sel_hi:[1,0]
    v_pk_fma_f16 v73, v42, v32, v73 op_sel:[1,1,0] op_sel_hi:[0,1,1] neg_lo:[1,0,0]
    ds_write_addtid_b32 v73 offset:6048
    ds_write_addtid_b32 v43 offset:6336
    v_pk_mul_f16 v74, v43, v30 op_sel:[0,0] op_sel_hi:[1,0]
    v_pk_fma_f16 v74, v43, v30, v74 op_sel:[1,1,0] op_sel_hi:[0,1,1] neg_lo:[1,0,0]
    ds_write_addtid_b32 v74 offset:6624
    v_pk_mul_f16 v75, v43, v32 op_sel:[0,0] op_sel_hi:[1,0]
    v_pk_fma_f16 v75, v43, v32, v75 op_sel:[1,1,0] op_sel_hi:[0,1,1] neg_lo:[1,0,0]
    ds_write_addtid_b32 v75 offset:6912
    ds_write_addtid_b32 v44 offset:7200
    v_pk_mul_f16 v76, v44, v30 op_sel:[0,0] op_sel_hi:[1,0]
    v_pk_fma_f16 v76, v44, v30, v76 op_sel:[1,1,0] op_sel_hi:[0,1,1] neg_lo:[1,0,0]
    ds_write_addtid_b32 v76 offset:7488
    v_pk_mul_f16 v69, v44, v32 op_sel:[0,0] op_sel_hi:[1,0]
    v_pk_fma_f16 v69, v44, v32, v69 op_sel:[1,1,0] op_sel_hi:[0,1,1] neg_lo:[1,0,0]
    ds_write_addtid_b32 v69 offset:7776
    ds_write_addtid_b32 v45 offset:8064
    v_pk_mul_f16 v70, v45, v30 op_sel:[0,0] op_sel_hi:[1,0]
    v_pk_fma_f16 v70, v45, v30, v70 op_sel:[1,1,0] op_sel_hi:[0,1,1] neg_lo:[1,0,0]
    ds_write_addtid_b32 v70 offset:8352
    v_pk_mul_f16 v71, v45, v32 op_sel:[0,0] op_sel_hi:[1,0]
    v_pk_fma_f16 v71, v45, v32, v71 op_sel:[1,1,0] op_sel_hi:[0,1,1] neg_lo:[1,0,0]
    ds_write_addtid_b32 v71 offset:8640
    s_add_u32 s56, s55, 80
    s_mul_i32 s57, s56, 57
    s_lshr_b32 s57, s57, 9
    s_mul_i32 s49, s57, 9
    s_sub_u32 s56, s56, s49
    s_lshr_b32 s58, s57, 1
    s_add_u32 s58, s58, s59
    s_cmp_ge_u32 s58, 9
    s_cselect_b32 s62, 9, 0
    s_sub_u32 s58, s58, s62
    s_and_b32 s57, s57, 1
    s_cmp_eq_u32 s57, 0
    s_cselect_b32 s44, s28, s30
    s_cselect_b32 s45, s29, s31
    s_mov_b32 s46, 663552
    s_mov_b32 s47, 0x00020000
    s_mul_i32 s49, s56, 73728
    s_lshl_b32 s50, s58, 7
    s_add_u32 s49, s49, s50
    buffer_load_dword v250, v6, s[44:47], s49 offen
p_t3:
    s_waitcnt lgkmcnt(14)
    ds_read_b128 v[128:131], v18 offset:0
    ds_read_b128 v[132:135], v19 offset:0
    ds_read_b128 v[136:139], v20 offset:0
    ds_read_b128 v[140:143], v18 offset:64
    ds_read_b128 v[144:147], v19 offset:64
    ds_read_b128 v[148:151], v20 offset:64
    v_mfma_f32_16x16x32_f16 v[80:83], v[96:99], v[100:103], 0
    v_mfma_f32_16x16x32_f16 v[80:83], v[104:107], v[108:111], v[80:83]
    v_mfma_f32_16x16x32_f16 v[80:83], v[112:115], v[116:119], v[80:83]
    v_mfma_f32_16x16x32_f16 v[80:83], v[120:123], v[124:127], v[80:83]
    s_waitcnt lgkmcnt(3)
    v_mfma_f32_16x16x32_f16 v[84:87], v[128:131], v[100:103], 0
    v_mfma_f32_16x16x32_f16 v[88:91], v[132:135], v[100:103], 0
    v_mfma_f32_16x16x32_f16 v[92:95], v[136:139], v[100:103], 0
    ds_read_b128 v[128:131], v18 offset:128
    ds_read_b128 v[132:135], v19 offset:128
    ds_read_b128 v[136:139], v20 offset:128
    s_waitcnt lgkmcnt(3)
    v_mfma_f32_16x16x32_f16 v[84:87], v[140:143], v[108:111], v[84:87]
    v_mfma_f32_16x16x32_f16 v[88:91], v[144:147], v[108:111], v[88:91]
    v_mfma_f32_16x16x32_f16 v[92:95], v[148:151], v[108:111], v[92:95]
    ds_read_b128 v[140:143], v18 offset:192
    ds_read_b128 v[144:147], v19 offset:192
    ds_read_b128 v[148:151], v20 offset:192
    s_waitcnt lgkmcnt(3)
    v_mfma_f32_16x16x32_f16 v[84:87], v[128:131], v[116:119], v[84:87]
    v_mfma_f32_16x16x32_f16 v[88:91], v[132:135], v[116:119], v[88:91]
    v_mfma_f32_16x16x32_f16 v[92:95], v[136:139], v[116:119], v[92:95]
    s_waitcnt lgkmcnt(0)
    v_mfma_f32_16x16x32_f16 v[84:87], v[140:143], v[124:127], v[84:87]
    v_mfma_f32_16x16x32_f16 v[88:91], v[144:147], v[124:127], v[88:91]
    v_mfma_f32_16x16x32_f16 v[92:95], v[148:151], v[124:127], v[92:95]
    v_mov_b32 v24, 0x3c00
    s_mov_b32 m0, s54
    s_nop 0
.p2align 3
    ds_write_addtid_b32 v24 offset:0
    ds_write_addtid_b32 v46 offset:288
    ds_write_addtid_b32 v47 offset:576
    ds_write_addtid_b32 v48 offset:864
    ds_write_addtid_b32 v49 offset:1152
    v_pk_mul_f16 v72, v49, v46 op_sel:[0,0] op_sel_hi:[1,0]
    v_pk_fma_f16 v72, v49, v46, v72 op_sel:[1,1,0] op_sel_hi:[0,1,1] neg_lo:[1,0,0]
    ds_write_addtid_b32 v72 offset:1440
    v_pk_mul_f16 v66, v49, v47 op_sel:[0,0] op_sel_hi:[1,0]
    v_pk_fma_f16 v66, v49, v47, v66 op_sel:[1,1,0] op_sel_hi:[0,1,1] neg_lo:[1,0,0]
    ds_write_addtid_b32 v66 offset:1728
    v_pk_mul_f16 v73, v49, v48 op_sel:[0,0] op_sel_hi:[1,0]
    v_pk_fma_f16 v73, v49, v48, v73 op_sel:[1,1,0] op_sel_hi:[0,1,1] neg_lo:[1,0,0]
    ds_write_addtid_b32 v73 offset:2016
    ds_write_addtid_b32 v50 offset:2304
    v_pk_mul_f16 v74, v50, v46 op_sel:[0,0] op_sel_hi:[1,0]
    v_pk_fma_f16 v74, v50, v46, v74 op_sel:[1,1,0] op_sel_hi:[0,1,1] neg_lo:[1,0,0]
    ds_write_addtid_b32 v74 offset:2592
    v_pk_mul_f16 v67, v50, v47 op_sel:[0,0] op_sel_hi:[1,0]
    v_pk_fma_f16 v67, v50, v47, v67 op_sel:[1,1,0] op_sel_hi:[0,1,1] neg_lo:[1,0,0]
    ds_write_addtid_b32 v67 offset:2880
    v_pk_mul_f16 v75, v50, v48 op_sel:[0,0] op_sel_hi:[1,0]
    v_pk_fma_f16 v75, v50, v48, v75 op_sel:[1,1,0] op_sel_hi:[0,1,1] neg_lo:[1,0,0]
    ds_write_addtid_b32 v75 offset:3168
    ds_write_addtid_b32 v51 offset:3456
    v_pk_mul_f16 v76, v51, v46 op_sel:[0,0] op_sel_hi:[1,0]
    v_pk_fma_f16 v76, v51, v46, v76 op_sel:[1,1,0] op_sel_hi:[0,1,1] neg_lo:[1,0,0]
    ds_write_addtid_b32 v76 offset:3744
    v_pk_mul_f16 v68, v51, v47 op_sel:[0,0] op_sel_hi:[1,0]
    v_pk_fma_f16 v68, v51, v47, v68 op_sel:[1,1,0] op_sel_hi:[0,1,1] neg_lo:[1,0,0]
    ds_write_addtid_b32 v68 offset:4032
    v_pk_mul_f16 v69, v51, v48 op_sel:[0,0] op_sel_hi:[1,0]
    v_pk_fma_f16 v69, v51, v48, v69 op_sel:[1,1,0] op_sel_hi:[0,1,1] neg_lo:[1,0,0]
    ds_write_addtid_b32 v69 offset:4320
    ds_write_addtid_b32 v55 offset:4608
    v_pk_mul_f16 v70, v55, v52 op_sel:[0,0] op_sel_hi:[1,0]
    v_pk_fma_f16 v70, v55, v52, v70 op_sel:[1,1,0] op_sel_hi:[0,1,1] neg_hi:[1,0,0]
    ds_write_addtid_b32 v70 offset:4896
    v_pk_mul_f16 v71, v55, v53 op_sel:[0,0] op_sel_hi:[1,0]
    v_pk_fma_f16 v71, v55, v53, v71 op_sel:[1,1,0] op_sel_hi:[0,1,1] neg_hi:[1,0,0]
    ds_write_addtid_b32 v71 offset:5184
    v_pk_mul_f16 v72, v55, v54 op_sel:[0,0] op_sel_hi:[1,0]
    v_pk_fma_f16 v72, v55, v54, v72 op_sel:[1,1,0] op_sel_hi:[0,1,1] neg_hi:[1,0,0]
    ds_write_addtid_b32 v72 offset:5472
    ds_write_addtid_b32 v56 offset:5760
    v_pk_mul_f16 v73, v56, v52 op_sel:[0,0] op_sel_hi:[1,0]
    v_pk_fma_f16 v73, v56, v52, v73 op_sel:[1,1,0] op_sel_hi:[0,1,1] neg_hi:[1,0,0]
    ds_write_addtid_b32 v73 offset:6048
    v_pk_mul_f16 v74, v56, v53 op_sel:[0,0] op_sel_hi:[1,0]
    v_pk_fma_f16 v74, v56, v53, v74 op_sel:[1,1,0] op_sel_hi:[0,1,1] neg_hi:[1,0,0]
    ds_write_addtid_b32 v74 offset:6336
    v_pk_mul_f16 v75, v56, v54 op_sel:[0,0] op_sel_hi:[1,0]
    v_pk_fma_f16 v75, v56, v54, v75 op_sel:[1,1,0] op_sel_hi:[0,1,1] neg_hi:[1,0,0]
    ds_write_addtid_b32 v75 offset:6624
    ds_write_addtid_b32 v57 offset:6912
    v_pk_mul_f16 v76, v57, v52 op_sel:[0,0] op_sel_hi:[1,0]
    v_pk_fma_f16 v76, v57, v52, v76 op_sel:[1,1,0] op_sel_hi:[0,1,1] neg_hi:[1,0,0]
    ds_write_addtid_b32 v76 offset:7200
    v_pk_mul_f16 v69, v57, v53 op_sel:[0,0] op_sel_hi:[1,0]
    v_pk_fma_f16 v69, v57, v53, v69 op_sel:[1,1,0] op_sel_hi:[0,1,1] neg_hi:[1,0,0]
    ds_write_addtid_b32 v69 offset:7488
    v_pk_mul_f16 v70, v57, v54 op_sel:[0,0] op_sel_hi:[1,0]
    v_pk_fma_f16 v70, v57, v54, v70 op_sel:[1,1,0] op_sel_hi:[0,1,1] neg_hi:[1,0,0]
    ds_write_addtid_b32 v70 offset:7776
    ds_write_addtid_b32 v58 offset:8064
    v_pk_mul_f16 v71, v58, v52 op_sel:[0,0] op_sel_hi:[1,0]
    v_pk_fma_f16 v71, v58, v52, v71 op_sel:[1,1,0] op_sel_hi:[0,1,1] neg_hi:[1,0,0]
    ds_write_addtid_b32 v71 offset:8352
    v_pk_mul_f16 v72, v58, v53 op_sel:[0,0] op_sel_hi:[1,0]
    v_pk_fma_f16 v72, v58, v53, v72 op_sel:[1,1,0] op_sel_hi:[0,1,1] neg_hi:[1,0,0]
    ds_write_addtid_b32 v72 offset:8640
    v_pk_mul_f16 v73, v58, v54 op_sel:[0,0] op_sel_hi:[1,0]
    v_pk_fma_f16 v73, v58, v54, v73 op_sel:[1,1,0] op_sel_hi:[0,1,1] neg_hi:[1,0,0]
    ds_write_addtid_b32 v73 offset:8928
    ds_read_b128 v[96:99], v17 offset:0
    ds_read_b128 v[100:103], v17 offset:4608
    ds_read_b128 v[104:107], v17 offset:64
    ds_read_b128 v[108:111], v17 offset:4672
    ds_read_b128 v[112:115], v17 offset:128
    ds_read_b128 v[116:119], v17 offset:4736
    ds_read_b128 v[120:123], v17 offset:192
    ds_read_b128 v[124:127], v17 offset:4800
.p2align 3
    ds_write_addtid_b32 v59 offset:0
    v_pk_mul_f16 v74, v59, v47 op_sel:[0,0] op_sel_hi:[1,0]
    v_pk_fma_f16 v74, v59, v47, v74 op_sel:[1,1,0] op_sel_hi:[0,1,1] neg_lo:[1,0,0]
    ds_write_addtid_b32 v74 offset:288
    v_pk_mul_f16 v75, v59, v49 op_sel:[0,0] op_sel_hi:[1,0]
    v_pk_fma_f16 v75, v59, v49, v75 op_sel:[1,1,0] op_sel_hi:[0,1,1] neg_lo:[1,0,0]
    ds_write_addtid_b32 v75 offset:576
    v_pk_mul_f16 v76, v59, v66 op_sel:[0,0] op_sel_hi:[1,0]
    v_pk_fma_f16 v76, v59, v66, v76 op_sel:[1,1,0] op_sel_hi:[0,1,1] neg_lo:[1,0,0]
    ds_write_addtid_b32 v76 offset:864
    v_pk_mul_f16 v69, v59, v50 op_sel:[0,0] op_sel_hi:[1,0]
    v_pk_fma_f16 v69, v59, v50, v69 op_sel:[1,1,0] op_sel_hi:[0,1,1] neg_lo:[1,0,0]
    ds_write_addtid_b32 v69 offset:1152
    v_pk_mul_f16 v70, v59, v67 op_sel:[0,0] op_sel_hi:[1,0]
    v_pk_fma_f16 v70, v59, v67, v70 op_sel:[1,1,0] op_sel_hi:[0,1,1] neg_lo:[1,0,0]
    ds_write_addtid_b32 v70 offset:1440
    v_pk_mul_f16 v71, v59, v51 op_sel:[0,0] op_sel_hi:[1,0]
    v_pk_fma_f16 v71, v59, v51, v71 op_sel:[1,1,0] op_sel_hi:[0,1,1] neg_lo:[1,0,0]
    ds_write_addtid_b32 v71 offset:1728
    v_pk_mul_f16 v72, v59, v68 op_sel:[0,0] op_sel_hi:[1,0]
    v_pk_fma_f16 v72, v59, v68, v72 op_sel:[1,1,0] op_sel_hi:[0,1,1] neg_lo:[1,0,0]
    ds_write_addtid_b32 v72 offset:2016
    v_pk_mul_f16 v73, v59, v52 op_sel:[0,0] op_sel_hi:[1,0]
    v_pk_fma_f16 v73, v59, v52, v73 op_sel:[1,1,0] op_sel_hi:[0,1,1] neg_lo:[1,0,0]
    ds_write_addtid_b32 v73 offset:2304
    ds_write_addtid_b32 v60 offset:2592
    v_pk_mul_f16 v74, v60, v49 op_sel:[0,0] op_sel_hi:[1,0]
    v_pk_fma_f16 v74, v60, v49, v74 op_sel:[1,1,0] op_sel_hi:[0,1,1] neg_lo:[1,0,0]
    ds_write_addtid_b32 v74 offset:2880
    v_pk_mul_f16 v75, v60, v50 op_sel:[0,0] op_sel_hi:[1,0]
    v_pk_fma_f16 v75, v60, v50, v75 op_sel:[1,1,0] op_sel_hi:[0,1,1] neg_lo:[1,0,0]
    ds_write_addtid_b32 v75 offset:3168
    v_pk_mul_f16 v76, v60, v51 op_sel:[0,0] op_sel_hi:[1,0]
    v_pk_fma_f16 v76, v60, v51, v76 op_sel:[1,1,0] op_sel_hi:[0,1,1] neg_lo:[1,0,0]
    ds_write_addtid_b32 v76 offset:3456
    v_pk_mul_f16 v69, v60, v52 op_sel:[0,0] op_sel_hi:[1,0]
    v_pk_fma_f16 v69, v60, v52, v69 op_sel:[1,1,0] op_sel_hi:[0,1,1] neg_lo:[1,0,0]
    ds_write_addtid_b32 v69 offset:3744
    ds_write_addtid_b32 v61 offset:4032
    v_pk_mul_f16 v70, v61, v49 op_sel:[0,0] op_sel_hi:[1,0]
    v_pk_fma_f16 v70, v61, v49, v70 op_sel:[1,1,0] op_sel_hi:[0,1,1] neg_lo:[1,0,0]
    ds_write_addtid_b32 v70 offset:4320
    v_pk_mul_f16 v71, v61, v50 op_sel:[0,0] op_sel_hi:[1,0]
    v_pk_fma_f16 v71, v61, v50, v71 op_sel:[1,1,0] op_sel_hi:[0,1,1] neg_lo:[1,0,0]
    ds_write_addtid_b32 v71 offset:4608
    v_pk_mul_f16 v72, v61, v51 op_sel:[0,0] op_sel_hi:[1,0]
    v_pk_fma_f16 v72, v61, v51, v72 op_sel:[1,1,0] op_sel_hi:[0,1,1] neg_lo:[1,0,0]
    ds_write_addtid_b32 v72 offset:4896
    v_pk_mul_f16 v73, v61, v52 op_sel:[0,0] op_sel_hi:[1,0]
    v_pk_fma_f16 v73, v61, v52, v73 op_sel:[1,1,0] op_sel_hi:[0,1,1] neg_lo:[1,0,0]
    ds_write_addtid_b32 v73 offset:5184
    ds_write_addtid_b32 v62 offset:5472
    v_pk_mul_f16 v74, v62, v50 op_sel:[0,0] op_sel_hi:[1,0]
    v_pk_fma_f16 v74, v62, v50, v74 op_sel:[1,1,0] op_sel_hi:[0,1,1] neg_lo:[1,0,0]
    ds_write_addtid_b32 v74 offset:5760
    v_pk_mul_f16 v75, v62, v52 op_sel:[0,0] op_sel_hi:[1,0]
    v_pk_fma_f16 v75, v62, v52, v75 op_sel:[1,1,0] op_sel_hi:[0,1,1] neg_lo:[1,0,0]
    ds_write_addtid_b32 v75 offset:6048
    ds_write_addtid_b32 v63 offset:6336
    v_pk_mul_f16 v76, v63, v50 op_sel:[0,0] op_sel_hi:[1,0]
    v_pk_fma_f16 v76, v63, v50, v76 op_sel:[1,1,0] op_sel_hi:[0,1,1] neg_lo:[1,0,0]
    ds_write_addtid_b32 v76 offset:6624
    v_pk_mul_f16 v69, v63, v52 op_sel:[0,0] op_sel_hi:[1,0]
    v_pk_fma_f16 v69, v63, v52, v69 op_sel:[1,1,0] op_sel_hi:[0,1,1] neg_lo:[1,0,0]
    ds_write_addtid_b32 v69 offset:6912
    ds_write_addtid_b32 v64 offset:7200
    v_pk_mul_f16 v70, v64, v50 op_sel:[0,0] op_sel_hi:[1,0]
    v_pk_fma_f16 v70, v64, v50, v70 op_sel:[1,1,0] op_sel_hi:[0,1,1] neg_lo:[1,0,0]
    ds_write_addtid_b32 v70 offset:7488
    v_pk_mul_f16 v71, v64, v52 op_sel:[0,0] op_sel_hi:[1,0]
    v_pk_fma_f16 v71, v64, v52, v71 op_sel:[1,1,0] op_sel_hi:[0,1,1] neg_lo:[1,0,0]
    ds_write_addtid_b32 v71 offset:7776
    ds_write_addtid_b32 v65 offset:8064
    v_pk_mul_f16 v72, v65, v50 op_sel:[0,0] op_sel_hi:[1,0]
    v_pk_fma_f16 v72, v65, v50, v72 op_sel:[1,1,0] op_sel_hi:[0,1,1] neg_lo:[1,0,0]
    ds_write_addtid_b32 v72 offset:8352
    v_pk_mul_f16 v73, v65, v52 op_sel:[0,0] op_sel_hi:[1,0]
    v_pk_fma_f16 v73, v65, v52, v73 op_sel:[1,1,0] op_sel_hi:[0,1,1] neg_lo:[1,0,0]
    ds_write_addtid_b32 v73 offset:8640
    s_waitcnt lgkmcnt(14)
    ds_read_b128 v[128:131], v18 offset:0
    ds_read_b128 v[132:135], v19 offset:0
    ds_read_b128 v[136:139], v20 offset:0
    ds_read_b128 v[140:143], v18 offset:64
    ds_read_b128 v[144:147], v19 offset:64
    ds_read_b128 v[148:151], v20 offset:64
    v_mfma_f32_16x16x32_f16 v[80:83], v[96:99], v[100:103], v[80:83]
    v_mfma_f32_16x16x32_f16 v[80:83], v[104:107], v[108:111], v[80:83]
    v_mfma_f32_16x16x32_f16 v[80:83], v[112:115], v[116:119], v[80:83]
    v_mfma_f32_16x16x32_f16 v[80:83], v[120:123], v[124:127], v[80:83]
    s_waitcnt lgkmcnt(3)
    v_mfma_f32_16x16x32_f16 v[84:87], v[128:131], v[100:103], v[84:87]
    v_mfma_f32_16x16x32_f16 v[88:91], v[132:135], v[100:103], v[88:91]
    v_mfma_f32_16x16x32_f16 v[92:95], v[136:139], v[100:103], v[92:95]
    ds_read_b128 v[128:131], v18 offset:128
    ds_read_b128 v[132:135], v19 offset:128
    ds_read_b128 v[136:139], v20 offset:128
    s_waitcnt lgkmcnt(3)
    v_mfma_f32_16x16x32_f16 v[84:87], v[140:143], v[108:111], v[84:87]
    v_mfma_f32_16x16x32_f16 v[88:91], v[144:147], v[108:111], v[88:91]
    v_mfma_f32_16x16x32_f16 v[92:95], v[148:151], v[108:111], v[92:95]
    ds_read_b128 v[140:143], v18 offset:192
    ds_read_b128 v[144:147], v19 offset:192
    ds_read_b128 v[148:151], v20 offset:192
    s_waitcnt lgkmcnt(3)
    v_mfma_f32_16x16x32_f16 v[84:87], v[128:131], v[116:119], v[84:87]
    v_mfma_f32_16x16x32_f16 v[88:91], v[132:135], v[116:119], v[88:91]
    v_mfma_f32_16x16x32_f16 v[92:95], v[136:139], v[116:119], v[92:95]
    s_waitcnt lgkmcnt(0)
    v_mfma_f32_16x16x32_f16 v[84:87], v[140:143], v[124:127], v[84:87]
    v_mfma_f32_16x16x32_f16 v[88:91], v[144:147], v[124:127], v[88:91]
    v_mfma_f32_16x16x32_f16 v[92:95], v[148:151], v[124:127], v[92:95]
    v_mul_f32 v24, s61, v23
    v_mul_f32 v80, v80, v24
    v_mul_f32 v81, v81, v24
    v_mul_f32 v82, v82, v24
    v_mul_f32 v83, v83, v24
    s_nop 0
    v_mul_f32 v84, v84, v24
    v_mul_f32 v85, v85, v24
    v_mul_f32 v86, v86, v24
    v_mul_f32 v87, v87, v24
    v_mul_f32 v88, v88, v24
    v_mul_f32 v89, v89, v24
    v_mul_f32 v90, v90, v24
    v_mul_f32 v92, v92, v24
    v_mul_f32 v93, v93, v24
    v_mul_f32 v94, v94, v24
    v_cvt_pk_bf16_f32 v96, v83, v82
    v_cvt_pk_bf16_f32 v97, v81, v80
    v_cvt_pk_bf16_f32 v98, v87, v86
    v_cvt_pk_bf16_f32 v99, v85, v84
    v_cvt_pk_bf16_f32 v100, v90, v90
    v_cvt_pk_bf16_f32 v101, v89, v89
    v_cvt_pk_bf16_f32 v102, v89, v88
    v_cvt_pk_bf16_f32 v103, v88, v88
    v_cvt_pk_bf16_f32 v104, v94, v94
    v_cvt_pk_bf16_f32 v105, v94, v94
    v_cvt_pk_bf16_f32 v106, v93, v93
    v_cvt_pk_bf16_f32 v107, v93, v93
    v_cvt_pk_bf16_f32 v108, v93, v93
    v_cvt_pk_bf16_f32 v109, v93, v92
    v_cvt_pk_bf16_f32 v110, v92, v92
    v_cvt_pk_bf16_f32 v111, v92, v92
    buffer_load_dword v4, v7, s[36:39], 0 offen offset:240 sc1
    s_add_u32 s40, s18, 9437184
    s_addc_u32 s41, s19, 0
    s_mov_b32 s42, 1179648
    s_mov_b32 s43, 0x00020000
    v_lshlrev_b32 v5, 4, v1
    s_lshl_b32 s49, s52, 2
    s_add_u32 s49, s49, s53
    s_lshl_b32 s49, s49, 12
    buffer_store_dwordx4 v[96:99], v5, s[40:43], s49 offen offset:0 sc1
    buffer_store_dwordx4 v[100:103], v5, s[40:43], s49 offen offset:1024 sc1
    buffer_store_dwordx4 v[104:107], v5, s[40:43], s49 offen offset:2048 sc1
    buffer_store_dwordx4 v[108:111], v5, s[40:43], s49 offen offset:3072 sc1
    s_add_u32 s40, s18, 8480768
    s_addc_u32 s41, s19, 0
    s_mov_b32 s42, 9216
    s_mov_b32 s43, 0x00020000
    s_lshl_b32 s49, s52, 7
    s_lshl_b32 s50, s53, 2
    s_add_u32 s49, s49, s50
    v_mov_b32 v2, s49
    v_mov_b32 v3, 0x7fffffff
    v_cmp_eq_u32 vcc, 0, v1
    s_nop 1
    v_cndmask_b32 v2, v3, v2, vcc
    v_mov_b32 v3, 1
    s_waitcnt vmcnt(0)
p_clr:
    v_cmp_eq_u32 vcc, 0, v4
    s_nop 0
    s_cmp_eq_u64 vcc, 0
    s_cbranch_scc1 p_clr_ok
    s_sleep 2
    buffer_load_dword v4, v7, s[36:39], 0 offen offset:240 sc1
    s_waitcnt vmcnt(0)
    s_branch p_clr
p_clr_ok:
    buffer_store_dword v3, v2, s[40:43], 0 offen sc1
    s_add_u32 s56, s55, 120
    s_mul_i32 s57, s56, 57
    s_lshr_b32 s57, s57, 9
    s_mul_i32 s49, s57, 9
    s_sub_u32 s56, s56, s49
    s_lshr_b32 s58, s57, 1
    s_add_u32 s58, s58, s59
    s_cmp_ge_u32 s58, 9
    s_cselect_b32 s62, 9, 0
    s_sub_u32 s58, s58, s62
    s_and_b32 s57, s57, 1
    s_cmp_eq_u32 s57, 0
    s_cselect_b32 s44, s28, s30
    s_cselect_b32 s45, s29, s31
    s_mov_b32 s46, 663552
    s_mov_b32 s47, 0x00020000
    s_mul_i32 s49, s56, 73728
    s_lshl_b32 s50, s58, 7
    s_add_u32 s49, s49, s50
    buffer_load_dword v250, v6, s[44:47], s49 offen
p_t4:
    s_add_u32 s56, s55, 160
    s_cmp_ge_u32 s56, 162
    s_cbranch_scc1 p_t5
    s_mul_i32 s57, s56, 57
    s_lshr_b32 s57, s57, 9
    s_mul_i32 s49, s57, 9
    s_sub_u32 s56, s56, s49
    s_lshr_b32 s58, s57, 1
    s_add_u32 s58, s58, s59
    s_cmp_ge_u32 s58, 9
    s_cselect_b32 s62, 9, 0
    s_sub_u32 s58, s58, s62
    s_and_b32 s57, s57, 1
    s_cmp_eq_u32 s57, 0
    s_cselect_b32 s44, s28, s30
    s_cselect_b32 s45, s29, s31
    s_mov_b32 s46, 663552
    s_mov_b32 s47, 0x00020000
    s_mul_i32 s49, s56, 73728
    s_lshl_b32 s50, s58, 7
    s_add_u32 s49, s49, s50
    buffer_load_dword v250, v6, s[44:47], s49 offen
p_t5:
    s_endpgm
p_nok:
    s_add_u32 s56, s55, 40
    s_mul_i32 s57, s56, 57
    s_lshr_b32 s57, s57, 9
    s_mul_i32 s49, s57, 9
    s_sub_u32 s56, s56, s49
    s_lshr_b32 s58, s57, 1
    s_add_u32 s58, s58, s59
    s_cmp_ge_u32 s58, 9
    s_cselect_b32 s62, 9, 0
    s_sub_u32 s58, s58, s62
    s_and_b32 s57, s57, 1
    s_cmp_eq_u32 s57, 0
    s_cselect_b32 s44, s28, s30
    s_cselect_b32 s45, s29, s31
    s_mov_b32 s46, 663552
    s_mov_b32 s47, 0x00020000
    s_mul_i32 s49, s56, 73728
    s_lshl_b32 s50, s58, 7
    s_add_u32 s49, s49, s50
    buffer_load_dword v250, v6, s[44:47], s49 offen
p_t6:
    s_add_u32 s56, s55, 80
    s_mul_i32 s57, s56, 57
    s_lshr_b32 s57, s57, 9
    s_mul_i32 s49, s57, 9
    s_sub_u32 s56, s56, s49
    s_lshr_b32 s58, s57, 1
    s_add_u32 s58, s58, s59
    s_cmp_ge_u32 s58, 9
    s_cselect_b32 s62, 9, 0
    s_sub_u32 s58, s58, s62
    s_and_b32 s57, s57, 1
    s_cmp_eq_u32 s57, 0
    s_cselect_b32 s44, s28, s30
    s_cselect_b32 s45, s29, s31
    s_mov_b32 s46, 663552
    s_mov_b32 s47, 0x00020000
    s_mul_i32 s49, s56, 73728
    s_lshl_b32 s50, s58, 7
    s_add_u32 s49, s49, s50
    buffer_load_dword v250, v6, s[44:47], s49 offen
p_t7:
    s_add_u32 s56, s55, 120
    s_mul_i32 s57, s56, 57
    s_lshr_b32 s57, s57, 9
    s_mul_i32 s49, s57, 9
    s_sub_u32 s56, s56, s49
    s_lshr_b32 s58, s57, 1
    s_add_u32 s58, s58, s59
    s_cmp_ge_u32 s58, 9
    s_cselect_b32 s62, 9, 0
    s_sub_u32 s58, s58, s62
    s_and_b32 s57, s57, 1
    s_cmp_eq_u32 s57, 0
    s_cselect_b32 s44, s28, s30
    s_cselect_b32 s45, s29, s31
    s_mov_b32 s46, 663552
    s_mov_b32 s47, 0x00020000
    s_mul_i32 s49, s56, 73728
    s_lshl_b32 s50, s58, 7
    s_add_u32 s49, s49, s50
    buffer_load_dword v250, v6, s[44:47], s49 offen
p_t8:
    s_add_u32 s56, s55, 160
    s_cmp_ge_u32 s56, 162
    s_cbranch_scc1 p_t9
    s_mul_i32 s57, s56, 57
    s_lshr_b32 s57, s57, 9
    s_mul_i32 s49, s57, 9
    s_sub_u32 s56, s56, s49
    s_lshr_b32 s58, s57, 1
    s_add_u32 s58, s58, s59
    s_cmp_ge_u32 s58, 9
    s_cselect_b32 s62, 9, 0
    s_sub_u32 s58, s58, s62
    s_and_b32 s57, s57, 1
    s_cmp_eq_u32 s57, 0
    s_cselect_b32 s44, s28, s30
    s_cselect_b32 s45, s29, s31
    s_mov_b32 s46, 663552
    s_mov_b32 s47, 0x00020000
    s_mul_i32 s49, s56, 73728
    s_lshl_b32 s50, s58, 7
    s_add_u32 s49, s49, s50
    buffer_load_dword v250, v6, s[44:47], s49 offen
p_t9:
    s_endpgm
k_end:
    s_endpgm
code_end:
.section .rodata,"a"
.p2align 6
.amdhsa_kernel concat_heads__ssm_conv_s5__ssm_conv_s4d__prompt_kernel
  .amdhsa_next_free_vgpr 256
  .amdhsa_next_free_sgpr 102
  .amdhsa_accum_offset 256
  .amdhsa_group_segment_fixed_size 0
  .amdhsa_kernarg_size 152
  .amdhsa_user_sgpr_count 2
  .amdhsa_user_sgpr_kernarg_segment_ptr 1
  .amdhsa_system_sgpr_workgroup_id_x 1
  .amdhsa_float_denorm_mode_32 3
.end_amdhsa_kernel
```
